```python
import torch

def _softmax(x, axis=-1):
    return torch.softmax(x, dim=axis)
def _gelu(x):
    return torch.nn.functional.gelu(x, approximate="tanh")
def _silu(x):
    return torch.nn.functional.silu(x)
def _sigmoid(x):
    return torch.sigmoid(x)
def _layernorm(x, axis=-1, eps=1e-5):
    m = x.mean(dim=axis, keepdim=True)
    v = x.var(dim=axis, keepdim=True, unbiased=False)
    return (x - m) / torch.sqrt(v + eps)
def _scatter_add(tgt, idx, src, axis=0):
    return tgt.clone().index_add_(axis, idx, src)
def _segment_sum(src, seg, n):
    out = torch.zeros((n,) + src.shape[1:], dtype=src.dtype)
    return out.index_add_(0, seg, src)
def _pad(x, pw):
    flat = tuple(v for pair in reversed(pw) for v in pair)
    return torch.nn.functional.pad(x, flat)

kernel_name = 'recurrent_scan__linear_attn_block__glu_gated_glu__prompt'

def setup_inputs():

    _w = (lambda a: (lambda t: t.to(torch.bfloat16) if t.is_floating_point() else t)(torch.as_tensor(a)))
    def _A_setup():
        B, S, D = 1, 2048, 576
        return {
            "x": _w((lambda *s: torch.randn(*s, dtype=torch.bfloat16) * 0.05)(B, S, D)),
            "wqkv": _w((lambda *s: torch.randn(*s, dtype=torch.bfloat16) * 0.05)(D, 3 * D)),
            "wo": _w((lambda *s: torch.randn(*s, dtype=torch.bfloat16) * 0.05)(D, D)),
        }
    _A_in = _A_setup()

    def _B_setup():
        B, S, D, F = 1, 2048, 576, 4608
        return {
            "x": _w((lambda *s: torch.randn(*s, dtype=torch.bfloat16) * 0.05)(B, S, D)),
            "w_gate": _w((lambda *s: torch.randn(*s, dtype=torch.bfloat16) * 0.05)(D, F)),
            "w_up": _w((lambda *s: torch.randn(*s, dtype=torch.bfloat16) * 0.05)(D, F)),
            "w_down": _w((lambda *s: torch.randn(*s, dtype=torch.bfloat16) * 0.05)(F, D)),
        }
    _B_in = _B_setup()

    return {
        "A_x": _A_in["x"],
        "A_wqkv": _A_in["wqkv"],
        "A_wo": _A_in["wo"],
        "B_x": _B_in["x"],
        "B_w_gate": _B_in["w_gate"],
        "B_w_up": _B_in["w_up"],
        "B_w_down": _B_in["w_down"],
    }

def reference(A_x, A_wqkv, A_wo, B_x, B_w_gate, B_w_up, B_w_down):
    def _A_ref(x, wqkv, wo):
        B, S, D = x.shape
        H = 32; Dh = D // H
        qkv = (lambda x, *d: x.permute(*d))((x @ wqkv).reshape(B, S, 3, H, Dh), 2, 0, 3, 1, 4)
        q, k, v = qkv[0], qkv[1], qkv[2]
        phi = lambda t: torch.where(t > 0, t + 1, torch.exp(t)) + 1e-6
        pq, pk = phi(q), phi(k)
        kv = torch.einsum("bhsd,bhse->bhde", pk, v)
        z = torch.einsum("bhsd->bhd", pk)
        num = torch.einsum("bhqd,bhde->bhqe", pq, kv)
        den = torch.einsum("bhqd,bhd->bhq", pq, z)[..., None] + 1e-6
        o = num / den
        return (lambda x, *d: x.permute(*d))(o, 0, 2, 1, 3).reshape(B, S, D) @ wo

    def _B_ref(x, w_gate, w_up, w_down):
        g = torch.einsum("bsd,df->bsf", x, w_gate)
        u = torch.einsum("bsd,df->bsf", x, w_up)
        h = _sigmoid(g) * u
        return torch.einsum("bsf,fd->bsd", h, w_down)

    x = A_x
    xn = _layernorm(x, axis=-1)
    s = _A_ref(xn, A_wqkv, A_wo)
    g = _silu(_B_ref(xn, B_w_gate, B_w_up, B_w_down))
    return x + s * g
```

```asm
; @launch grid=(256,1,1) block=(256,1,1) lds=163840
.amdgcn_target "amdgcn-amd-amdhsa--gfx950"
.text
.p2align 8
.fill 576, 4, 0xbf810000
.text
.globl recurrent_scan__linear_attn_block__glu_gated_glu__prompt_kernel
.p2align 8
.type recurrent_scan__linear_attn_block__glu_gated_glu__prompt_kernel,@function
recurrent_scan__linear_attn_block__glu_gated_glu__prompt_kernel:
s_cmp_ge_u32 s2, 256
s_cbranch_scc1 L_end
s_load_dwordx2 s[4:5], s[0:1], 0
s_getpc_b64 s[36:37]
L_code_base:
s_mov_b32 s38, L_code_end-L_code_base
s_mov_b32 s39, 0x20000
s_lshr_b32 s66, s2, 3
s_lshl_b32 s3, s66, 11
v_lshlrev_b32 v2, 3, v0
v_lshrrev_b32 v3, 6, v0
buffer_load_dword v11, v2, s[36:39], s3 offen
v_and_b32 v0, 63, v0
v_readfirstlane_b32 s60, v3
s_and_b32 s64, s66, 3
s_lshr_b32 s66, s66, 2
s_and_b32 s61, s2, 4
s_lshl_b32 s61, s61, 1
s_add_u32 s61, s61, s66
s_lshl_b32 s67, s61, 2
s_add_u32 s67, s67, s60
s_mul_i32 s67, s67, 36864
s_mul_i32 s68, s64, 9216
s_add_u32 s68, s68, s67
v_lshlrev_b32 v2, 7, v0
s_mov_b32 s6, 2359296
s_mov_b32 s7, 0x20000
s_load_dwordx16 s[40:55], s[0:1], 0
s_load_dwordx4 s[56:59], s[0:1], 64
s_and_b32 s63, s2, 3
s_lshl_b32 s62, s63, 2
s_add_u32 s62, s62, s64
s_lshr_b32 s65, s60, 1
s_and_b32 s66, s60, 1
v_lshrrev_b32 v4, 3, v0
v_mul_u32_u24 v4, 1152, v4
v_and_b32 v5, 7, v0
v_lshl_add_u32 v255, v5, 4, v4
s_and_b32 s71, s61, 7
s_add_u32 s68, s64, 0
s_and_b32 s68, s68, 3
s_mul_i32 s68, s68, 9216
s_add_u32 s68, s68, s67
v_add_u32 v254, s68, v255
s_lshl_b32 s78, s71, 7
s_waitcnt lgkmcnt(0)
buffer_load_dwordx4 v[20:23], v254, s[4:7], s78 offen
s_add_u32 s79, s78, 128
s_sub_u32 s68, s79, 1152
s_min_u32 s79, s79, s68
buffer_load_dwordx4 v[24:27], v254, s[4:7], s79 offen
s_add_u32 s80, s79, 128
s_sub_u32 s68, s80, 1152
s_min_u32 s80, s80, s68
buffer_load_dwordx4 v[28:31], v254, s[4:7], s80 offen
s_add_u32 s81, s80, 128
s_sub_u32 s68, s81, 1152
s_min_u32 s81, s81, s68
buffer_load_dwordx4 v[32:35], v254, s[4:7], s81 offen
s_add_u32 s82, s81, 128
s_sub_u32 s68, s82, 1152
s_min_u32 s82, s82, s68
buffer_load_dwordx4 v[36:39], v254, s[4:7], s82 offen
s_add_u32 s83, s82, 128
s_sub_u32 s68, s83, 1152
s_min_u32 s83, s83, s68
buffer_load_dwordx4 v[52:55], v254, s[4:7], s83 offen
s_add_u32 s84, s83, 128
s_sub_u32 s68, s84, 1152
s_min_u32 s84, s84, s68
buffer_load_dwordx4 v[56:59], v254, s[4:7], s84 offen
s_add_u32 s85, s84, 128
s_sub_u32 s68, s85, 1152
s_min_u32 s85, s85, s68
buffer_load_dwordx4 v[60:63], v254, s[4:7], s85 offen
s_add_u32 s86, s85, 128
s_sub_u32 s68, s86, 1152
s_min_u32 s86, s86, s68
buffer_load_dwordx4 v[64:67], v254, s[4:7], s86 offen
s_mov_b32 s8, s42
s_mov_b32 s9, s43
s_mov_b32 s10, 1990656
s_mov_b32 s11, 0x20000
s_mov_b32 s24, s54
s_mov_b32 s25, s55
s_mov_b32 s26, 2359296
s_mov_b32 s27, 0x20000
s_mov_b32 s28, s56
s_mov_b32 s29, s57
s_mov_b32 s30, 256
s_mov_b32 s31, 0x20000
s_mov_b32 s32, s58
s_mov_b32 s33, s59
s_mov_b32 s34, 268435456
s_mov_b32 s35, 0x20000
s_cmp_eq_u32 s65, 0
s_cselect_b32 s16, s48, s50
s_cselect_b32 s17, s49, s51
s_mov_b32 s18, 5308416
s_mov_b32 s19, 0x20000
s_cmp_lt_u32 s61, 12
s_cselect_b32 s12, s52, s44
s_cselect_b32 s13, s53, s45
s_mov_b32 s46, 663552
s_cselect_b32 s14, 5308416, s46
s_mov_b32 s15, 0x20000
s_cmp_eq_u32 s60, 0
s_cselect_b64 s[52:53], -1, 0
s_mov_b32 s90, 0xbfb8aa3b
s_mov_b32 s91, 0x3f317218
s_mov_b32 s92, 0x35c1a2a0
s_mov_b32 s99, 0xb5c1a2a0
s_mov_b32 s93, 0xffff0000
s_mov_b32 s94, 0x3f803f80
s_lshl_b32 s46, s61, 4
s_add_u32 s46, s46, s62
s_lshl_b32 s77, s46, 7
s_lshl_b32 s47, s60, 2
s_add_u32 s77, s77, s47
s_add_u32 s77, s77, 24903680
v_lshlrev_b32 v1, 4, v0
v_lshlrev_b32 v10, 2, v0
v_mov_b32 v6, 2147483648
v_cmp_eq_u32 vcc, 0, v0
s_nop 1
v_cndmask_b32 v13, v6, v10, vcc
v_mov_b32 v12, 0
s_lshl_b32 s72, s60, 10
s_mul_i32 s49, s62, 72
s_add_u32 s48, s61, s60
s_and_b32 s48, s48, 1
s_lshl_b32 s48, s48, 2
v_lshrrev_b32 v4, 4, v0
v_add_u32 v5, s48, v4
v_lshlrev_b32 v5, 1, v5
v_sub_u32 v5, v0, v5
v_and_b32 v5, 15, v5
v_min_u32 v5, 14, v5
v_mul_u32_u24 v6, 52, v5
v_lshrrev_b32 v6, 8, v6
v_mul_u32_u24 v7, 5, v6
v_sub_u32 v7, v5, v7
v_add_u32 v8, 1, v6
v_cmp_eq_u32 vcc, 2, v6
s_nop 1
v_cndmask_b32 v8, v8, v12, vcc
v_mul_u32_u24 v8, 1152, v8
v_lshl_add_u32 v8, v7, 4, v8
v_mul_u32_u24 v4, 3456, v4
v_add3_u32 v253, v4, v8, s49
v_lshrrev_b32 v206, 4, v0
v_bfe_u32 v207, v0, 2, 2
v_and_b32 v208, 3, v0
v_and_b32 v209, 15, v0
s_and_b32 s48, s62, 1
s_mul_i32 s70, s62, 576
s_lshl_b32 s49, s48, 6
s_add_u32 s50, s70, s49
s_xor_b32 s48, s48, 1
s_lshl_b32 s48, s48, 9
s_add_u32 s70, s70, s48
s_mul_i32 s76, s60, 9216
v_lshrrev_b32 v200, 5, v0
v_lshlrev_b32 v200, 3, v200
v_bfe_u32 v201, v0, 3, 2
s_lshl_b32 s48, s66, 4
v_add3_u32 v200, v200, v201, s48
v_mul_u32_u24 v200, 9216, v200
v_lshlrev_b32 v201, 1, v206
v_xor_b32 v201, v201, v0
v_and_b32 v201, 7, v201
v_lshl_add_u32 v2, v201, 4, v200
v_add_u32 v2, s50, v2
v_lshrrev_b32 v200, 2, v0
v_lshlrev_b32 v200, 7, v200
v_bfe_u32 v201, v0, 3, 2
v_xor_b32 v201, s66, v201
v_lshl_add_u32 v200, v201, 5, v200
v_lshl_add_u32 v4, v208, 3, v200
v_xor_b32 v5, 64, v4
v_add_u32 v6, 49152, v4
v_add_u32 v7, 49152, v5
s_lshl_b32 s48, s66, 2
v_lshlrev_b32 v200, 3, v206
v_add3_u32 v200, v200, v207, s48
v_mul_u32_u24 v200, 9216, v200
v_and_b32 v201, 1, v206
v_lshlrev_b32 v202, 1, v201
v_xor_b32 v202, v202, v208
v_lshl_add_u32 v200, v202, 4, v200
v_add_u32 v3, s70, v200
v_lshrrev_b32 v200, 2, v0
v_lshlrev_b32 v200, 6, v200
v_xor_b32 v202, s66, v201
v_lshl_add_u32 v200, v202, 5, v200
v_lshl_add_u32 v8, v208, 3, v200
v_add_u32 v9, 36864, v8
v_and_b32 v201, 1, v206
v_lshl_add_u32 v202, v201, 2, v207
v_lshlrev_b32 v202, 5, v202
v_lshrrev_b32 v200, 2, v0
v_lshlrev_b32 v200, 8, v200
v_add_u32 v200, 57344, v200
s_mul_i32 s48, s66, 40
v_lshl_add_u32 v203, v208, 3, v202
v_add_u32 v203, s48, v203
v_add_u32 v204, 0, v203
v_and_b32 v204, 0xff, v204
v_add_u32 v220, v204, v200
v_add_u32 v204, 80, v203
v_and_b32 v204, 0xff, v204
v_add_u32 v221, v204, v200
v_add_u32 v204, 160, v203
v_and_b32 v204, 0xff, v204
v_add_u32 v222, v204, v200
v_min_u32 v204, 2, v208
v_mul_u32_u24 v204, 80, v204
v_add3_u32 v204, v204, 32, v202
v_and_b32 v204, 0xff, v204
v_add_u32 v223, v204, v200
s_lshl_b32 s40, s60, 12
s_add_u32 s40, s40, 147456
v_mul_u32_u24 v204, 136, v208
v_lshl_add_u32 v204, v206, 3, v204
v_mov_b32 v205, 544
v_cmp_eq_u32 vcc, 2, v207
s_nop 1
v_cndmask_b32 v204, v205, v204, vcc
s_add_u32 s48, s40, 3072
v_add_u32 v16, s48, v204
v_mul_u32_u24 v204, 136, v207
v_lshl_add_u32 v204, v208, 3, v204
v_add_u32 v17, s48, v204
s_lshl_b32 s48, s61, 2
s_and_b32 s48, s48, 28
s_add_u32 s48, s48, s60
s_mov_b32 s1, s48
s_lshl_b32 s95, s48, 7
s_mul_i32 s48, s61, 144
s_mul_i32 s49, s62, 9
s_add_u32 s73, s48, s49
s_lshl_b32 s73, s73, 13
s_lshl_b32 s49, s65, 12
s_mul_i32 s2, s66, 3072
s_add_u32 s49, s49, s2
s_mul_i32 s2, s66, 10240
s_add_u32 s2, s2, s73
s_add_u32 s73, s73, s49
s_lshl_b32 s49, s65, 12
s_add_u32 s2, s2, s49
s_mul_i32 s49, s63, 36
s_add_u32 s51, s48, s49
s_lshl_b32 s51, s51, 13
s_lshl_b32 s49, s60, 11
s_add_u32 s51, s51, s49
s_add_u32 s49, s64, 0
s_and_b32 s49, s49, 3
s_mul_i32 s49, s49, 73728
s_add_u32 s54, s51, s49
s_add_u32 s49, s64, 1
s_and_b32 s49, s49, 3
s_mul_i32 s49, s49, 73728
s_add_u32 s55, s51, s49
s_add_u32 s49, s64, 2
s_and_b32 s49, s49, 3
s_mul_i32 s49, s49, 73728
s_add_u32 s59, s51, s49
s_add_u32 s49, s64, 3
s_and_b32 s49, s49, 3
s_mul_i32 s49, s49, 73728
s_add_u32 s3, s51, s49
s_lshl_b32 s48, s61, 1
s_add_u32 s48, s48, s65
s_lshl_b32 s48, s48, 1
s_add_u32 s48, s48, s66
s_mul_i32 s48, s48, 36864
s_add_u32 s48, s48, 19922944
s_lshl_b32 s49, s62, 1
s_add_u32 s49, s49, s66
s_lshl_b32 s41, s49, 10
s_add_u32 s41, s41, s48
s_lshl_b32 s42, s62, 8
s_lshl_b32 s50, s66, 3
s_add_u32 s42, s42, s50
s_add_u32 s42, s42, s48
s_add_u32 s42, s42, 32768
s_mul_i32 s49, s49, 32768
s_add_u32 s49, s49, 23068672
s_mul_i32 s22, s61, 2048
s_add_u32 s22, s22, s49
s_mul_i32 s23, s65, 16384
s_add_u32 s23, s23, s49
s_mul_i32 s50, s62, 331776
s_add_u32 s50, s50, 35651584
s_add_u32 s75, s50, s76
s_lshl_b32 s48, s61, 2
s_add_u32 s48, s48, s64
s_lshl_b32 s48, s48, 2
s_add_u32 s43, s48, s60
s_lshl_b32 s43, s43, 2
s_add_u32 s43, s43, s63
s_mul_i32 s43, s43, 9216
s_add_u32 s43, s43, 25165824
s_cmp_eq_u32 s60, s63
s_cselect_b32 s43, 2147483648, s43
s_add_u32 s44, s48, s63
s_mul_i32 s44, s44, 36864
s_lshl_b32 s51, s60, 1
s_add_u32 s51, s51, 1
s_cmp_eq_u32 s60, 0
s_cselect_b32 s51, 0, s51
s_lshl_b32 s48, s51, 10
s_mul_i32 s98, s64, 165888
s_add_u32 s98, s98, 41943040
s_add_u32 s98, s98, s48
s_add_u32 s44, s44, s48
s_add_u32 s44, s44, 25165824
s_mul_i32 s49, s64, 288
s_lshl_b32 s48, s61, 2
s_add_u32 s48, s48, s63
s_mul_i32 s45, s48, 36864
s_add_u32 s45, s45, s49
s_lshl_b32 s51, s51, 5
s_add_u32 s45, s45, s51
s_mul_i32 s48, s48, 36864
s_add_u32 s48, s48, 19922944
s_add_u32 s97, s48, s76
s_lshl_b32 s56, s61, 11
s_add_u32 s56, s56, 24903680
s_lshl_b32 s74, s63, 9
s_add_u32 s74, s74, s56
s_lshl_b32 s57, s62, 7
s_add_u32 s57, s57, 24903680
s_lshl_b32 s58, s64, 7
s_add_u32 s58, s58, s56
s_lshl_b32 s48, s63, 2
s_add_u32 s58, s58, s48
s_mul_i32 s47, s61, 3
s_add_u32 s47, s47, s60
s_mul_i32 s21, s47, 9216
s_add_u32 s21, s21, s50
s_add_u32 s50, s47, s64
s_and_b32 s50, s50, 3
s_add_u32 s48, s48, s50
s_mul_i32 s48, s48, 288
s_and_b32 s50, s50, 1
s_lshl_b32 s46, s50, 5
s_lshr_b32 s0, s47, 2
s_sub_u32 s51, s0, 1
s_cmp_lt_u32 s0, 2
s_cselect_b32 s51, s0, s51
s_and_b32 s20, s51, 1
s_lshl_b32 s20, s20, 4
s_add_u32 s46, s46, s20
s_lshr_b32 s51, s51, 1
s_lshl_b32 s51, s51, 6
s_add_u32 s46, s46, s51
s_xor_b32 s50, s50, 1
s_lshl_b32 s50, s50, 8
s_cmp_eq_u32 s0, 2
s_cselect_b32 s50, s50, s46
s_cselect_b32 s46, 0, 16
s_add_u32 s48, s48, s50
s_sub_u32 s0, s47, 36
s_lshl_b32 s0, s0, 2
s_add_u32 s0, s0, s63
s_mul_i32 s50, s64, 18
s_add_u32 s50, s50, s0
s_mul_i32 s50, s50, 9216
s_add_u32 s50, s50, 41943040
s_mul_i32 s51, s0, 36
s_cmp_lt_u32 s47, 36
s_cselect_b32 s21, s21, s50
s_cselect_b32 s48, s48, s51
s_cselect_b32 s51, s46, 4
s_cselect_b32 s0, 0, s0
s_sub_u32 s50, s0, 16
s_mul_i32 s50, s50, 288
s_add_u32 s50, s50, 16
s_cmp_lt_u32 s0, 16
s_cselect_b32 s48, s48, s50
s_cselect_b32 s51, s51, 0
s_cselect_b32 s50, 0, 32
s_mul_i32 s20, s48, 1152
s_add_u32 s20, s20, s49
s_cmp_lt_u32 s0, 18
s_cselect_b32 s20, s20, 2147483648
s_cselect_b32 s21, s21, 2147483648
s_cmp_lt_u32 s60, 3
s_cselect_b32 s20, s20, 2147483648
s_cselect_b32 s21, s21, 2147483648
v_add_u32 v200, 0, v0
v_mul_u32_u24 v201, 10923, v200
v_lshrrev_b32 v201, 16, v201
v_mul_u32_u24 v202, 6, v201
v_sub_u32 v202, v200, v202
v_lshrrev_b32 v203, 4, v201
v_mad_u32_u24 v203, v203, s51, v201
v_lshrrev_b32 v204, 2, v201
v_mad_u32_u24 v203, v204, s50, v203
v_mul_u32_u24 v203, 1152, v203
v_lshl_add_u32 v164, v202, 4, v203
v_add_u32 v200, 64, v0
v_mul_u32_u24 v201, 10923, v200
v_lshrrev_b32 v201, 16, v201
v_mul_u32_u24 v202, 6, v201
v_sub_u32 v202, v200, v202
v_lshrrev_b32 v203, 4, v201
v_mad_u32_u24 v203, v203, s51, v201
v_lshrrev_b32 v204, 2, v201
v_mad_u32_u24 v203, v204, s50, v203
v_mul_u32_u24 v203, 1152, v203
v_lshl_add_u32 v165, v202, 4, v203
v_add_u32 v200, 128, v0
v_mul_u32_u24 v201, 10923, v200
v_lshrrev_b32 v201, 16, v201
v_mul_u32_u24 v202, 6, v201
v_sub_u32 v202, v200, v202
v_lshrrev_b32 v203, 4, v201
v_mad_u32_u24 v203, v203, s51, v201
v_lshrrev_b32 v204, 2, v201
v_mad_u32_u24 v203, v204, s50, v203
v_mul_u32_u24 v203, 1152, v203
v_lshl_add_u32 v166, v202, 4, v203
s_mul_i32 s47, s61, 9
s_add_u32 s47, s47, s60
s_lshl_b32 s51, s47, 10
s_mul_i32 s50, s62, 147456
s_add_u32 s50, s50, 45088768
s_add_u32 s101, s51, s50
s_add_u32 s70, s50, s72
v_mov_b32 v208, s94
s_add_u32 s68, s64, 1
s_and_b32 s68, s68, 3
s_mul_i32 s68, s68, 9216
s_add_u32 s68, s68, s67
v_add_u32 v254, s68, v255
buffer_load_dwordx4 v[40:43], v254, s[4:7], s78 offen
v_and_b32 v212, 7, v0
v_lshrrev_b32 v213, 3, v0
v_xor_b32 v209, v212, v213
v_and_b32 v213, 3, v0
v_lshl_add_u32 v209, v213, 4, v209
v_lshlrev_b32 v209, 4, v209
v_lshrrev_b32 v212, 2, v212
v_lshl_add_u32 v209, v212, 10, v209
s_mul_i32 s48, s60, 20480
s_add_u32 s48, s48, 73728
v_add_u32 v209, s48, v209
s_add_u32 s48, s64, 0
s_and_b32 s49, s48, 1
s_lshl_b32 s49, s49, 7
s_bfe_u32 s48, s48, 0x10001
s_mul_i32 s48, s48, 10240
buffer_load_dwordx4 v[44:47], v254, s[4:7], s79 offen
s_add_u32 s48, s48, s49
v_add_u32 v248, s48, v209
s_add_u32 s48, s64, 1
s_and_b32 s49, s48, 1
s_lshl_b32 s49, s49, 7
s_bfe_u32 s48, s48, 0x10001
s_mul_i32 s48, s48, 10240
s_add_u32 s48, s48, s49
v_add_u32 v249, s48, v209
s_add_u32 s48, s64, 2
s_and_b32 s49, s48, 1
s_lshl_b32 s49, s49, 7
s_bfe_u32 s48, s48, 0x10001
s_mul_i32 s48, s48, 10240
s_add_u32 s48, s48, s49
v_add_u32 v250, s48, v209
buffer_load_dwordx4 v[48:51], v254, s[4:7], s80 offen
s_add_u32 s48, s64, 3
s_and_b32 s49, s48, 1
s_lshl_b32 s49, s49, 7
s_bfe_u32 s48, s48, 0x10001
s_mul_i32 s48, s48, 10240
s_add_u32 s48, s48, s49
v_add_u32 v251, s48, v209
v_lshrrev_b32 v212, 4, v0
v_xor_b32 v210, v212, v0
v_lshlrev_b32 v210, 4, v210
v_xor_b32 v211, 64, v210
s_mul_i32 s48, s65, 40960
s_add_u32 s48, s48, 73728
s_mul_i32 s49, s66, 20480
s_sub_u32 s50, s48, s49
s_add_u32 s50, s50, 20480
buffer_load_dwordx4 v[116:119], v254, s[4:7], s81 offen
s_add_u32 s48, s48, s49
v_add_u32 v214, s50, v210
v_add_u32 v215, s50, v211
v_add_u32 v210, s48, v210
v_add_u32 v211, s48, v211
s_waitcnt vmcnt(12)
v_dot2_f32_bf16 v200, v208, v20, 0
buffer_load_dwordx4 v[120:123], v254, s[4:7], s82 offen
v_dot2_f32_bf16 v202, v20, v20, 0
v_dot2_f32_bf16 v201, v208, v21, 0
v_dot2_f32_bf16 v203, v21, v21, 0
v_dot2c_f32_bf16 v200, v208, v22
v_dot2c_f32_bf16 v202, v22, v22
v_dot2c_f32_bf16 v201, v208, v23
v_dot2c_f32_bf16 v203, v23, v23
s_waitcnt vmcnt(12)
v_dot2c_f32_bf16 v200, v208, v24
v_dot2c_f32_bf16 v202, v24, v24
v_dot2c_f32_bf16 v201, v208, v25
v_dot2c_f32_bf16 v203, v25, v25
buffer_load_dwordx4 v[68:71], v254, s[4:7], s83 offen
v_dot2c_f32_bf16 v200, v208, v26
v_dot2c_f32_bf16 v202, v26, v26
v_dot2c_f32_bf16 v201, v208, v27
v_dot2c_f32_bf16 v203, v27, v27
s_waitcnt vmcnt(12)
v_dot2c_f32_bf16 v200, v208, v28
v_dot2c_f32_bf16 v202, v28, v28
v_dot2c_f32_bf16 v201, v208, v29
v_dot2c_f32_bf16 v203, v29, v29
v_dot2c_f32_bf16 v200, v208, v30
v_dot2c_f32_bf16 v202, v30, v30
v_dot2c_f32_bf16 v201, v208, v31
buffer_load_dwordx4 v[72:75], v254, s[4:7], s84 offen
v_dot2c_f32_bf16 v203, v31, v31
s_waitcnt vmcnt(12)
v_dot2c_f32_bf16 v200, v208, v32
v_dot2c_f32_bf16 v202, v32, v32
v_dot2c_f32_bf16 v201, v208, v33
v_dot2c_f32_bf16 v203, v33, v33
v_dot2c_f32_bf16 v200, v208, v34
v_dot2c_f32_bf16 v202, v34, v34
v_dot2c_f32_bf16 v201, v208, v35
v_dot2c_f32_bf16 v203, v35, v35
s_waitcnt vmcnt(11)
v_dot2c_f32_bf16 v200, v208, v36
v_dot2c_f32_bf16 v202, v36, v36
buffer_load_dwordx4 v[76:79], v254, s[4:7], s85 offen
v_dot2c_f32_bf16 v201, v208, v37
v_dot2c_f32_bf16 v203, v37, v37
v_dot2c_f32_bf16 v200, v208, v38
v_dot2c_f32_bf16 v202, v38, v38
v_dot2c_f32_bf16 v201, v208, v39
v_dot2c_f32_bf16 v203, v39, v39
s_waitcnt vmcnt(11)
v_dot2c_f32_bf16 v200, v208, v52
v_dot2c_f32_bf16 v202, v52, v52
v_dot2c_f32_bf16 v201, v208, v53
v_dot2c_f32_bf16 v203, v53, v53
v_dot2c_f32_bf16 v200, v208, v54
buffer_load_dwordx4 v[80:83], v254, s[4:7], s86 offen
v_dot2c_f32_bf16 v202, v54, v54
v_dot2c_f32_bf16 v201, v208, v55
v_dot2c_f32_bf16 v203, v55, v55
s_waitcnt vmcnt(11)
v_dot2c_f32_bf16 v200, v208, v56
v_dot2c_f32_bf16 v202, v56, v56
v_dot2c_f32_bf16 v201, v208, v57
v_dot2c_f32_bf16 v203, v57, v57
v_dot2c_f32_bf16 v200, v208, v58
v_dot2c_f32_bf16 v202, v58, v58
v_dot2c_f32_bf16 v201, v208, v59
v_dot2c_f32_bf16 v203, v59, v59
s_add_u32 s68, s64, 2
s_and_b32 s68, s68, 3
s_mul_i32 s68, s68, 9216
s_add_u32 s68, s68, s67
v_add_u32 v254, s68, v255
buffer_load_dwordx4 v[124:127], v254, s[4:7], s78 offen
s_waitcnt vmcnt(11)
v_dot2c_f32_bf16 v200, v208, v60
v_dot2c_f32_bf16 v202, v60, v60
v_dot2c_f32_bf16 v201, v208, v61
v_dot2c_f32_bf16 v203, v61, v61
v_dot2c_f32_bf16 v200, v208, v62
v_dot2c_f32_bf16 v202, v62, v62
v_dot2c_f32_bf16 v201, v208, v63
v_dot2c_f32_bf16 v203, v63, v63
s_waitcnt vmcnt(10)
v_dot2c_f32_bf16 v200, v208, v64
v_dot2c_f32_bf16 v202, v64, v64
v_dot2c_f32_bf16 v201, v208, v65
buffer_load_dwordx4 v[128:131], v254, s[4:7], s79 offen
v_dot2c_f32_bf16 v203, v65, v65
v_dot2c_f32_bf16 v200, v208, v66
v_dot2c_f32_bf16 v202, v66, v66
v_dot2c_f32_bf16 v201, v208, v67
v_dot2c_f32_bf16 v203, v67, v67
s_nop 1
v_add_f32 v200, v200, v201
v_add_f32 v202, v202, v203
s_nop 0
v_add_f32_dpp v200, v200, v200 quad_perm:[1,0,3,2] row_mask:0xf bank_mask:0xf
v_add_f32_dpp v202, v202, v202 quad_perm:[1,0,3,2] row_mask:0xf bank_mask:0xf
s_nop 0
v_add_f32_dpp v200, v200, v200 quad_perm:[2,3,0,1] row_mask:0xf bank_mask:0xf
v_add_f32_dpp v202, v202, v202 quad_perm:[2,3,0,1] row_mask:0xf bank_mask:0xf
buffer_load_dwordx4 v[132:135], v254, s[4:7], s80 offen
v_add_f32_dpp v200, v200, v200 row_half_mirror row_mask:0xf bank_mask:0xf
v_add_f32_dpp v202, v202, v202 row_half_mirror row_mask:0xf bank_mask:0xf
v_mul_f32 v200, 0x3ae38e39, v200
v_mul_f32 v202, 0x3ae38e39, v202
v_fma_f32 v202, -v200, v200, v202
v_max_f32 v202, 0, v202
v_cvt_pk_bf16_f32 v200, v200, v202
v_and_b32 v202, s93, v200
v_lshlrev_b32 v200, 16, v200
v_add_f32 v202, 0x3727c5ac, v202
v_cvt_pk_bf16_f32 v202, v202, v202
buffer_load_dwordx4 v[136:139], v254, s[4:7], s81 offen
v_and_b32 v202, s93, v202
v_sqrt_f32 v202, v202
s_nop 0
v_cvt_pk_bf16_f32 v202, v202, v202
v_and_b32 v202, s93, v202
v_rcp_f32 v202, v202
s_nop 0
v_mul_f32 v202, s90, v202
v_cvt_pk_bf16_f32 v202, v202, v202
v_and_b32 v185, s93, v202
v_lshrrev_b32 v184, 16, v202
v_mul_f32 v186, -v200, v185
v_dot2_f32_bf16 v168, v20, v184, v186
buffer_load_dwordx4 v[140:143], v254, s[4:7], s82 offen
v_dot2_f32_bf16 v169, v20, v185, v186
v_dot2_f32_bf16 v170, v21, v184, v186
v_dot2_f32_bf16 v171, v21, v185, v186
v_dot2_f32_bf16 v172, v22, v184, v186
v_dot2_f32_bf16 v173, v22, v185, v186
v_dot2_f32_bf16 v174, v23, v184, v186
v_dot2_f32_bf16 v175, v23, v185, v186
v_cvt_pk_bf16_f32 v20, v168, v169
v_cvt_pk_bf16_f32 v21, v170, v171
v_cvt_pk_bf16_f32 v22, v172, v173
v_cvt_pk_bf16_f32 v23, v174, v175
buffer_load_dwordx4 v[84:87], v254, s[4:7], s83 offen
ds_write_b128 v248, v[20:23] offset:0
s_waitcnt vmcnt(14)
v_dot2_f32_bf16 v204, v208, v40, 0
v_dot2_f32_bf16 v206, v40, v40, 0
v_dot2_f32_bf16 v205, v208, v41, 0
v_dot2_f32_bf16 v207, v41, v41, 0
v_dot2c_f32_bf16 v204, v208, v42
v_dot2c_f32_bf16 v206, v42, v42
v_dot2c_f32_bf16 v205, v208, v43
v_dot2c_f32_bf16 v207, v43, v43
s_waitcnt vmcnt(13)
v_dot2c_f32_bf16 v204, v208, v44
v_dot2c_f32_bf16 v206, v44, v44
v_dot2c_f32_bf16 v205, v208, v45
buffer_load_dwordx4 v[88:91], v254, s[4:7], s84 offen
v_dot2c_f32_bf16 v207, v45, v45
v_dot2c_f32_bf16 v204, v208, v46
v_dot2c_f32_bf16 v206, v46, v46
v_dot2c_f32_bf16 v205, v208, v47
v_dot2c_f32_bf16 v207, v47, v47
s_waitcnt vmcnt(13)
v_dot2c_f32_bf16 v204, v208, v48
v_dot2c_f32_bf16 v206, v48, v48
v_dot2c_f32_bf16 v205, v208, v49
v_dot2_f32_bf16 v176, v24, v184, v186
v_dot2_f32_bf16 v177, v24, v185, v186
v_dot2_f32_bf16 v178, v25, v184, v186
buffer_load_dwordx4 v[92:95], v254, s[4:7], s85 offen
v_dot2_f32_bf16 v179, v25, v185, v186
v_dot2_f32_bf16 v180, v26, v184, v186
v_dot2_f32_bf16 v181, v26, v185, v186
v_dot2_f32_bf16 v182, v27, v184, v186
v_dot2_f32_bf16 v183, v27, v185, v186
v_cvt_pk_bf16_f32 v24, v176, v177
v_cvt_pk_bf16_f32 v25, v178, v179
v_cvt_pk_bf16_f32 v26, v180, v181
v_cvt_pk_bf16_f32 v27, v182, v183
ds_write_b128 v248, v[24:27] offset:2048
v_dot2c_f32_bf16 v207, v49, v49
v_dot2c_f32_bf16 v204, v208, v50
buffer_load_dwordx4 v[96:99], v254, s[4:7], s86 offen
v_dot2c_f32_bf16 v206, v50, v50
v_dot2c_f32_bf16 v205, v208, v51
v_dot2c_f32_bf16 v207, v51, v51
s_waitcnt vmcnt(14)
v_dot2c_f32_bf16 v204, v208, v116
v_dot2c_f32_bf16 v206, v116, v116
v_dot2c_f32_bf16 v205, v208, v117
v_dot2c_f32_bf16 v207, v117, v117
v_dot2c_f32_bf16 v204, v208, v118
v_dot2c_f32_bf16 v206, v118, v118
v_dot2c_f32_bf16 v205, v208, v119
v_dot2c_f32_bf16 v207, v119, v119
s_add_u32 s68, s64, 3
s_and_b32 s68, s68, 3
s_mul_i32 s68, s68, 9216
s_add_u32 s68, s68, s67
v_add_u32 v254, s68, v255
buffer_load_dwordx4 v[144:147], v254, s[4:7], s78 offen
s_waitcnt vmcnt(14)
v_dot2c_f32_bf16 v204, v208, v120
v_dot2c_f32_bf16 v206, v120, v120
v_dot2c_f32_bf16 v205, v208, v121
v_dot2c_f32_bf16 v207, v121, v121
v_dot2c_f32_bf16 v204, v208, v122
v_dot2c_f32_bf16 v206, v122, v122
v_dot2c_f32_bf16 v205, v208, v123
v_dot2_f32_bf16 v168, v28, v184, v186
v_dot2_f32_bf16 v169, v28, v185, v186
v_dot2_f32_bf16 v170, v29, v184, v186
v_dot2_f32_bf16 v171, v29, v185, v186
buffer_load_dwordx4 v[148:151], v254, s[4:7], s79 offen
v_dot2_f32_bf16 v172, v30, v184, v186
v_dot2_f32_bf16 v173, v30, v185, v186
v_dot2_f32_bf16 v174, v31, v184, v186
v_dot2_f32_bf16 v175, v31, v185, v186
v_cvt_pk_bf16_f32 v28, v168, v169
v_cvt_pk_bf16_f32 v29, v170, v171
v_cvt_pk_bf16_f32 v30, v172, v173
v_cvt_pk_bf16_f32 v31, v174, v175
ds_write_b128 v248, v[28:31] offset:4096
v_dot2c_f32_bf16 v207, v123, v123
s_waitcnt vmcnt(14)
v_dot2c_f32_bf16 v204, v208, v68
v_dot2c_f32_bf16 v206, v68, v68
buffer_store_dword v12, v13, s[32:35], s77 offen sc1
v_dot2c_f32_bf16 v205, v208, v69
v_dot2c_f32_bf16 v207, v69, v69
v_dot2c_f32_bf16 v204, v208, v70
v_dot2c_f32_bf16 v206, v70, v70
s_add_u32 s48, s47, 0
s_lshr_b32 s49, s48, 3
s_lshl_b32 s49, s49, 5
s_and_b32 s50, s48, 3
s_lshl_b32 s50, s50, 3
s_add_u32 s49, s49, s50
s_and_b32 s50, s48, 4
s_add_u32 s49, s49, s50
s_mul_i32 s49, s49, 3456
buffer_load_dwordx4 v[236:239], v253, s[8:11], s49 offen
v_dot2c_f32_bf16 v205, v208, v71
v_dot2c_f32_bf16 v207, v71, v71
s_waitcnt vmcnt(15)
v_dot2c_f32_bf16 v204, v208, v72
v_dot2c_f32_bf16 v206, v72, v72
v_dot2c_f32_bf16 v205, v208, v73
v_dot2c_f32_bf16 v207, v73, v73
v_dot2c_f32_bf16 v204, v208, v74
v_dot2c_f32_bf16 v206, v74, v74
v_dot2c_f32_bf16 v205, v208, v75
v_dot2c_f32_bf16 v207, v75, v75
s_waitcnt vmcnt(14)
v_dot2c_f32_bf16 v204, v208, v76
v_dot2c_f32_bf16 v206, v76, v76
v_dot2_f32_bf16 v176, v32, v184, v186
v_dot2_f32_bf16 v177, v32, v185, v186
v_dot2_f32_bf16 v178, v33, v184, v186
v_dot2_f32_bf16 v179, v33, v185, v186
v_dot2_f32_bf16 v180, v34, v184, v186
v_dot2_f32_bf16 v181, v34, v185, v186
v_dot2_f32_bf16 v182, v35, v184, v186
v_dot2_f32_bf16 v183, v35, v185, v186
v_cvt_pk_bf16_f32 v32, v176, v177
v_cvt_pk_bf16_f32 v33, v178, v179
v_cvt_pk_bf16_f32 v34, v180, v181
v_cvt_pk_bf16_f32 v35, v182, v183
ds_write_b128 v248, v[32:35] offset:6144
v_dot2c_f32_bf16 v205, v208, v77
v_dot2c_f32_bf16 v207, v77, v77
v_dot2c_f32_bf16 v204, v208, v78
v_dot2c_f32_bf16 v206, v78, v78
v_dot2c_f32_bf16 v205, v208, v79
v_dot2c_f32_bf16 v207, v79, v79
s_waitcnt vmcnt(13)
v_dot2c_f32_bf16 v204, v208, v80
v_dot2c_f32_bf16 v206, v80, v80
s_add_u32 s48, s47, 4
s_lshr_b32 s49, s48, 3
s_lshl_b32 s49, s49, 5
s_and_b32 s50, s48, 3
s_lshl_b32 s50, s50, 3
s_add_u32 s49, s49, s50
s_and_b32 s50, s48, 4
s_add_u32 s49, s49, s50
s_mul_i32 s49, s49, 3456
buffer_load_dwordx4 v[240:243], v253, s[8:11], s49 offen
v_dot2c_f32_bf16 v205, v208, v81
v_dot2c_f32_bf16 v207, v81, v81
v_dot2c_f32_bf16 v204, v208, v82
v_dot2c_f32_bf16 v206, v82, v82
v_dot2c_f32_bf16 v205, v208, v83
v_dot2c_f32_bf16 v207, v83, v83
s_nop 1
v_add_f32 v204, v204, v205
v_add_f32 v206, v206, v207
s_nop 0
v_add_f32_dpp v204, v204, v204 quad_perm:[1,0,3,2] row_mask:0xf bank_mask:0xf
v_add_f32_dpp v206, v206, v206 quad_perm:[1,0,3,2] row_mask:0xf bank_mask:0xf
s_nop 0
v_add_f32_dpp v204, v204, v204 quad_perm:[2,3,0,1] row_mask:0xf bank_mask:0xf
v_add_f32_dpp v206, v206, v206 quad_perm:[2,3,0,1] row_mask:0xf bank_mask:0xf
s_nop 0
v_add_f32_dpp v204, v204, v204 row_half_mirror row_mask:0xf bank_mask:0xf
v_dot2_f32_bf16 v168, v36, v184, v186
v_dot2_f32_bf16 v169, v36, v185, v186
v_dot2_f32_bf16 v170, v37, v184, v186
v_dot2_f32_bf16 v171, v37, v185, v186
v_dot2_f32_bf16 v172, v38, v184, v186
v_dot2_f32_bf16 v173, v38, v185, v186
v_dot2_f32_bf16 v174, v39, v184, v186
v_dot2_f32_bf16 v175, v39, v185, v186
v_cvt_pk_bf16_f32 v36, v168, v169
v_cvt_pk_bf16_f32 v37, v170, v171
v_cvt_pk_bf16_f32 v38, v172, v173
v_cvt_pk_bf16_f32 v39, v174, v175
ds_write_b128 v248, v[36:39] offset:8192
v_add_f32_dpp v206, v206, v206 row_half_mirror row_mask:0xf bank_mask:0xf
v_mul_f32 v204, 0x3ae38e39, v204
v_mul_f32 v206, 0x3ae38e39, v206
v_fma_f32 v206, -v204, v204, v206
v_max_f32 v206, 0, v206
v_cvt_pk_bf16_f32 v204, v204, v206
v_and_b32 v206, s93, v204
s_add_u32 s48, s47, 8
s_lshr_b32 s49, s48, 3
s_lshl_b32 s49, s49, 5
s_and_b32 s50, s48, 3
s_lshl_b32 s50, s50, 3
s_add_u32 s49, s49, s50
s_and_b32 s50, s48, 4
s_add_u32 s49, s49, s50
s_mul_i32 s49, s49, 3456
s_cmp_eq_u32 s60, 0
s_cselect_b32 s49, s49, 2147483648
buffer_load_dwordx4 v[244:247], v253, s[8:11], s49 offen
v_lshlrev_b32 v204, 16, v204
v_add_f32 v206, 0x3727c5ac, v206
v_cvt_pk_bf16_f32 v206, v206, v206
v_and_b32 v206, s93, v206
v_sqrt_f32 v206, v206
s_nop 0
v_cvt_pk_bf16_f32 v206, v206, v206
v_and_b32 v206, s93, v206
v_rcp_f32 v206, v206
s_nop 0
v_mul_f32 v206, s90, v206
v_cvt_pk_bf16_f32 v206, v206, v206
v_and_b32 v189, s93, v206
v_lshrrev_b32 v188, 16, v206
v_mul_f32 v190, -v204, v189
s_waitcnt vmcnt(14)
v_dot2_f32_bf16 v200, v208, v124, 0
v_dot2_f32_bf16 v202, v124, v124, 0
v_dot2_f32_bf16 v201, v208, v125, 0
v_dot2_f32_bf16 v203, v125, v125, 0
v_dot2c_f32_bf16 v200, v208, v126
v_dot2c_f32_bf16 v202, v126, v126
v_dot2c_f32_bf16 v201, v208, v127
v_dot2c_f32_bf16 v203, v127, v127
s_waitcnt vmcnt(13)
v_dot2c_f32_bf16 v200, v208, v128
v_dot2c_f32_bf16 v202, v128, v128
v_dot2c_f32_bf16 v201, v208, v129
v_dot2c_f32_bf16 v203, v129, v129
v_dot2c_f32_bf16 v200, v208, v130
v_dot2c_f32_bf16 v202, v130, v130
v_dot2c_f32_bf16 v201, v208, v131
v_dot2_f32_bf16 v176, v40, v188, v190
v_dot2_f32_bf16 v177, v40, v189, v190
v_dot2_f32_bf16 v178, v41, v188, v190
v_dot2_f32_bf16 v179, v41, v189, v190
buffer_load_dwordx4 v[152:155], v254, s[4:7], s80 offen
v_dot2_f32_bf16 v180, v42, v188, v190
v_dot2_f32_bf16 v181, v42, v189, v190
v_dot2_f32_bf16 v182, v43, v188, v190
v_dot2_f32_bf16 v183, v43, v189, v190
v_cvt_pk_bf16_f32 v40, v176, v177
v_cvt_pk_bf16_f32 v41, v178, v179
v_cvt_pk_bf16_f32 v42, v180, v181
v_cvt_pk_bf16_f32 v43, v182, v183
ds_write_b128 v249, v[40:43] offset:0
v_dot2c_f32_bf16 v203, v131, v131
s_waitcnt vmcnt(13)
v_dot2c_f32_bf16 v200, v208, v132
v_dot2c_f32_bf16 v202, v132, v132
buffer_load_dwordx4 v[156:159], v254, s[4:7], s81 offen
v_dot2c_f32_bf16 v201, v208, v133
v_dot2c_f32_bf16 v203, v133, v133
v_dot2c_f32_bf16 v200, v208, v134
v_dot2c_f32_bf16 v202, v134, v134
v_dot2c_f32_bf16 v201, v208, v135
v_dot2c_f32_bf16 v203, v135, v135
s_waitcnt vmcnt(13)
v_dot2c_f32_bf16 v200, v208, v136
v_dot2c_f32_bf16 v202, v136, v136
v_dot2c_f32_bf16 v201, v208, v137
v_dot2c_f32_bf16 v203, v137, v137
v_dot2c_f32_bf16 v200, v208, v138
buffer_load_dwordx4 v[160:163], v254, s[4:7], s82 offen
v_dot2c_f32_bf16 v202, v138, v138
v_dot2_f32_bf16 v168, v44, v188, v190
v_dot2_f32_bf16 v169, v44, v189, v190
v_dot2_f32_bf16 v170, v45, v188, v190
v_dot2_f32_bf16 v171, v45, v189, v190
v_dot2_f32_bf16 v172, v46, v188, v190
v_dot2_f32_bf16 v173, v46, v189, v190
v_dot2_f32_bf16 v174, v47, v188, v190
v_dot2_f32_bf16 v175, v47, v189, v190
v_cvt_pk_bf16_f32 v44, v168, v169
v_cvt_pk_bf16_f32 v45, v170, v171
buffer_load_dwordx4 v[100:103], v254, s[4:7], s83 offen
v_cvt_pk_bf16_f32 v46, v172, v173
v_cvt_pk_bf16_f32 v47, v174, v175
ds_write_b128 v249, v[44:47] offset:2048
v_dot2c_f32_bf16 v201, v208, v139
v_dot2c_f32_bf16 v203, v139, v139
s_waitcnt vmcnt(14)
v_dot2c_f32_bf16 v200, v208, v140
v_dot2c_f32_bf16 v202, v140, v140
v_dot2c_f32_bf16 v201, v208, v141
v_dot2c_f32_bf16 v203, v141, v141
v_dot2c_f32_bf16 v200, v208, v142
v_dot2c_f32_bf16 v202, v142, v142
v_dot2c_f32_bf16 v201, v208, v143
buffer_load_dwordx4 v[104:107], v254, s[4:7], s84 offen
v_dot2c_f32_bf16 v203, v143, v143
s_waitcnt vmcnt(14)
v_dot2c_f32_bf16 v200, v208, v84
v_dot2c_f32_bf16 v202, v84, v84
v_dot2c_f32_bf16 v201, v208, v85
v_dot2c_f32_bf16 v203, v85, v85
v_dot2c_f32_bf16 v200, v208, v86
v_dot2_f32_bf16 v176, v48, v188, v190
v_dot2_f32_bf16 v177, v48, v189, v190
v_dot2_f32_bf16 v178, v49, v188, v190
v_dot2_f32_bf16 v179, v49, v189, v190
v_dot2_f32_bf16 v180, v50, v188, v190
buffer_load_dwordx4 v[108:111], v254, s[4:7], s85 offen
v_dot2_f32_bf16 v181, v50, v189, v190
v_dot2_f32_bf16 v182, v51, v188, v190
v_dot2_f32_bf16 v183, v51, v189, v190
v_cvt_pk_bf16_f32 v48, v176, v177
v_cvt_pk_bf16_f32 v49, v178, v179
v_cvt_pk_bf16_f32 v50, v180, v181
v_cvt_pk_bf16_f32 v51, v182, v183
ds_write_b128 v249, v[48:51] offset:4096
v_dot2c_f32_bf16 v202, v86, v86
v_dot2c_f32_bf16 v201, v208, v87
v_dot2c_f32_bf16 v203, v87, v87
s_waitcnt vmcnt(14)
v_dot2c_f32_bf16 v200, v208, v88
buffer_load_dwordx4 v[112:115], v254, s[4:7], s86 offen
v_dot2c_f32_bf16 v202, v88, v88
v_dot2c_f32_bf16 v201, v208, v89
v_dot2c_f32_bf16 v203, v89, v89
v_dot2c_f32_bf16 v200, v208, v90
v_dot2c_f32_bf16 v202, v90, v90
v_dot2c_f32_bf16 v201, v208, v91
v_dot2c_f32_bf16 v203, v91, v91
s_waitcnt vmcnt(14)
v_dot2c_f32_bf16 v200, v208, v92
v_dot2c_f32_bf16 v202, v92, v92
v_dot2c_f32_bf16 v201, v208, v93
v_dot2c_f32_bf16 v203, v93, v93
s_mul_i32 s69, s71, 589824
s_add_u32 m0, s72, 0
s_nop 0
buffer_load_dwordx4 v3, s[16:19], s69 offen  lds
v_dot2_f32_bf16 v168, v116, v188, v190
v_dot2_f32_bf16 v169, v116, v189, v190
v_dot2_f32_bf16 v170, v117, v188, v190
v_dot2_f32_bf16 v171, v117, v189, v190
v_dot2_f32_bf16 v172, v118, v188, v190
v_dot2_f32_bf16 v173, v118, v189, v190
v_dot2_f32_bf16 v174, v119, v188, v190
v_dot2_f32_bf16 v175, v119, v189, v190
v_cvt_pk_bf16_f32 v116, v168, v169
v_cvt_pk_bf16_f32 v117, v170, v171
v_cvt_pk_bf16_f32 v118, v172, v173
v_cvt_pk_bf16_f32 v119, v174, v175
ds_write_b128 v249, v[116:119] offset:6144
v_dot2c_f32_bf16 v200, v208, v94
v_dot2c_f32_bf16 v202, v94, v94
v_dot2c_f32_bf16 v201, v208, v95
v_dot2c_f32_bf16 v203, v95, v95
s_waitcnt vmcnt(14)
v_dot2c_f32_bf16 v200, v208, v96
v_dot2c_f32_bf16 v202, v96, v96
v_dot2c_f32_bf16 v201, v208, v97
v_dot2c_f32_bf16 v203, v97, v97
v_dot2c_f32_bf16 v200, v208, v98
v_dot2c_f32_bf16 v202, v98, v98
v_dot2c_f32_bf16 v201, v208, v99
v_dot2c_f32_bf16 v203, v99, v99
s_nop 1
v_add_f32 v200, v200, v201
v_add_f32 v202, v202, v203
s_nop 0
v_add_f32_dpp v200, v200, v200 quad_perm:[1,0,3,2] row_mask:0xf bank_mask:0xf
v_add_f32_dpp v202, v202, v202 quad_perm:[1,0,3,2] row_mask:0xf bank_mask:0xf
v_dot2_f32_bf16 v176, v120, v188, v190
v_dot2_f32_bf16 v177, v120, v189, v190
v_dot2_f32_bf16 v178, v121, v188, v190
v_dot2_f32_bf16 v179, v121, v189, v190
v_dot2_f32_bf16 v180, v122, v188, v190
v_dot2_f32_bf16 v181, v122, v189, v190
v_dot2_f32_bf16 v182, v123, v188, v190
v_dot2_f32_bf16 v183, v123, v189, v190
v_cvt_pk_bf16_f32 v120, v176, v177
v_cvt_pk_bf16_f32 v121, v178, v179
v_cvt_pk_bf16_f32 v122, v180, v181
v_cvt_pk_bf16_f32 v123, v182, v183
s_add_u32 s69, s69, 294912
s_sub_u32 s0, s69, 5308416
s_min_u32 s69, s69, s0
s_add_u32 m0, s72, 4096
s_nop 0
buffer_load_dwordx4 v3, s[16:19], s69 offen  lds
ds_write_b128 v249, v[120:123] offset:8192
v_add_f32_dpp v200, v200, v200 quad_perm:[2,3,0,1] row_mask:0xf bank_mask:0xf
v_add_f32_dpp v202, v202, v202 quad_perm:[2,3,0,1] row_mask:0xf bank_mask:0xf
s_nop 0
v_add_f32_dpp v200, v200, v200 row_half_mirror row_mask:0xf bank_mask:0xf
v_add_f32_dpp v202, v202, v202 row_half_mirror row_mask:0xf bank_mask:0xf
v_mul_f32 v200, 0x3ae38e39, v200
v_mul_f32 v202, 0x3ae38e39, v202
v_fma_f32 v202, -v200, v200, v202
v_max_f32 v202, 0, v202
v_cvt_pk_bf16_f32 v200, v200, v202
v_and_b32 v202, s93, v200
v_lshlrev_b32 v200, 16, v200
v_add_f32 v202, 0x3727c5ac, v202
v_cvt_pk_bf16_f32 v202, v202, v202
v_and_b32 v202, s93, v202
v_sqrt_f32 v202, v202
s_nop 0
v_cvt_pk_bf16_f32 v202, v202, v202
v_and_b32 v202, s93, v202
v_rcp_f32 v202, v202
s_nop 0
v_mul_f32 v202, s90, v202
v_cvt_pk_bf16_f32 v202, v202, v202
v_and_b32 v193, s93, v202
v_lshrrev_b32 v192, 16, v202
v_mul_f32 v194, -v200, v193
s_waitcnt vmcnt(11)
buffer_store_dwordx4 v[236:239], v1, s[32:35], s101 offen sc1
s_nop 1
s_add_u32 s101, s101, 4096
v_mov_b32 v252, 2147483648
v_cndmask_b32 v253, v252, v1, s[52:53]
v_cndmask_b32 v252, v252, v13, s[52:53]
s_waitcnt vmcnt(11)
buffer_store_dwordx4 v[240:243], v1, s[32:35], s101 offen sc1
s_nop 1
s_add_u32 s101, s101, 4096
s_waitcnt vmcnt(11)
buffer_store_dwordx4 v[244:247], v253, s[32:35], s101 offen sc1
s_nop 1
s_add_u32 s101, s101, 4096
v_dot2_f32_bf16 v204, v208, v144, 0
v_dot2_f32_bf16 v206, v144, v144, 0
v_dot2_f32_bf16 v205, v208, v145, 0
v_dot2_f32_bf16 v207, v145, v145, 0
v_dot2c_f32_bf16 v204, v208, v146
v_dot2c_f32_bf16 v206, v146, v146
v_dot2c_f32_bf16 v205, v208, v147
v_dot2c_f32_bf16 v207, v147, v147
s_add_u32 s69, s69, 294912
s_sub_u32 s0, s69, 5308416
s_min_u32 s69, s69, s0
s_add_u32 m0, s72, 8192
s_nop 0
buffer_load_dwordx4 v3, s[16:19], s69 offen  lds
v_dot2c_f32_bf16 v204, v208, v148
v_dot2c_f32_bf16 v206, v148, v148
v_dot2c_f32_bf16 v205, v208, v149
v_dot2c_f32_bf16 v207, v149, v149
v_dot2c_f32_bf16 v204, v208, v150
v_dot2c_f32_bf16 v206, v150, v150
v_dot2c_f32_bf16 v205, v208, v151
v_dot2_f32_bf16 v168, v124, v192, v194
v_dot2_f32_bf16 v169, v124, v193, v194
v_dot2_f32_bf16 v170, v125, v192, v194
v_dot2_f32_bf16 v171, v125, v193, v194
v_dot2_f32_bf16 v172, v126, v192, v194
v_dot2_f32_bf16 v173, v126, v193, v194
v_dot2_f32_bf16 v174, v127, v192, v194
v_dot2_f32_bf16 v175, v127, v193, v194
v_cvt_pk_bf16_f32 v124, v168, v169
v_cvt_pk_bf16_f32 v125, v170, v171
v_cvt_pk_bf16_f32 v126, v172, v173
v_cvt_pk_bf16_f32 v127, v174, v175
ds_write_b128 v250, v[124:127] offset:0
v_dot2c_f32_bf16 v207, v151, v151
s_waitcnt vmcnt(12)
v_dot2c_f32_bf16 v204, v208, v152
v_dot2c_f32_bf16 v206, v152, v152
v_dot2c_f32_bf16 v205, v208, v153
v_dot2c_f32_bf16 v207, v153, v153
v_dot2c_f32_bf16 v204, v208, v154
v_dot2c_f32_bf16 v206, v154, v154
v_dot2c_f32_bf16 v205, v208, v155
v_dot2c_f32_bf16 v207, v155, v155
s_waitcnt vmcnt(11)
v_dot2c_f32_bf16 v204, v208, v156
v_dot2c_f32_bf16 v206, v156, v156
v_dot2c_f32_bf16 v205, v208, v157
v_dot2c_f32_bf16 v207, v157, v157
v_dot2c_f32_bf16 v204, v208, v158
v_dot2c_f32_bf16 v206, v158, v158
v_dot2_f32_bf16 v176, v128, v192, v194
v_dot2_f32_bf16 v177, v128, v193, v194
v_dot2_f32_bf16 v178, v129, v192, v194
v_dot2_f32_bf16 v179, v129, v193, v194
v_dot2_f32_bf16 v180, v130, v192, v194
v_dot2_f32_bf16 v181, v130, v193, v194
s_add_u32 s69, s69, 294912
s_sub_u32 s0, s69, 5308416
s_min_u32 s69, s69, s0
s_add_u32 m0, s72, 12288
s_nop 0
buffer_load_dwordx4 v3, s[16:19], s69 offen  lds
v_dot2_f32_bf16 v182, v131, v192, v194
v_dot2_f32_bf16 v183, v131, v193, v194
v_cvt_pk_bf16_f32 v128, v176, v177
v_cvt_pk_bf16_f32 v129, v178, v179
v_cvt_pk_bf16_f32 v130, v180, v181
v_cvt_pk_bf16_f32 v131, v182, v183
ds_write_b128 v250, v[128:131] offset:2048
v_dot2c_f32_bf16 v205, v208, v159
v_dot2c_f32_bf16 v207, v159, v159
s_waitcnt vmcnt(11)
v_dot2c_f32_bf16 v204, v208, v160
v_dot2c_f32_bf16 v206, v160, v160
v_dot2c_f32_bf16 v205, v208, v161
v_dot2c_f32_bf16 v207, v161, v161
v_dot2c_f32_bf16 v204, v208, v162
v_dot2c_f32_bf16 v206, v162, v162
v_dot2c_f32_bf16 v205, v208, v163
v_dot2c_f32_bf16 v207, v163, v163
s_waitcnt vmcnt(10)
v_dot2c_f32_bf16 v204, v208, v100
v_dot2c_f32_bf16 v206, v100, v100
v_dot2c_f32_bf16 v205, v208, v101
v_dot2c_f32_bf16 v207, v101, v101
v_dot2c_f32_bf16 v204, v208, v102
v_dot2_f32_bf16 v168, v132, v192, v194
v_dot2_f32_bf16 v169, v132, v193, v194
v_dot2_f32_bf16 v170, v133, v192, v194
v_dot2_f32_bf16 v171, v133, v193, v194
v_dot2_f32_bf16 v172, v134, v192, v194
v_dot2_f32_bf16 v173, v134, v193, v194
v_dot2_f32_bf16 v174, v135, v192, v194
v_dot2_f32_bf16 v175, v135, v193, v194
v_cvt_pk_bf16_f32 v132, v168, v169
v_cvt_pk_bf16_f32 v133, v170, v171
v_cvt_pk_bf16_f32 v134, v172, v173
v_cvt_pk_bf16_f32 v135, v174, v175
ds_write_b128 v250, v[132:135] offset:4096
v_dot2c_f32_bf16 v206, v102, v102
v_dot2c_f32_bf16 v205, v208, v103
v_dot2c_f32_bf16 v207, v103, v103
s_waitcnt vmcnt(9)
v_dot2c_f32_bf16 v204, v208, v104
v_dot2c_f32_bf16 v206, v104, v104
v_dot2c_f32_bf16 v205, v208, v105
v_dot2c_f32_bf16 v207, v105, v105
s_add_u32 s69, s69, 294912
s_sub_u32 s0, s69, 5308416
s_min_u32 s69, s69, s0
s_add_u32 m0, s72, 16384
s_nop 0
buffer_load_dwordx4 v3, s[16:19], s69 offen  lds
v_dot2c_f32_bf16 v204, v208, v106
v_dot2c_f32_bf16 v206, v106, v106
v_dot2c_f32_bf16 v205, v208, v107
v_dot2c_f32_bf16 v207, v107, v107
s_waitcnt vmcnt(9)
v_dot2c_f32_bf16 v204, v208, v108
v_dot2c_f32_bf16 v206, v108, v108
v_dot2c_f32_bf16 v205, v208, v109
v_dot2c_f32_bf16 v207, v109, v109
v_dot2_f32_bf16 v176, v136, v192, v194
v_dot2_f32_bf16 v177, v136, v193, v194
v_dot2_f32_bf16 v178, v137, v192, v194
v_dot2_f32_bf16 v179, v137, v193, v194
v_dot2_f32_bf16 v180, v138, v192, v194
v_dot2_f32_bf16 v181, v138, v193, v194
v_dot2_f32_bf16 v182, v139, v192, v194
v_dot2_f32_bf16 v183, v139, v193, v194
v_cvt_pk_bf16_f32 v136, v176, v177
v_cvt_pk_bf16_f32 v137, v178, v179
v_cvt_pk_bf16_f32 v138, v180, v181
v_cvt_pk_bf16_f32 v139, v182, v183
ds_write_b128 v250, v[136:139] offset:6144
v_dot2c_f32_bf16 v204, v208, v110
v_dot2c_f32_bf16 v206, v110, v110
v_dot2c_f32_bf16 v205, v208, v111
v_dot2c_f32_bf16 v207, v111, v111
s_waitcnt vmcnt(8)
v_dot2c_f32_bf16 v204, v208, v112
v_dot2c_f32_bf16 v206, v112, v112
v_dot2c_f32_bf16 v205, v208, v113
v_dot2c_f32_bf16 v207, v113, v113
v_dot2c_f32_bf16 v204, v208, v114
v_dot2c_f32_bf16 v206, v114, v114
v_dot2c_f32_bf16 v205, v208, v115
v_dot2c_f32_bf16 v207, v115, v115
s_nop 1
v_add_f32 v204, v204, v205
v_add_f32 v206, v206, v207
s_nop 0
v_add_f32_dpp v204, v204, v204 quad_perm:[1,0,3,2] row_mask:0xf bank_mask:0xf
v_add_f32_dpp v206, v206, v206 quad_perm:[1,0,3,2] row_mask:0xf bank_mask:0xf
v_dot2_f32_bf16 v168, v140, v192, v194
v_dot2_f32_bf16 v169, v140, v193, v194
v_dot2_f32_bf16 v170, v141, v192, v194
v_dot2_f32_bf16 v171, v141, v193, v194
s_add_u32 s69, s69, 294912
s_sub_u32 s0, s69, 5308416
s_min_u32 s69, s69, s0
s_add_u32 m0, s72, 20480
s_nop 0
buffer_load_dwordx4 v3, s[16:19], s69 offen  lds
v_dot2_f32_bf16 v172, v142, v192, v194
v_dot2_f32_bf16 v173, v142, v193, v194
v_dot2_f32_bf16 v174, v143, v192, v194
v_dot2_f32_bf16 v175, v143, v193, v194
v_cvt_pk_bf16_f32 v140, v168, v169
v_cvt_pk_bf16_f32 v141, v170, v171
v_cvt_pk_bf16_f32 v142, v172, v173
v_cvt_pk_bf16_f32 v143, v174, v175
ds_write_b128 v250, v[140:143] offset:8192
v_add_f32_dpp v204, v204, v204 quad_perm:[2,3,0,1] row_mask:0xf bank_mask:0xf
v_add_f32_dpp v206, v206, v206 quad_perm:[2,3,0,1] row_mask:0xf bank_mask:0xf
s_nop 0
v_add_f32_dpp v204, v204, v204 row_half_mirror row_mask:0xf bank_mask:0xf
v_add_f32_dpp v206, v206, v206 row_half_mirror row_mask:0xf bank_mask:0xf
v_mul_f32 v204, 0x3ae38e39, v204
v_mul_f32 v206, 0x3ae38e39, v206
v_fma_f32 v206, -v204, v204, v206
v_max_f32 v206, 0, v206
v_cvt_pk_bf16_f32 v204, v204, v206
v_and_b32 v206, s93, v204
v_lshlrev_b32 v204, 16, v204
v_add_f32 v206, 0x3727c5ac, v206
v_cvt_pk_bf16_f32 v206, v206, v206
v_and_b32 v206, s93, v206
v_sqrt_f32 v206, v206
s_nop 0
v_cvt_pk_bf16_f32 v206, v206, v206
v_and_b32 v206, s93, v206
v_rcp_f32 v206, v206
s_nop 0
v_mul_f32 v206, s90, v206
v_cvt_pk_bf16_f32 v206, v206, v206
v_and_b32 v197, s93, v206
v_lshrrev_b32 v196, 16, v206
v_mul_f32 v198, -v204, v197
v_dot2_f32_bf16 v168, v144, v196, v198
v_dot2_f32_bf16 v169, v144, v197, v198
v_dot2_f32_bf16 v170, v145, v196, v198
v_dot2_f32_bf16 v171, v145, v197, v198
v_dot2_f32_bf16 v172, v146, v196, v198
v_dot2_f32_bf16 v173, v146, v197, v198
v_dot2_f32_bf16 v174, v147, v196, v198
v_dot2_f32_bf16 v175, v147, v197, v198
v_cvt_pk_bf16_f32 v144, v168, v169
s_add_u32 s69, s69, 294912
s_sub_u32 s0, s69, 5308416
s_min_u32 s69, s69, s0
s_add_u32 m0, s72, 24576
s_nop 0
buffer_load_dwordx4 v3, s[16:19], s69 offen  lds
v_cvt_pk_bf16_f32 v145, v170, v171
v_cvt_pk_bf16_f32 v146, v172, v173
v_cvt_pk_bf16_f32 v147, v174, v175
ds_write_b128 v251, v[144:147] offset:0
v_dot2_f32_bf16 v176, v52, v184, v186
v_dot2_f32_bf16 v177, v52, v185, v186
v_dot2_f32_bf16 v178, v53, v184, v186
v_dot2_f32_bf16 v179, v53, v185, v186
v_dot2_f32_bf16 v180, v54, v184, v186
v_dot2_f32_bf16 v181, v54, v185, v186
v_dot2_f32_bf16 v182, v55, v184, v186
v_dot2_f32_bf16 v183, v55, v185, v186
v_cvt_pk_bf16_f32 v52, v176, v177
v_cvt_pk_bf16_f32 v53, v178, v179
v_cvt_pk_bf16_f32 v54, v180, v181
v_cvt_pk_bf16_f32 v55, v182, v183
v_dot2_f32_bf16 v176, v148, v196, v198
v_dot2_f32_bf16 v177, v148, v197, v198
v_dot2_f32_bf16 v178, v149, v196, v198
v_dot2_f32_bf16 v179, v149, v197, v198
v_dot2_f32_bf16 v180, v150, v196, v198
v_dot2_f32_bf16 v181, v150, v197, v198
v_dot2_f32_bf16 v182, v151, v196, v198
v_dot2_f32_bf16 v183, v151, v197, v198
v_cvt_pk_bf16_f32 v148, v176, v177
v_cvt_pk_bf16_f32 v149, v178, v179
v_cvt_pk_bf16_f32 v150, v180, v181
v_cvt_pk_bf16_f32 v151, v182, v183
ds_write_b128 v251, v[148:151] offset:2048
v_dot2_f32_bf16 v168, v56, v184, v186
v_dot2_f32_bf16 v169, v56, v185, v186
v_dot2_f32_bf16 v170, v57, v184, v186
v_dot2_f32_bf16 v171, v57, v185, v186
v_dot2_f32_bf16 v172, v58, v184, v186
v_dot2_f32_bf16 v173, v58, v185, v186
v_dot2_f32_bf16 v174, v59, v184, v186
v_dot2_f32_bf16 v175, v59, v185, v186
v_cvt_pk_bf16_f32 v56, v168, v169
v_cvt_pk_bf16_f32 v57, v170, v171
v_cvt_pk_bf16_f32 v58, v172, v173
v_cvt_pk_bf16_f32 v59, v174, v175
v_dot2_f32_bf16 v168, v152, v196, v198
s_add_u32 s69, s69, 294912
s_sub_u32 s0, s69, 5308416
s_min_u32 s69, s69, s0
s_add_u32 m0, s72, 28672
s_nop 0
buffer_load_dwordx4 v3, s[16:19], s69 offen  lds
v_dot2_f32_bf16 v169, v152, v197, v198
v_dot2_f32_bf16 v170, v153, v196, v198
v_dot2_f32_bf16 v171, v153, v197, v198
v_dot2_f32_bf16 v172, v154, v196, v198
v_dot2_f32_bf16 v173, v154, v197, v198
v_dot2_f32_bf16 v174, v155, v196, v198
v_dot2_f32_bf16 v175, v155, v197, v198
v_cvt_pk_bf16_f32 v152, v168, v169
v_cvt_pk_bf16_f32 v153, v170, v171
v_cvt_pk_bf16_f32 v154, v172, v173
v_cvt_pk_bf16_f32 v155, v174, v175
ds_write_b128 v251, v[152:155] offset:4096
v_dot2_f32_bf16 v176, v60, v184, v186
v_dot2_f32_bf16 v177, v60, v185, v186
v_dot2_f32_bf16 v178, v61, v184, v186
v_dot2_f32_bf16 v179, v61, v185, v186
v_dot2_f32_bf16 v180, v62, v184, v186
v_dot2_f32_bf16 v181, v62, v185, v186
v_dot2_f32_bf16 v182, v63, v184, v186
v_dot2_f32_bf16 v183, v63, v185, v186
v_cvt_pk_bf16_f32 v60, v176, v177
v_cvt_pk_bf16_f32 v61, v178, v179
v_cvt_pk_bf16_f32 v62, v180, v181
v_cvt_pk_bf16_f32 v63, v182, v183
v_dot2_f32_bf16 v176, v156, v196, v198
v_dot2_f32_bf16 v177, v156, v197, v198
v_dot2_f32_bf16 v178, v157, v196, v198
v_dot2_f32_bf16 v179, v157, v197, v198
v_dot2_f32_bf16 v180, v158, v196, v198
v_dot2_f32_bf16 v181, v158, v197, v198
v_dot2_f32_bf16 v182, v159, v196, v198
v_dot2_f32_bf16 v183, v159, v197, v198
v_cvt_pk_bf16_f32 v156, v176, v177
v_cvt_pk_bf16_f32 v157, v178, v179
v_cvt_pk_bf16_f32 v158, v180, v181
v_cvt_pk_bf16_f32 v159, v182, v183
ds_write_b128 v251, v[156:159] offset:6144
v_dot2_f32_bf16 v168, v64, v184, v186
v_dot2_f32_bf16 v169, v64, v185, v186
v_dot2_f32_bf16 v170, v65, v184, v186
v_dot2_f32_bf16 v171, v65, v185, v186
v_dot2_f32_bf16 v172, v66, v184, v186
s_add_u32 s69, s69, 294912
s_sub_u32 s0, s69, 5308416
s_min_u32 s69, s69, s0
s_add_u32 m0, s72, 32768
s_nop 0
buffer_load_dwordx4 v3, s[16:19], s69 offen  lds
v_dot2_f32_bf16 v173, v66, v185, v186
v_dot2_f32_bf16 v174, v67, v184, v186
v_dot2_f32_bf16 v175, v67, v185, v186
v_cvt_pk_bf16_f32 v64, v168, v169
v_cvt_pk_bf16_f32 v65, v170, v171
v_cvt_pk_bf16_f32 v66, v172, v173
v_cvt_pk_bf16_f32 v67, v174, v175
v_dot2_f32_bf16 v168, v160, v196, v198
v_dot2_f32_bf16 v169, v160, v197, v198
v_dot2_f32_bf16 v170, v161, v196, v198
v_dot2_f32_bf16 v171, v161, v197, v198
v_dot2_f32_bf16 v172, v162, v196, v198
v_dot2_f32_bf16 v173, v162, v197, v198
v_dot2_f32_bf16 v174, v163, v196, v198
v_dot2_f32_bf16 v175, v163, v197, v198
v_cvt_pk_bf16_f32 v160, v168, v169
v_cvt_pk_bf16_f32 v161, v170, v171
v_cvt_pk_bf16_f32 v162, v172, v173
v_cvt_pk_bf16_f32 v163, v174, v175
ds_write_b128 v251, v[160:163] offset:8192
v_dot2_f32_bf16 v176, v68, v188, v190
v_dot2_f32_bf16 v177, v68, v189, v190
v_dot2_f32_bf16 v178, v69, v188, v190
v_dot2_f32_bf16 v179, v69, v189, v190
v_dot2_f32_bf16 v180, v70, v188, v190
v_dot2_f32_bf16 v181, v70, v189, v190
v_dot2_f32_bf16 v182, v71, v188, v190
v_dot2_f32_bf16 v183, v71, v189, v190
v_cvt_pk_bf16_f32 v68, v176, v177
v_cvt_pk_bf16_f32 v69, v178, v179
v_cvt_pk_bf16_f32 v70, v180, v181
v_cvt_pk_bf16_f32 v71, v182, v183
s_waitcnt vmcnt(7) lgkmcnt(0)
s_barrier
v_mov_b32 v15, 1
s_lshl_b32 s51, s62, 4
buffer_atomic_add v15, v252, s[28:31], s51 offen
ds_read_b128 a[0:3], v210 offset:0
ds_read_b128 a[4:7], v210 offset:10240
ds_read_b128 a[8:11], v214 offset:0
ds_read_b128 a[12:15], v214 offset:10240
v_dot2_f32_bf16 v176, v72, v188, v190
v_dot2_f32_bf16 v177, v72, v189, v190
v_dot2_f32_bf16 v178, v73, v188, v190
v_dot2_f32_bf16 v179, v73, v189, v190
v_dot2_f32_bf16 v180, v74, v188, v190
v_dot2_f32_bf16 v181, v74, v189, v190
v_dot2_f32_bf16 v182, v75, v188, v190
s_add_u32 s69, s69, 294912
s_sub_u32 s0, s69, 5308416
s_min_u32 s69, s69, s0
s_add_u32 m0, s72, 36864
s_nop 0
buffer_load_dwordx4 v3, s[16:19], s69 offen  lds
v_dot2_f32_bf16 v183, v75, v189, v190
v_cvt_pk_bf16_f32 v72, v176, v177
v_cvt_pk_bf16_f32 v73, v178, v179
v_cvt_pk_bf16_f32 v74, v180, v181
v_cvt_pk_bf16_f32 v75, v182, v183
ds_read_b128 a[16:19], v211 offset:1024
ds_read_b128 a[20:23], v211 offset:11264
ds_read_b128 a[24:27], v215 offset:1024
ds_read_b128 a[28:31], v215 offset:11264
v_dot2_f32_bf16 v168, v76, v188, v190
v_dot2_f32_bf16 v169, v76, v189, v190
v_dot2_f32_bf16 v170, v77, v188, v190
v_dot2_f32_bf16 v171, v77, v189, v190
v_dot2_f32_bf16 v172, v78, v188, v190
v_dot2_f32_bf16 v173, v78, v189, v190
v_dot2_f32_bf16 v174, v79, v188, v190
v_dot2_f32_bf16 v175, v79, v189, v190
v_cvt_pk_bf16_f32 v76, v168, v169
v_cvt_pk_bf16_f32 v77, v170, v171
v_cvt_pk_bf16_f32 v78, v172, v173
v_cvt_pk_bf16_f32 v79, v174, v175
ds_read_b128 a[32:35], v210 offset:2048
ds_read_b128 a[36:39], v210 offset:12288
ds_read_b128 a[40:43], v214 offset:2048
ds_read_b128 a[44:47], v214 offset:12288
v_dot2_f32_bf16 v176, v80, v188, v190
v_dot2_f32_bf16 v177, v80, v189, v190
v_dot2_f32_bf16 v178, v81, v188, v190
v_dot2_f32_bf16 v179, v81, v189, v190
v_dot2_f32_bf16 v180, v82, v188, v190
v_dot2_f32_bf16 v181, v82, v189, v190
v_dot2_f32_bf16 v182, v83, v188, v190
v_dot2_f32_bf16 v183, v83, v189, v190
v_cvt_pk_bf16_f32 v80, v176, v177
v_cvt_pk_bf16_f32 v81, v178, v179
v_cvt_pk_bf16_f32 v82, v180, v181
v_cvt_pk_bf16_f32 v83, v182, v183
ds_read_b128 a[48:51], v211 offset:3072
ds_read_b128 a[52:55], v211 offset:13312
ds_read_b128 a[56:59], v215 offset:3072
ds_read_b128 a[60:63], v215 offset:13312
v_dot2_f32_bf16 v168, v84, v192, v194
v_dot2_f32_bf16 v169, v84, v193, v194
v_dot2_f32_bf16 v170, v85, v192, v194
v_dot2_f32_bf16 v171, v85, v193, v194
v_dot2_f32_bf16 v172, v86, v192, v194
v_dot2_f32_bf16 v173, v86, v193, v194
v_dot2_f32_bf16 v174, v87, v192, v194
v_dot2_f32_bf16 v175, v87, v193, v194
v_cvt_pk_bf16_f32 v84, v168, v169
v_cvt_pk_bf16_f32 v85, v170, v171
v_cvt_pk_bf16_f32 v86, v172, v173
s_add_u32 s69, s69, 294912
s_sub_u32 s0, s69, 5308416
s_min_u32 s69, s69, s0
s_add_u32 m0, s72, 40960
s_nop 0
buffer_load_dwordx4 v3, s[16:19], s69 offen  lds
v_cvt_pk_bf16_f32 v87, v174, v175
ds_read_b128 a[64:67], v210 offset:4096
ds_read_b128 a[68:71], v210 offset:14336
ds_read_b128 a[72:75], v214 offset:4096
ds_read_b128 a[76:79], v214 offset:14336
v_dot2_f32_bf16 v176, v88, v192, v194
v_dot2_f32_bf16 v177, v88, v193, v194
v_dot2_f32_bf16 v178, v89, v192, v194
v_dot2_f32_bf16 v179, v89, v193, v194
v_dot2_f32_bf16 v180, v90, v192, v194
v_dot2_f32_bf16 v181, v90, v193, v194
v_dot2_f32_bf16 v182, v91, v192, v194
v_dot2_f32_bf16 v183, v91, v193, v194
v_cvt_pk_bf16_f32 v88, v176, v177
v_cvt_pk_bf16_f32 v89, v178, v179
v_cvt_pk_bf16_f32 v90, v180, v181
v_cvt_pk_bf16_f32 v91, v182, v183
ds_read_b128 a[80:83], v211 offset:5120
ds_read_b128 a[84:87], v211 offset:15360
ds_read_b128 a[88:91], v215 offset:5120
ds_read_b128 a[92:95], v215 offset:15360
v_dot2_f32_bf16 v168, v92, v192, v194
v_dot2_f32_bf16 v169, v92, v193, v194
v_dot2_f32_bf16 v170, v93, v192, v194
v_dot2_f32_bf16 v171, v93, v193, v194
v_dot2_f32_bf16 v172, v94, v192, v194
v_dot2_f32_bf16 v173, v94, v193, v194
v_dot2_f32_bf16 v174, v95, v192, v194
v_dot2_f32_bf16 v175, v95, v193, v194
v_cvt_pk_bf16_f32 v92, v168, v169
v_cvt_pk_bf16_f32 v93, v170, v171
v_cvt_pk_bf16_f32 v94, v172, v173
v_cvt_pk_bf16_f32 v95, v174, v175
ds_read_b128 a[96:99], v210 offset:6144
ds_read_b128 a[100:103], v210 offset:16384
ds_read_b128 a[104:107], v214 offset:6144
ds_read_b128 a[108:111], v214 offset:16384
v_dot2_f32_bf16 v176, v96, v192, v194
v_dot2_f32_bf16 v177, v96, v193, v194
v_dot2_f32_bf16 v178, v97, v192, v194
v_dot2_f32_bf16 v179, v97, v193, v194
v_dot2_f32_bf16 v180, v98, v192, v194
v_dot2_f32_bf16 v181, v98, v193, v194
v_dot2_f32_bf16 v182, v99, v192, v194
v_dot2_f32_bf16 v183, v99, v193, v194
v_cvt_pk_bf16_f32 v96, v176, v177
v_cvt_pk_bf16_f32 v97, v178, v179
v_cvt_pk_bf16_f32 v98, v180, v181
v_cvt_pk_bf16_f32 v99, v182, v183
ds_read_b128 a[112:115], v211 offset:7168
ds_read_b128 a[116:119], v211 offset:17408
ds_read_b128 a[120:123], v215 offset:7168
ds_read_b128 a[124:127], v215 offset:17408
v_dot2_f32_bf16 v168, v100, v196, v198
v_dot2_f32_bf16 v169, v100, v197, v198
v_dot2_f32_bf16 v170, v101, v196, v198
s_add_u32 s69, s69, 294912
s_sub_u32 s0, s69, 5308416
s_min_u32 s69, s69, s0
s_add_u32 m0, s72, 45056
s_nop 0
buffer_load_dwordx4 v3, s[16:19], s69 offen  lds
v_dot2_f32_bf16 v171, v101, v197, v198
v_dot2_f32_bf16 v172, v102, v196, v198
v_dot2_f32_bf16 v173, v102, v197, v198
v_dot2_f32_bf16 v174, v103, v196, v198
v_dot2_f32_bf16 v175, v103, v197, v198
v_cvt_pk_bf16_f32 v100, v168, v169
v_cvt_pk_bf16_f32 v101, v170, v171
v_cvt_pk_bf16_f32 v102, v172, v173
v_cvt_pk_bf16_f32 v103, v174, v175
ds_read_b128 a[128:131], v210 offset:8192
ds_read_b128 a[132:135], v210 offset:18432
ds_read_b128 a[136:139], v214 offset:8192
ds_read_b128 a[140:143], v214 offset:18432
v_dot2_f32_bf16 v176, v104, v196, v198
v_dot2_f32_bf16 v177, v104, v197, v198
v_dot2_f32_bf16 v178, v105, v196, v198
v_dot2_f32_bf16 v179, v105, v197, v198
v_dot2_f32_bf16 v180, v106, v196, v198
v_dot2_f32_bf16 v181, v106, v197, v198
v_dot2_f32_bf16 v182, v107, v196, v198
v_dot2_f32_bf16 v183, v107, v197, v198
v_cvt_pk_bf16_f32 v104, v176, v177
v_cvt_pk_bf16_f32 v105, v178, v179
v_cvt_pk_bf16_f32 v106, v180, v181
v_cvt_pk_bf16_f32 v107, v182, v183
ds_read_b128 a[144:147], v211 offset:9216
ds_read_b128 a[148:151], v211 offset:19456
ds_read_b128 a[152:155], v215 offset:9216
ds_read_b128 a[156:159], v215 offset:19456
v_dot2_f32_bf16 v168, v108, v196, v198
v_dot2_f32_bf16 v169, v108, v197, v198
v_dot2_f32_bf16 v170, v109, v196, v198
v_dot2_f32_bf16 v171, v109, v197, v198
v_dot2_f32_bf16 v172, v110, v196, v198
v_dot2_f32_bf16 v173, v110, v197, v198
v_dot2_f32_bf16 v174, v111, v196, v198
v_dot2_f32_bf16 v175, v111, v197, v198
v_cvt_pk_bf16_f32 v108, v168, v169
v_cvt_pk_bf16_f32 v109, v170, v171
v_cvt_pk_bf16_f32 v110, v172, v173
v_cvt_pk_bf16_f32 v111, v174, v175
v_dot2_f32_bf16 v176, v112, v196, v198
v_dot2_f32_bf16 v177, v112, v197, v198
v_dot2_f32_bf16 v178, v113, v196, v198
v_dot2_f32_bf16 v179, v113, v197, v198
v_dot2_f32_bf16 v180, v114, v196, v198
v_dot2_f32_bf16 v181, v114, v197, v198
v_dot2_f32_bf16 v182, v115, v196, v198
s_add_u32 s69, s69, 294912
s_sub_u32 s0, s69, 5308416
s_min_u32 s69, s69, s0
s_add_u32 m0, s72, 49152
s_nop 0
buffer_load_dwordx4 v3, s[16:19], s69 offen  lds
v_dot2_f32_bf16 v183, v115, v197, v198
v_cvt_pk_bf16_f32 v112, v176, v177
v_cvt_pk_bf16_f32 v113, v178, v179
v_cvt_pk_bf16_f32 v114, v180, v181
v_cvt_pk_bf16_f32 v115, v182, v183
s_cmp_eq_u32 s66, 1
s_cselect_b64 s[88:89], -1, 0
s_cselect_b32 s84, 0xffff, 0
s_cselect_b32 s82, 0, 0xffff
s_mov_b32 s83, 0
s_mov_b32 s85, 0
s_mov_b32 s78, 0x00f000f0
s_mov_b32 s79, 0x00f000f0
s_mov_b32 s80, 0xf000f000
s_mov_b32 s81, 0xf000f000
s_waitcnt lgkmcnt(0)
s_barrier
ds_write_b128 v248, v[52:55] offset:0
ds_write_b128 v248, v[56:59] offset:2048
ds_write_b128 v248, v[60:63] offset:4096
ds_write_b128 v248, v[64:67] offset:6144
ds_write_b128 v249, v[68:71] offset:0
ds_write_b128 v249, v[72:75] offset:2048
ds_write_b128 v249, v[76:79] offset:4096
ds_write_b128 v249, v[80:83] offset:6144
ds_write_b128 v250, v[84:87] offset:0
ds_write_b128 v250, v[88:91] offset:2048
ds_write_b128 v250, v[92:95] offset:4096
ds_write_b128 v250, v[96:99] offset:6144
ds_write_b128 v251, v[100:103] offset:0
ds_write_b128 v251, v[104:107] offset:2048
ds_write_b128 v251, v[108:111] offset:4096
ds_write_b128 v251, v[112:115] offset:6144
s_add_u32 s69, s69, 294912
s_sub_u32 s0, s69, 5308416
s_min_u32 s69, s69, s0
s_add_u32 m0, s72, 53248
s_nop 0
buffer_load_dwordx4 v3, s[16:19], s69 offen  lds
s_add_u32 s69, s69, 294912
s_sub_u32 s0, s69, 5308416
s_min_u32 s69, s69, s0
s_add_u32 m0, s72, 57344
s_nop 0
buffer_load_dwordx4 v3, s[16:19], s69 offen  lds
s_add_u32 s69, s69, 294912
s_sub_u32 s0, s69, 5308416
s_min_u32 s69, s69, s0
s_add_u32 m0, s72, 61440
s_nop 0
buffer_load_dwordx4 v3, s[16:19], s69 offen  lds
s_add_u32 s69, s69, 294912
s_sub_u32 s0, s69, 5308416
s_min_u32 s69, s69, s0
s_add_u32 m0, s72, 65536
s_nop 0
buffer_load_dwordx4 v3, s[16:19], s69 offen  lds
s_add_u32 s69, s69, 294912
s_sub_u32 s0, s69, 5308416
s_min_u32 s69, s69, s0
s_add_u32 m0, s72, 69632
s_nop 0
buffer_load_dwordx4 v3, s[16:19], s69 offen  lds
s_waitcnt vmcnt(10) lgkmcnt(0)
s_barrier
ds_read_b64_tr_b16 v[148:149], v8 offset:0
ds_read_b64_tr_b16 v[150:151], v8 offset:1024
s_waitcnt lgkmcnt(0)
v_mfma_f32_16x16x32_bf16 v[20:23], v[148:151], a[0:3], 0
s_xor_b32 s48, s40, 8192
ds_read_b64_tr_b16 v[152:153], v8 offset:2048
ds_read_b64_tr_b16 v[154:155], v8 offset:3072
v_mfma_f32_16x16x32_bf16 v[24:27], v[148:151], a[4:7], 0
s_add_u32 s101, s2, 8192
ds_read_b64_tr_b16 v[156:157], v8 offset:4096
ds_read_b64_tr_b16 v[158:159], v8 offset:5120
v_mfma_f32_16x16x32_bf16 v[28:31], v[148:151], a[8:11], 0
ds_read_b128 a[160:163], v210 offset:0
v_mov_b32 v14, 0
v_mfma_f32_16x16x32_bf16 v[32:35], v[148:151], a[12:15], 0
s_waitcnt lgkmcnt(3)
ds_read_b64_tr_b16 v[160:161], v8 offset:6144
ds_read_b64_tr_b16 v[162:163], v8 offset:7168
v_mfma_f32_16x16x32_bf16 v[36:39], v[152:155], a[0:3], 0
buffer_load_dword v12, v14, s[28:31], s51 offen sc1
v_mfma_f32_16x16x32_bf16 v[40:43], v[152:155], a[4:7], 0
ds_read_b128 a[164:167], v210 offset:10240
ds_read_b128 a[168:171], v214 offset:0
v_mfma_f32_16x16x32_bf16 v[44:47], v[152:155], a[8:11], 0
ds_read_b128 a[172:175], v214 offset:10240
ds_read_b128 a[176:179], v211 offset:1024
v_mfma_f32_16x16x32_bf16 v[48:51], v[152:155], a[12:15], 0
s_waitcnt lgkmcnt(7)
ds_read_b64_tr_b16 v[148:149], v8 offset:8192
ds_read_b64_tr_b16 v[150:151], v8 offset:9216
v_mfma_f32_16x16x32_bf16 v[20:23], v[156:159], a[16:19], v[20:23]
ds_read_b128 a[180:183], v211 offset:11264
ds_read_b128 a[184:187], v215 offset:1024
v_mfma_f32_16x16x32_bf16 v[24:27], v[156:159], a[20:23], v[24:27]
ds_read_b128 a[188:191], v215 offset:11264
ds_read_b128 a[192:195], v210 offset:2048
v_mfma_f32_16x16x32_bf16 v[28:31], v[156:159], a[24:27], v[28:31]
ds_read_b128 a[196:199], v210 offset:12288
ds_read_b128 a[200:203], v214 offset:2048
v_mfma_f32_16x16x32_bf16 v[32:35], v[156:159], a[28:31], v[32:35]
s_waitcnt lgkmcnt(12)
ds_read_b64_tr_b16 v[152:153], v8 offset:10240
ds_read_b64_tr_b16 v[154:155], v8 offset:11264
v_mfma_f32_16x16x32_bf16 v[36:39], v[160:163], a[16:19], v[36:39]
ds_read_b128 a[204:207], v214 offset:12288
ds_read_b128 a[208:211], v211 offset:3072
v_mfma_f32_16x16x32_bf16 v[40:43], v[160:163], a[20:23], v[40:43]
ds_read_b128 a[212:215], v211 offset:13312
ds_read_b128 a[216:219], v215 offset:3072
v_mfma_f32_16x16x32_bf16 v[44:47], v[160:163], a[24:27], v[44:47]
ds_read_b128 a[220:223], v215 offset:13312
ds_read_b128 a[224:227], v210 offset:4096
v_mfma_f32_16x16x32_bf16 v[48:51], v[160:163], a[28:31], v[48:51]
s_waitcnt lgkmcnt(14)
ds_read_b64_tr_b16 v[156:157], v8 offset:12288
ds_read_b64_tr_b16 v[158:159], v8 offset:13312
v_mfma_f32_16x16x32_bf16 v[20:23], v[148:151], a[32:35], v[20:23]
ds_read_b128 a[228:231], v210 offset:14336
ds_read_b128 a[232:235], v214 offset:4096
v_mfma_f32_16x16x32_bf16 v[24:27], v[148:151], a[36:39], v[24:27]
ds_read_b128 a[236:239], v214 offset:14336
ds_read_b128 a[240:243], v211 offset:5120
v_mfma_f32_16x16x32_bf16 v[28:31], v[148:151], a[40:43], v[28:31]
ds_read_b128 a[244:247], v211 offset:15360
ds_read_b128 a[248:251], v215 offset:5120
v_mfma_f32_16x16x32_bf16 v[32:35], v[148:151], a[44:47], v[32:35]
s_waitcnt lgkmcnt(14)
ds_read_b64_tr_b16 v[160:161], v8 offset:14336
ds_read_b64_tr_b16 v[162:163], v8 offset:15360
v_mfma_f32_16x16x32_bf16 v[36:39], v[152:155], a[32:35], v[36:39]
ds_read_b128 a[252:255], v215 offset:15360
ds_read_b128 v[168:171], v210 offset:6144
v_mfma_f32_16x16x32_bf16 v[40:43], v[152:155], a[36:39], v[40:43]
ds_read_b128 v[172:175], v210 offset:16384
ds_read_b128 v[176:179], v214 offset:6144
v_mfma_f32_16x16x32_bf16 v[44:47], v[152:155], a[40:43], v[44:47]
ds_read_b128 v[180:183], v214 offset:16384
ds_read_b128 v[184:187], v211 offset:7168
v_mfma_f32_16x16x32_bf16 v[48:51], v[152:155], a[44:47], v[48:51]
s_waitcnt lgkmcnt(14)
ds_read_b64_tr_b16 v[148:149], v8 offset:16384
ds_read_b64_tr_b16 v[150:151], v8 offset:17408
v_mfma_f32_16x16x32_bf16 v[20:23], v[156:159], a[48:51], v[20:23]
ds_read_b128 v[188:191], v211 offset:17408
ds_read_b128 v[192:195], v215 offset:7168
v_mfma_f32_16x16x32_bf16 v[24:27], v[156:159], a[52:55], v[24:27]
ds_read_b128 v[196:199], v215 offset:17408
v_mov_b32 v18, 2147483648
v_mfma_f32_16x16x32_bf16 v[28:31], v[156:159], a[56:59], v[28:31]
v_mov_b32 v11, 2147483648
v_cndmask_b32 v11, v11, v1, s[52:53]
v_mfma_f32_16x16x32_bf16 v[32:35], v[156:159], a[60:63], v[32:35]
s_waitcnt lgkmcnt(11)
ds_read_b64_tr_b16 v[152:153], v8 offset:18432
ds_read_b64_tr_b16 v[154:155], v8 offset:19456
v_mfma_f32_16x16x32_bf16 v[36:39], v[160:163], a[48:51], v[36:39]
v_mfma_f32_16x16x32_bf16 v[40:43], v[160:163], a[52:55], v[40:43]
v_mfma_f32_16x16x32_bf16 v[44:47], v[160:163], a[56:59], v[44:47]
s_waitcnt lgkmcnt(2)
v_mfma_f32_16x16x32_bf16 v[48:51], v[160:163], a[60:63], v[48:51]
s_barrier
ds_read_b64_tr_b16 v[156:157], v8 offset:20480
ds_read_b64_tr_b16 v[158:159], v8 offset:21504
v_mfma_f32_16x16x32_bf16 v[20:23], v[148:151], a[64:67], v[20:23]
v_mfma_f32_16x16x32_bf16 v[24:27], v[148:151], a[68:71], v[24:27]
v_mfma_f32_16x16x32_bf16 v[28:31], v[148:151], a[72:75], v[28:31]
v_mfma_f32_16x16x32_bf16 v[32:35], v[148:151], a[76:79], v[32:35]
s_waitcnt lgkmcnt(2)
ds_read_b64_tr_b16 v[160:161], v8 offset:22528
ds_read_b64_tr_b16 v[162:163], v8 offset:23552
v_mfma_f32_16x16x32_bf16 v[36:39], v[152:155], a[64:67], v[36:39]
v_mfma_f32_16x16x32_bf16 v[40:43], v[152:155], a[68:71], v[40:43]
v_mfma_f32_16x16x32_bf16 v[44:47], v[152:155], a[72:75], v[44:47]
v_mfma_f32_16x16x32_bf16 v[48:51], v[152:155], a[76:79], v[48:51]
s_waitcnt lgkmcnt(2)
ds_read_b64_tr_b16 v[148:149], v8 offset:24576
ds_read_b64_tr_b16 v[150:151], v8 offset:25600
v_mfma_f32_16x16x32_bf16 v[20:23], v[156:159], a[80:83], v[20:23]
v_mfma_f32_16x16x32_bf16 v[24:27], v[156:159], a[84:87], v[24:27]
v_mfma_f32_16x16x32_bf16 v[28:31], v[156:159], a[88:91], v[28:31]
v_mfma_f32_16x16x32_bf16 v[32:35], v[156:159], a[92:95], v[32:35]
s_waitcnt lgkmcnt(2)
ds_read_b64_tr_b16 v[152:153], v8 offset:26624
ds_read_b64_tr_b16 v[154:155], v8 offset:27648
v_mfma_f32_16x16x32_bf16 v[36:39], v[160:163], a[80:83], v[36:39]
s_waitcnt vmcnt(0)
v_cmp_ge_u32 s[86:87], v12, 16
v_mfma_f32_16x16x32_bf16 v[40:43], v[160:163], a[84:87], v[40:43]
v_mfma_f32_16x16x32_bf16 v[44:47], v[160:163], a[88:91], v[44:47]
s_cmp_eq_u64 s[86:87], -1
s_cbranch_scc0 L_slow0
L_back0:
v_mfma_f32_16x16x32_bf16 v[48:51], v[160:163], a[92:95], v[48:51]
s_waitcnt lgkmcnt(2)
ds_read_b64_tr_b16 v[156:157], v8 offset:28672
ds_read_b64_tr_b16 v[158:159], v8 offset:29696
v_mfma_f32_16x16x32_bf16 v[20:23], v[148:151], a[96:99], v[20:23]
s_mul_i32 s69, s71, 16384
v_lshlrev_b32 v14, 4, v0
s_add_u32 s67, s69, s70
v_mfma_f32_16x16x32_bf16 v[24:27], v[148:151], a[100:103], v[24:27]
s_add_u32 m0, s72, 73728
v_and_b32 v14, 0xf0, v14
v_mfma_f32_16x16x32_bf16 v[28:31], v[148:151], a[104:107], v[28:31]
s_add_u32 s69, s69, 4096
buffer_load_dwordx4 v1, s[32:35], s67 offen sc1 lds
v_mfma_f32_16x16x32_bf16 v[32:35], v[148:151], a[108:111], v[32:35]
s_waitcnt lgkmcnt(2)
ds_read_b64_tr_b16 v[160:161], v8 offset:30720
ds_read_b64_tr_b16 v[162:163], v8 offset:31744
v_mfma_f32_16x16x32_bf16 v[36:39], v[152:155], a[96:99], v[36:39]
s_sub_u32 s0, s69, 147456
v_mfma_f32_16x16x32_bf16 v[40:43], v[152:155], a[100:103], v[40:43]
s_min_u32 s69, s69, s0
v_mfma_f32_16x16x32_bf16 v[44:47], v[152:155], a[104:107], v[44:47]
s_add_u32 s67, s69, s70
v_mfma_f32_16x16x32_bf16 v[48:51], v[152:155], a[108:111], v[48:51]
s_waitcnt lgkmcnt(2)
ds_read_b64_tr_b16 v[148:149], v8 offset:32768
ds_read_b64_tr_b16 v[150:151], v8 offset:33792
v_mfma_f32_16x16x32_bf16 v[20:23], v[156:159], a[112:115], v[20:23]
s_add_u32 m0, s72, 77824
v_mfma_f32_16x16x32_bf16 v[24:27], v[156:159], a[116:119], v[24:27]
s_add_u32 s69, s69, 4096
buffer_load_dwordx4 v1, s[32:35], s67 offen sc1 lds
v_mfma_f32_16x16x32_bf16 v[28:31], v[156:159], a[120:123], v[28:31]
s_sub_u32 s0, s69, 147456
v_mfma_f32_16x16x32_bf16 v[32:35], v[156:159], a[124:127], v[32:35]
s_waitcnt lgkmcnt(2)
ds_read_b64_tr_b16 v[152:153], v8 offset:34816
ds_read_b64_tr_b16 v[154:155], v8 offset:35840
v_mfma_f32_16x16x32_bf16 v[36:39], v[160:163], a[112:115], v[36:39]
s_min_u32 s69, s69, s0
v_add_u32 v8, 98304, v4
s_add_u32 s67, s69, s70
v_mfma_f32_16x16x32_bf16 v[40:43], v[160:163], a[116:119], v[40:43]
s_add_u32 m0, s72, 81920
v_mfma_f32_16x16x32_bf16 v[44:47], v[160:163], a[120:123], v[44:47]
s_barrier
buffer_load_dwordx4 v1, s[32:35], s67 offen sc1 lds
v_mfma_f32_16x16x32_bf16 v[48:51], v[160:163], a[124:127], v[48:51]
s_waitcnt lgkmcnt(2)
ds_read_b64_tr_b16 v[156:157], v9 offset:0
ds_read_b64_tr_b16 v[158:159], v9 offset:1024
v_mfma_f32_16x16x32_bf16 v[20:23], v[148:151], a[128:131], v[20:23]
s_add_u32 s69, s69, 4096
v_mfma_f32_16x16x32_bf16 v[24:27], v[148:151], a[132:135], v[24:27]
s_sub_u32 s0, s69, 147456
v_mfma_f32_16x16x32_bf16 v[28:31], v[148:151], a[136:139], v[28:31]
s_min_u32 s69, s69, s0
v_mfma_f32_16x16x32_bf16 v[32:35], v[148:151], a[140:143], v[32:35]
s_waitcnt lgkmcnt(2)
ds_read_b64_tr_b16 v[160:161], v9 offset:2048
ds_read_b64_tr_b16 v[162:163], v9 offset:3072
v_mfma_f32_16x16x32_bf16 v[36:39], v[152:155], a[128:131], v[36:39]
s_add_u32 s67, s69, s70
v_mfma_f32_16x16x32_bf16 v[40:43], v[152:155], a[132:135], v[40:43]
s_add_u32 m0, s72, 86016
v_mfma_f32_16x16x32_bf16 v[44:47], v[152:155], a[136:139], v[44:47]
s_add_u32 s69, s69, 4096
buffer_load_dwordx4 v1, s[32:35], s67 offen sc1 lds
v_mfma_f32_16x16x32_bf16 v[48:51], v[152:155], a[140:143], v[48:51]
s_waitcnt lgkmcnt(2)
ds_read_b64_tr_b16 v[148:149], v9 offset:4096
ds_read_b64_tr_b16 v[150:151], v9 offset:5120
v_mfma_f32_16x16x32_bf16 v[20:23], v[156:159], a[144:147], v[20:23]
s_sub_u32 s0, s69, 147456
v_mfma_f32_16x16x32_bf16 v[24:27], v[156:159], a[148:151], v[24:27]
s_min_u32 s69, s69, s0
v_lshrrev_b32 v167, 2, v0
s_add_u32 s67, s69, s70
v_mfma_f32_16x16x32_bf16 v[28:31], v[156:159], a[152:155], v[28:31]
s_add_u32 m0, s72, 90112
v_mul_u32_u24 v167, 96, v167
s_add_u32 s69, s69, 4096
v_mfma_f32_16x16x32_bf16 v[32:35], v[156:159], a[156:159], v[32:35]
s_waitcnt lgkmcnt(2)
ds_read_b64_tr_b16 v[152:153], v9 offset:6144
ds_read_b64_tr_b16 v[154:155], v9 offset:7168
v_mfma_f32_16x16x32_bf16 v[36:39], v[160:163], a[144:147], v[36:39]
s_sub_u32 s0, s69, 147456
buffer_load_dwordx4 v1, s[32:35], s67 offen sc1 lds
v_mfma_f32_16x16x32_bf16 v[40:43], v[160:163], a[148:151], v[40:43]
s_min_u32 s69, s69, s0
v_and_b32 v15, 12, v10
s_add_u32 s67, s69, s70
v_mfma_f32_16x16x32_bf16 v[44:47], v[160:163], a[152:155], v[44:47]
s_add_u32 m0, s72, 94208
v_lshl_add_u32 v167, v15, 1, v167
s_add_u32 s69, s69, 4096
v_mfma_f32_16x16x32_bf16 v[48:51], v[160:163], a[156:159], v[48:51]
s_waitcnt lgkmcnt(2)
ds_read_b64_tr_b16 v[156:157], v9 offset:8192
ds_read_b64_tr_b16 v[158:159], v9 offset:9216
v_mfma_f32_16x16x32_bf16 v[20:23], v[148:151], a[160:163], v[20:23]
s_sub_u32 s0, s69, 147456
v_add_u32 v167, s40, v167
s_min_u32 s69, s69, s0
v_mfma_f32_16x16x32_bf16 v[24:27], v[148:151], a[164:167], v[24:27]
s_add_u32 s68, s20, 0
buffer_load_dwordx4 v1, s[32:35], s67 offen sc1 lds
v_mfma_f32_16x16x32_bf16 v[28:31], v[148:151], a[168:171], v[28:31]
s_add_u32 s67, s69, s70
v_mov_b32 v15, s94
s_add_u32 m0, s72, 98304
v_mfma_f32_16x16x32_bf16 v[32:35], v[148:151], a[172:175], v[32:35]
s_waitcnt lgkmcnt(2)
ds_read_b64_tr_b16 v[160:161], v9 offset:10240
ds_read_b64_tr_b16 v[162:163], v9 offset:11264
v_mfma_f32_16x16x32_bf16 v[36:39], v[152:155], a[160:163], v[36:39]
s_add_u32 s69, s69, 4096
v_mfma_f32_16x16x32_bf16 v[40:43], v[152:155], a[164:167], v[40:43]
s_sub_u32 s0, s69, 147456
v_mfma_f32_16x16x32_bf16 v[44:47], v[152:155], a[168:171], v[44:47]
s_min_u32 s69, s69, s0
buffer_load_dwordx4 v1, s[32:35], s67 offen sc1 lds
v_mfma_f32_16x16x32_bf16 v[48:51], v[152:155], a[172:175], v[48:51]
s_waitcnt lgkmcnt(2)
ds_read_b64_tr_b16 v[148:149], v9 offset:12288
ds_read_b64_tr_b16 v[150:151], v9 offset:13312
v_mfma_f32_16x16x32_bf16 v[20:23], v[156:159], a[176:179], v[20:23]
s_add_u32 s67, s69, s70
v_mfma_f32_16x16x32_bf16 v[24:27], v[156:159], a[180:183], v[24:27]
s_add_u32 m0, s72, 102400
v_mfma_f32_16x16x32_bf16 v[28:31], v[156:159], a[184:187], v[28:31]
s_add_u32 s69, s69, 4096
v_mfma_f32_16x16x32_bf16 v[32:35], v[156:159], a[188:191], v[32:35]
s_waitcnt lgkmcnt(2)
ds_read_b64_tr_b16 v[152:153], v9 offset:14336
ds_read_b64_tr_b16 v[154:155], v9 offset:15360
v_mfma_f32_16x16x32_bf16 v[36:39], v[160:163], a[176:179], v[36:39]
s_sub_u32 s0, s69, 147456
buffer_load_dwordx4 v1, s[32:35], s67 offen sc1 lds
v_mfma_f32_16x16x32_bf16 v[40:43], v[160:163], a[180:183], v[40:43]
s_min_u32 s69, s69, s0
v_mfma_f32_16x16x32_bf16 v[44:47], v[160:163], a[184:187], v[44:47]
s_add_u32 s67, s69, s70
v_mfma_f32_16x16x32_bf16 v[48:51], v[160:163], a[188:191], v[48:51]
s_waitcnt lgkmcnt(2)
ds_read_b64_tr_b16 v[156:157], v9 offset:16384
ds_read_b64_tr_b16 v[158:159], v9 offset:17408
v_mfma_f32_16x16x32_bf16 v[20:23], v[148:151], a[192:195], v[20:23]
s_add_u32 m0, s72, 106496
v_mfma_f32_16x16x32_bf16 v[24:27], v[148:151], a[196:199], v[24:27]
s_add_u32 s69, s69, 4096
buffer_load_dwordx4 v1, s[32:35], s67 offen sc1 lds
v_mfma_f32_16x16x32_bf16 v[28:31], v[148:151], a[200:203], v[28:31]
s_add_u32 m0, s40, 0
v_mfma_f32_16x16x32_bf16 v[32:35], v[148:151], a[204:207], v[32:35]
s_waitcnt lgkmcnt(2)
ds_read_b64_tr_b16 v[160:161], v9 offset:18432
ds_read_b64_tr_b16 v[162:163], v9 offset:19456
v_mfma_f32_16x16x32_bf16 v[36:39], v[152:155], a[192:195], v[36:39]
s_sub_u32 s0, s69, 147456
v_mfma_f32_16x16x32_bf16 v[40:43], v[152:155], a[196:199], v[40:43]
s_min_u32 s69, s69, s0
v_mfma_f32_16x16x32_bf16 v[44:47], v[152:155], a[200:203], v[44:47]
s_add_u32 s67, s69, s70
buffer_load_dwordx4 v164, s[12:15], s68 offen  lds
v_mfma_f32_16x16x32_bf16 v[48:51], v[152:155], a[204:207], v[48:51]
s_waitcnt lgkmcnt(2)
ds_read_b64_tr_b16 v[148:149], v9 offset:20480
ds_read_b64_tr_b16 v[150:151], v9 offset:21504
v_mfma_f32_16x16x32_bf16 v[20:23], v[156:159], a[208:211], v[20:23]
s_add_u32 m0, s40, 1024
v_mfma_f32_16x16x32_bf16 v[24:27], v[156:159], a[212:215], v[24:27]
s_add_u32 s68, s20, 0
v_mfma_f32_16x16x32_bf16 v[28:31], v[156:159], a[216:219], v[28:31]
s_add_u32 s69, s69, 4096
v_mfma_f32_16x16x32_bf16 v[32:35], v[156:159], a[220:223], v[32:35]
s_waitcnt lgkmcnt(2)
ds_read_b64_tr_b16 v[152:153], v9 offset:22528
ds_read_b64_tr_b16 v[154:155], v9 offset:23552
v_mfma_f32_16x16x32_bf16 v[36:39], v[160:163], a[208:211], v[36:39]
s_sub_u32 s0, s69, 147456
v_mfma_f32_16x16x32_bf16 v[40:43], v[160:163], a[212:215], v[40:43]
s_min_u32 s69, s69, s0
v_mfma_f32_16x16x32_bf16 v[44:47], v[160:163], a[216:219], v[44:47]
v_mfma_f32_16x16x32_bf16 v[48:51], v[160:163], a[220:223], v[48:51]
s_waitcnt lgkmcnt(2)
ds_read_b64_tr_b16 v[156:157], v9 offset:24576
ds_read_b64_tr_b16 v[158:159], v9 offset:25600
v_mfma_f32_16x16x32_bf16 v[20:23], v[148:151], a[224:227], v[20:23]
buffer_load_dwordx4 v165, s[12:15], s68 offen  lds
v_mfma_f32_16x16x32_bf16 v[24:27], v[148:151], a[228:231], v[24:27]
s_add_u32 m0, s72, 110592
v_mfma_f32_16x16x32_bf16 v[28:31], v[148:151], a[232:235], v[28:31]
s_add_u32 s68, s20, 0
v_mfma_f32_16x16x32_bf16 v[32:35], v[148:151], a[236:239], v[32:35]
s_waitcnt lgkmcnt(2)
ds_read_b64_tr_b16 v[160:161], v9 offset:26624
ds_read_b64_tr_b16 v[162:163], v9 offset:27648
v_mfma_f32_16x16x32_bf16 v[36:39], v[152:155], a[224:227], v[36:39]
v_mfma_f32_16x16x32_bf16 v[40:43], v[152:155], a[228:231], v[40:43]
v_mfma_f32_16x16x32_bf16 v[44:47], v[152:155], a[232:235], v[44:47]
buffer_load_dwordx4 v1, s[32:35], s67 offen sc1 lds
v_mfma_f32_16x16x32_bf16 v[48:51], v[152:155], a[236:239], v[48:51]
s_waitcnt lgkmcnt(2)
ds_read_b64_tr_b16 v[148:149], v9 offset:28672
ds_read_b64_tr_b16 v[150:151], v9 offset:29696
v_mfma_f32_16x16x32_bf16 v[20:23], v[156:159], a[240:243], v[20:23]
s_add_u32 m0, s40, 2048
v_mfma_f32_16x16x32_bf16 v[24:27], v[156:159], a[244:247], v[24:27]
s_add_u32 s67, s69, s70
buffer_load_dwordx4 v166, s[12:15], s68 offen  lds
v_mfma_f32_16x16x32_bf16 v[28:31], v[156:159], a[248:251], v[28:31]
s_add_u32 m0, s72, 114688
v_mfma_f32_16x16x32_bf16 v[32:35], v[156:159], a[252:255], v[32:35]
s_waitcnt lgkmcnt(2)
ds_read_b64_tr_b16 v[152:153], v9 offset:30720
ds_read_b64_tr_b16 v[154:155], v9 offset:31744
v_mfma_f32_16x16x32_bf16 v[36:39], v[160:163], a[240:243], v[36:39]
s_add_u32 s69, s69, 4096
v_mfma_f32_16x16x32_bf16 v[40:43], v[160:163], a[244:247], v[40:43]
s_sub_u32 s0, s69, 147456
v_mfma_f32_16x16x32_bf16 v[44:47], v[160:163], a[248:251], v[44:47]
s_min_u32 s69, s69, s0
buffer_load_dwordx4 v1, s[32:35], s67 offen sc1 lds
v_mfma_f32_16x16x32_bf16 v[48:51], v[160:163], a[252:255], v[48:51]
s_waitcnt lgkmcnt(2)
ds_read_b64_tr_b16 v[156:157], v9 offset:32768
ds_read_b64_tr_b16 v[158:159], v9 offset:33792
v_mfma_f32_16x16x32_bf16 v[20:23], v[148:151], v[168:171], v[20:23]
s_add_u32 s67, s69, s70
v_mfma_f32_16x16x32_bf16 v[24:27], v[148:151], v[172:175], v[24:27]
s_add_u32 m0, s72, 118784
v_mfma_f32_16x16x32_bf16 v[28:31], v[148:151], v[176:179], v[28:31]
s_add_u32 s69, s69, 4096
buffer_load_dwordx4 v1, s[32:35], s67 offen sc1 lds
v_mfma_f32_16x16x32_bf16 v[32:35], v[148:151], v[180:183], v[32:35]
s_waitcnt lgkmcnt(2)
ds_read_b64_tr_b16 v[160:161], v9 offset:34816
ds_read_b64_tr_b16 v[162:163], v9 offset:35840
v_mfma_f32_16x16x32_bf16 v[36:39], v[152:155], v[168:171], v[36:39]
s_sub_u32 s0, s69, 147456
v_add_u32 v9, 98304, v5
s_min_u32 s69, s69, s0
v_mfma_f32_16x16x32_bf16 v[40:43], v[152:155], v[172:175], v[40:43]
s_add_u32 s67, s69, s70
v_mfma_f32_16x16x32_bf16 v[44:47], v[152:155], v[176:179], v[44:47]
s_add_u32 m0, s72, 122880
s_waitcnt vmcnt(6)
s_barrier
v_mfma_f32_16x16x32_bf16 v[48:51], v[152:155], v[180:183], v[48:51]
s_waitcnt lgkmcnt(2)
ds_read_b64_tr_b16 v[148:149], v220 offset:16384
ds_read_b64_tr_b16 v[150:151], v220 offset:20480
v_mfma_f32_16x16x32_bf16 v[20:23], v[156:159], v[184:187], v[20:23]
s_add_u32 s69, s69, 4096
buffer_load_dwordx4 v1, s[32:35], s67 offen sc1 lds
v_mfma_f32_16x16x32_bf16 v[24:27], v[156:159], v[188:191], v[24:27]
s_sub_u32 s0, s69, 147456
v_mfma_f32_16x16x32_bf16 v[28:31], v[156:159], v[192:195], v[28:31]
s_min_u32 s69, s69, s0
v_mfma_f32_16x16x32_bf16 v[32:35], v[156:159], v[196:199], v[32:35]
s_waitcnt lgkmcnt(2)
ds_read_b64_tr_b16 v[152:153], v221 offset:16384
ds_read_b64_tr_b16 v[154:155], v221 offset:20480
v_mfma_f32_16x16x32_bf16 v[36:39], v[160:163], v[184:187], v[36:39]
s_add_u32 s67, s69, s70
v_exp_f32 v20, v20
v_mfma_f32_16x16x32_bf16 v[40:43], v[160:163], v[188:191], v[40:43]
s_add_u32 m0, s72, 126976
v_fma_f32 v20, v20, s90, s90
s_add_u32 s69, s69, 4096
v_mfma_f32_16x16x32_bf16 v[44:47], v[160:163], v[192:195], v[44:47]
s_sub_u32 s0, s69, 147456
buffer_load_dwordx4 v1, s[32:35], s67 offen sc1 lds
v_mfma_f32_16x16x32_bf16 v[48:51], v[160:163], v[196:199], v[48:51]
s_waitcnt lgkmcnt(2)
ds_read_b64_tr_b16 v[156:157], v222 offset:16384
ds_read_b64_tr_b16 v[158:159], v222 offset:20480
v_mfma_f32_16x16x32_bf16 v[52:55], a[0:3], v[148:151], 0
s_min_u32 s69, s69, s0
v_rcp_f32 v20, v20
v_mfma_f32_16x16x32_bf16 v[56:59], a[4:7], v[148:151], 0
s_add_u32 s67, s69, s70
v_mul_f32 v36, v36, v20
s_add_u32 m0, s72, 131072
v_mfma_f32_16x16x32_bf16 v[60:63], a[8:11], v[148:151], 0
s_add_u32 s69, s69, 4096
buffer_load_dwordx4 v1, s[32:35], s67 offen sc1 lds
v_mfma_f32_16x16x32_bf16 v[64:67], a[12:15], v[148:151], 0
s_waitcnt lgkmcnt(2)
ds_read_b64_tr_b16 v[160:161], v223 offset:16384
ds_read_b64_tr_b16 v[162:163], v223 offset:20480
v_mfma_f32_16x16x32_bf16 v[68:71], a[0:3], v[152:155], 0
s_sub_u32 s0, s69, 147456
v_exp_f32 v21, v21
v_mfma_f32_16x16x32_bf16 v[72:75], a[4:7], v[152:155], 0
s_min_u32 s69, s69, s0
ds_read_b64_tr_b16 v[148:149], v220 offset:24576
ds_read_b64_tr_b16 v[150:151], v220 offset:28672
v_mfma_f32_16x16x32_bf16 v[76:79], a[8:11], v[152:155], 0
s_add_u32 s67, s69, s70
v_fma_f32 v21, v21, s90, s90
s_add_u32 m0, s72, 135168
v_mfma_f32_16x16x32_bf16 v[80:83], a[12:15], v[152:155], 0
s_waitcnt lgkmcnt(4)
buffer_load_dwordx4 v1, s[32:35], s67 offen sc1 lds
v_mfma_f32_16x16x32_bf16 v[84:87], v[156:159], a[0:3], 0
s_add_u32 s69, s69, 4096
v_rcp_f32 v21, v21
v_mfma_f32_16x16x32_bf16 v[88:91], v[156:159], a[4:7], 0
s_sub_u32 s0, s69, 147456
ds_read_b64_tr_b16 v[152:153], v221 offset:24576
ds_read_b64_tr_b16 v[154:155], v221 offset:28672
v_mfma_f32_16x16x32_bf16 v[92:95], v[156:159], a[8:11], 0
s_min_u32 s69, s69, s0
v_mul_f32 v37, v37, v21
s_add_u32 s67, s69, s70
v_mfma_f32_16x16x32_bf16 v[96:99], v[156:159], a[12:15], 0
s_waitcnt lgkmcnt(4)
v_exp_f32 v22, v22
v_mfma_f32_16x16x32_bf16 v[100:103], a[0:3], v[160:163], 0
s_add_u32 m0, s72, 139264
v_fma_f32 v22, v22, s90, s90
s_add_u32 s69, s69, 4096
v_mfma_f32_16x16x32_bf16 v[104:107], a[4:7], v[160:163], 0
s_waitcnt lgkmcnt(2)
ds_read_b64_tr_b16 v[156:157], v222 offset:24576
ds_read_b64_tr_b16 v[158:159], v222 offset:28672
v_mfma_f32_16x16x32_bf16 v[52:55], a[16:19], v[148:151], v[52:55]
s_sub_u32 s0, s69, 147456
buffer_load_dwordx4 v1, s[32:35], s67 offen sc1 lds
v_mfma_f32_16x16x32_bf16 v[56:59], a[20:23], v[148:151], v[56:59]
s_min_u32 s69, s69, s0
v_rcp_f32 v22, v22
v_mfma_f32_16x16x32_bf16 v[60:63], a[24:27], v[148:151], v[60:63]
s_add_u32 s67, s69, s70
v_mul_f32 v38, v38, v22
s_add_u32 m0, s72, 143360
v_mfma_f32_16x16x32_bf16 v[64:67], a[28:31], v[148:151], v[64:67]
s_waitcnt lgkmcnt(2)
buffer_load_dwordx4 v1, s[32:35], s67 offen sc1 lds
v_mfma_f32_16x16x32_bf16 v[68:71], a[16:19], v[152:155], v[68:71]
s_add_u32 s69, s69, 4096
ds_read_b64_tr_b16 v[160:161], v223 offset:24576
ds_read_b64_tr_b16 v[162:163], v223 offset:28672
v_mfma_f32_16x16x32_bf16 v[72:75], a[20:23], v[152:155], v[72:75]
s_sub_u32 s0, s69, 147456
ds_read_b64_tr_b16 v[148:149], v220 offset:32768
ds_read_b64_tr_b16 v[150:151], v220 offset:36864
v_mfma_f32_16x16x32_bf16 v[76:79], a[24:27], v[152:155], v[76:79]
s_min_u32 s69, s69, s0
v_exp_f32 v23, v23
v_mfma_f32_16x16x32_bf16 v[80:83], a[28:31], v[152:155], v[80:83]
s_waitcnt lgkmcnt(4)
v_fma_f32 v23, v23, s90, s90
s_add_u32 s67, s69, s70
v_mfma_f32_16x16x32_bf16 v[84:87], v[156:159], a[16:19], v[84:87]
s_add_u32 m0, s72, 0
v_rcp_f32 v23, v23
v_mfma_f32_16x16x32_bf16 v[88:91], v[156:159], a[20:23], v[88:91]
s_add_u32 s69, s69, 4096
ds_read_b64_tr_b16 v[152:153], v221 offset:32768
ds_read_b64_tr_b16 v[154:155], v221 offset:36864
v_mfma_f32_16x16x32_bf16 v[92:95], v[156:159], a[24:27], v[92:95]
s_sub_u32 s0, s69, 147456
buffer_load_dwordx4 v1, s[32:35], s67 offen sc1 lds
v_mfma_f32_16x16x32_bf16 v[96:99], v[156:159], a[28:31], v[96:99]
s_waitcnt lgkmcnt(4)
v_mul_f32 v39, v39, v23
s_min_u32 s69, s69, s0
v_mfma_f32_16x16x32_bf16 v[100:103], a[16:19], v[160:163], v[100:103]
s_add_u32 s67, s69, s70
v_cvt_pk_bf16_f32 v20, v36, v37
s_add_u32 m0, s72, 4096
v_mfma_f32_16x16x32_bf16 v[104:107], a[20:23], v[160:163], v[104:107]
s_waitcnt lgkmcnt(2)
ds_read_b64_tr_b16 v[156:157], v222 offset:32768
ds_read_b64_tr_b16 v[158:159], v222 offset:36864
v_mfma_f32_16x16x32_bf16 v[52:55], a[32:35], v[148:151], v[52:55]
s_add_u32 s69, s69, 4096
buffer_load_dwordx4 v1, s[32:35], s67 offen sc1 lds
v_mfma_f32_16x16x32_bf16 v[56:59], a[36:39], v[148:151], v[56:59]
s_sub_u32 s0, s69, 147456
v_cvt_pk_bf16_f32 v21, v38, v39
s_min_u32 s69, s69, s0
v_mfma_f32_16x16x32_bf16 v[60:63], a[40:43], v[148:151], v[60:63]
s_add_u32 s67, s69, s70
v_exp_f32 v24, v24
v_mfma_f32_16x16x32_bf16 v[64:67], a[44:47], v[148:151], v[64:67]
s_waitcnt lgkmcnt(2)
ds_read_b64_tr_b16 v[160:161], v223 offset:32768
ds_read_b64_tr_b16 v[162:163], v223 offset:36864
v_mfma_f32_16x16x32_bf16 v[68:71], a[32:35], v[152:155], v[68:71]
s_add_u32 m0, s72, 8192
v_fma_f32 v24, v24, s90, s90
s_add_u32 s69, s69, 4096
v_mfma_f32_16x16x32_bf16 v[72:75], a[36:39], v[152:155], v[72:75]
s_sub_u32 s0, s69, 147456
ds_read_b64_tr_b16 v[148:149], v220 offset:40960
ds_read_b64_tr_b16 v[150:151], v220 offset:45056
v_mfma_f32_16x16x32_bf16 v[76:79], a[40:43], v[152:155], v[76:79]
s_min_u32 s69, s69, s0
buffer_load_dwordx4 v1, s[32:35], s67 offen sc1 lds
v_mfma_f32_16x16x32_bf16 v[80:83], a[44:47], v[152:155], v[80:83]
s_waitcnt lgkmcnt(4)
v_rcp_f32 v24, v24
v_mfma_f32_16x16x32_bf16 v[84:87], v[156:159], a[32:35], v[84:87]
s_add_u32 s67, s69, s70
v_mul_f32 v40, v40, v24
s_add_u32 m0, s72, 12288
v_mfma_f32_16x16x32_bf16 v[88:91], v[156:159], a[36:39], v[88:91]
s_add_u32 s69, s69, 4096
ds_read_b64_tr_b16 v[152:153], v221 offset:40960
ds_read_b64_tr_b16 v[154:155], v221 offset:45056
v_mfma_f32_16x16x32_bf16 v[92:95], v[156:159], a[40:43], v[92:95]
s_sub_u32 s0, s69, 147456
buffer_load_dwordx4 v1, s[32:35], s67 offen sc1 lds
v_mfma_f32_16x16x32_bf16 v[96:99], v[156:159], a[44:47], v[96:99]
s_waitcnt lgkmcnt(4)
v_exp_f32 v25, v25
v_mfma_f32_16x16x32_bf16 v[100:103], a[32:35], v[160:163], v[100:103]
s_min_u32 s69, s69, s0
v_fma_f32 v25, v25, s90, s90
s_add_u32 s67, s69, s70
v_mfma_f32_16x16x32_bf16 v[104:107], a[36:39], v[160:163], v[104:107]
s_waitcnt lgkmcnt(2)
ds_read_b64_tr_b16 v[156:157], v222 offset:40960
ds_read_b64_tr_b16 v[158:159], v222 offset:45056
v_mfma_f32_16x16x32_bf16 v[52:55], a[48:51], v[148:151], v[52:55]
s_add_u32 m0, s72, 16384
v_rcp_f32 v25, v25
v_mfma_f32_16x16x32_bf16 v[56:59], a[52:55], v[148:151], v[56:59]
s_add_u32 s69, s69, 4096
buffer_load_dwordx4 v1, s[32:35], s67 offen sc1 lds
v_mfma_f32_16x16x32_bf16 v[60:63], a[56:59], v[148:151], v[60:63]
s_sub_u32 s0, s69, 147456
v_mul_f32 v41, v41, v25
s_min_u32 s69, s69, s0
v_mfma_f32_16x16x32_bf16 v[64:67], a[60:63], v[148:151], v[64:67]
s_waitcnt vmcnt(5) lgkmcnt(2)
ds_read_b64_tr_b16 v[160:161], v223 offset:40960
ds_read_b64_tr_b16 v[162:163], v223 offset:45056
v_mfma_f32_16x16x32_bf16 v[68:71], a[48:51], v[152:155], v[68:71]
s_add_u32 s67, s69, s70
ds_read_b64_tr_b16 v[224:225], v167 offset:0
s_add_u32 m0, s72, 20480
s_barrier
v_mfma_f32_16x16x32_bf16 v[72:75], a[52:55], v[152:155], v[72:75]
s_add_u32 s69, s69, 4096
ds_read_b64_tr_b16 v[148:149], v220 offset:49152
ds_read_b64_tr_b16 v[150:151], v220 offset:53248
v_mfma_f32_16x16x32_bf16 v[76:79], a[56:59], v[152:155], v[76:79]
s_sub_u32 s0, s69, 147456
buffer_load_dwordx4 v1, s[32:35], s67 offen sc1 lds
v_mfma_f32_16x16x32_bf16 v[80:83], a[60:63], v[152:155], v[80:83]
s_waitcnt lgkmcnt(5)
ds_read_b64_tr_b16 v[226:227], v167 offset:1536
s_min_u32 s69, s69, s0
v_mfma_f32_16x16x32_bf16 v[84:87], v[156:159], a[48:51], v[84:87]
s_add_u32 s67, s69, s70
ds_read_b64_tr_b16 v[228:229], v167 offset:32
s_add_u32 m0, s72, 24576
v_mfma_f32_16x16x32_bf16 v[88:91], v[156:159], a[52:55], v[88:91]
s_add_u32 s69, s69, 4096
ds_read_b64_tr_b16 v[152:153], v221 offset:49152
ds_read_b64_tr_b16 v[154:155], v221 offset:53248
v_mfma_f32_16x16x32_bf16 v[92:95], v[156:159], a[56:59], v[92:95]
s_sub_u32 s0, s69, 147456
buffer_load_dwordx4 v1, s[32:35], s67 offen sc1 lds
v_mfma_f32_16x16x32_bf16 v[96:99], v[156:159], a[60:63], v[96:99]
s_waitcnt lgkmcnt(7)
ds_read_b64_tr_b16 v[230:231], v167 offset:1568
s_min_u32 s69, s69, s0
v_mfma_f32_16x16x32_bf16 v[100:103], a[48:51], v[160:163], v[100:103]
s_add_u32 s67, s69, s70
ds_read_b64_tr_b16 v[232:233], v167 offset:64
s_add_u32 m0, s72, 28672
v_mfma_f32_16x16x32_bf16 v[104:107], a[52:55], v[160:163], v[104:107]
s_waitcnt lgkmcnt(6)
ds_read_b64_tr_b16 v[156:157], v222 offset:49152
ds_read_b64_tr_b16 v[158:159], v222 offset:53248
v_mfma_f32_16x16x32_bf16 v[52:55], a[64:67], v[148:151], v[52:55]
s_add_u32 s69, s69, 4096
buffer_load_dwordx4 v1, s[32:35], s67 offen sc1 lds
v_mfma_f32_16x16x32_bf16 v[56:59], a[68:71], v[148:151], v[56:59]
s_sub_u32 s0, s69, 147456
ds_read_b64_tr_b16 v[234:235], v167 offset:1600
s_min_u32 s69, s69, s0
v_mfma_f32_16x16x32_bf16 v[60:63], a[72:75], v[148:151], v[60:63]
s_add_u32 s67, s69, s70
v_add_u32 v220, 57344, v220
s_add_u32 m0, s72, 32768
v_mfma_f32_16x16x32_bf16 v[64:67], a[76:79], v[148:151], v[64:67]
s_waitcnt lgkmcnt(5)
ds_read_b64_tr_b16 v[160:161], v223 offset:49152
ds_read_b64_tr_b16 v[162:163], v223 offset:53248
v_mfma_f32_16x16x32_bf16 v[68:71], a[64:67], v[152:155], v[68:71]
s_add_u32 s50, s21, 0
buffer_load_dwordx4 v1, s[32:35], s67 offen sc1 lds
v_mfma_f32_16x16x32_bf16 v[72:75], a[68:71], v[152:155], v[72:75]
s_add_u32 s69, s69, 4096
ds_read_b64_tr_b16 v[148:149], v220 offset:0
ds_read_b64_tr_b16 v[150:151], v220 offset:4096
v_mfma_f32_16x16x32_bf16 v[76:79], a[72:75], v[152:155], v[76:79]
s_sub_u32 s0, s69, 147456
v_add_u32 v221, 57344, v221
s_min_u32 s69, s69, s0
v_mfma_f32_16x16x32_bf16 v[80:83], a[76:79], v[152:155], v[80:83]
s_waitcnt lgkmcnt(5)
v_add_u32 v222, 57344, v222
s_add_u32 s67, s69, s70
v_mfma_f32_16x16x32_bf16 v[84:87], v[156:159], a[64:67], v[84:87]
s_add_u32 m0, s72, 36864
v_exp_f32 v26, v26
v_mfma_f32_16x16x32_bf16 v[88:91], v[156:159], a[68:71], v[88:91]
s_add_u32 s69, s69, 4096
ds_read_b64_tr_b16 v[152:153], v221 offset:0
ds_read_b64_tr_b16 v[154:155], v221 offset:4096
v_mfma_f32_16x16x32_bf16 v[92:95], v[156:159], a[72:75], v[92:95]
s_sub_u32 s0, s69, 147456
buffer_load_dwordx4 v1, s[32:35], s67 offen sc1 lds
v_mfma_f32_16x16x32_bf16 v[96:99], v[156:159], a[76:79], v[96:99]
s_waitcnt lgkmcnt(4)
v_add_u32 v223, 57344, v223
s_min_u32 s69, s69, s0
v_mfma_f32_16x16x32_bf16 v[100:103], a[64:67], v[160:163], v[100:103]
s_add_u32 s67, s69, s70
v_fma_f32 v26, v26, s90, s90
s_add_u32 m0, s72, 40960
v_mfma_f32_16x16x32_bf16 v[104:107], a[68:71], v[160:163], v[104:107]
s_waitcnt lgkmcnt(2)
ds_read_b64_tr_b16 v[156:157], v222 offset:0
ds_read_b64_tr_b16 v[158:159], v222 offset:4096
v_mfma_f32_16x16x32_bf16 v[52:55], a[80:83], v[148:151], v[52:55]
s_add_u32 s69, s69, 4096
v_rcp_f32 v26, v26
v_mfma_f32_16x16x32_bf16 v[56:59], a[84:87], v[148:151], v[56:59]
s_sub_u32 s0, s69, 147456
buffer_load_dwordx4 v1, s[32:35], s67 offen sc1 lds
v_mfma_f32_16x16x32_bf16 v[60:63], a[88:91], v[148:151], v[60:63]
s_min_u32 s69, s69, s0
v_mul_f32 v42, v42, v26
s_add_u32 s67, s69, s70
v_mfma_f32_16x16x32_bf16 v[64:67], a[92:95], v[148:151], v[64:67]
s_waitcnt lgkmcnt(2)
ds_read_b64_tr_b16 v[160:161], v223 offset:0
ds_read_b64_tr_b16 v[162:163], v223 offset:4096
v_mfma_f32_16x16x32_bf16 v[68:71], a[80:83], v[152:155], v[68:71]
s_add_u32 m0, s72, 45056
v_exp_f32 v27, v27
v_mfma_f32_16x16x32_bf16 v[72:75], a[84:87], v[152:155], v[72:75]
s_add_u32 s69, s69, 4096
ds_read_b64_tr_b16 v[148:149], v220 offset:8192
ds_read_b64_tr_b16 v[150:151], v220 offset:12288
v_mfma_f32_16x16x32_bf16 v[76:79], a[88:91], v[152:155], v[76:79]
s_sub_u32 s0, s69, 147456
buffer_store_dwordx4 v[224:227], v1, s[32:35], s50 offen offset:0 sc1
v_mfma_f32_16x16x32_bf16 v[80:83], a[92:95], v[152:155], v[80:83]
s_waitcnt lgkmcnt(4)
v_fma_f32 v27, v27, s90, s90
s_min_u32 s69, s69, s0
v_mfma_f32_16x16x32_bf16 v[84:87], v[156:159], a[80:83], v[84:87]
v_rcp_f32 v27, v27
v_mfma_f32_16x16x32_bf16 v[88:91], v[156:159], a[84:87], v[88:91]
ds_read_b64_tr_b16 v[152:153], v221 offset:8192
ds_read_b64_tr_b16 v[154:155], v221 offset:12288
v_mfma_f32_16x16x32_bf16 v[92:95], v[156:159], a[88:91], v[92:95]
v_mul_f32 v43, v43, v27
v_cvt_pk_bf16_f32 v22, v40, v41
v_mfma_f32_16x16x32_bf16 v[96:99], v[156:159], a[92:95], v[96:99]
s_waitcnt lgkmcnt(4)
v_cvt_pk_bf16_f32 v23, v42, v43
v_mfma_f32_16x16x32_bf16 v[100:103], a[80:83], v[160:163], v[100:103]
v_exp_f32 v28, v28
v_mfma_f32_16x16x32_bf16 v[104:107], a[84:87], v[160:163], v[104:107]
s_waitcnt lgkmcnt(2)
ds_read_b64_tr_b16 v[156:157], v222 offset:8192
ds_read_b64_tr_b16 v[158:159], v222 offset:12288
v_mfma_f32_16x16x32_bf16 v[52:55], a[96:99], v[148:151], v[52:55]
v_fma_f32 v28, v28, s90, s90
v_mfma_f32_16x16x32_bf16 v[56:59], a[100:103], v[148:151], v[56:59]
v_rcp_f32 v28, v28
v_mfma_f32_16x16x32_bf16 v[60:63], a[104:107], v[148:151], v[60:63]
v_mul_f32 v44, v44, v28
v_mfma_f32_16x16x32_bf16 v[64:67], a[108:111], v[148:151], v[64:67]
s_waitcnt lgkmcnt(2)
ds_read_b64_tr_b16 v[160:161], v223 offset:8192
ds_read_b64_tr_b16 v[162:163], v223 offset:12288
v_mfma_f32_16x16x32_bf16 v[68:71], a[96:99], v[152:155], v[68:71]
buffer_store_dwordx4 v[228:231], v1, s[32:35], s50 offen offset:1024 sc1
v_mfma_f32_16x16x32_bf16 v[72:75], a[100:103], v[152:155], v[72:75]
ds_read_b64_tr_b16 v[148:149], v220 offset:16384
ds_read_b64_tr_b16 v[150:151], v220 offset:20480
v_mfma_f32_16x16x32_bf16 v[76:79], a[104:107], v[152:155], v[76:79]
v_exp_f32 v29, v29
v_mfma_f32_16x16x32_bf16 v[80:83], a[108:111], v[152:155], v[80:83]
s_waitcnt lgkmcnt(4)
v_fma_f32 v29, v29, s90, s90
v_mfma_f32_16x16x32_bf16 v[84:87], v[156:159], a[96:99], v[84:87]
v_rcp_f32 v29, v29
v_mfma_f32_16x16x32_bf16 v[88:91], v[156:159], a[100:103], v[88:91]
ds_read_b64_tr_b16 v[152:153], v221 offset:16384
ds_read_b64_tr_b16 v[154:155], v221 offset:20480
v_mfma_f32_16x16x32_bf16 v[92:95], v[156:159], a[104:107], v[92:95]
v_mul_f32 v45, v45, v29
v_cvt_pk_bf16_f32 v24, v44, v45
v_mfma_f32_16x16x32_bf16 v[96:99], v[156:159], a[108:111], v[96:99]
s_waitcnt lgkmcnt(4)
v_exp_f32 v30, v30
v_mfma_f32_16x16x32_bf16 v[100:103], a[96:99], v[160:163], v[100:103]
v_fma_f32 v30, v30, s90, s90
v_mfma_f32_16x16x32_bf16 v[104:107], a[100:103], v[160:163], v[104:107]
s_waitcnt lgkmcnt(2)
ds_read_b64_tr_b16 v[156:157], v222 offset:16384
ds_read_b64_tr_b16 v[158:159], v222 offset:20480
v_mfma_f32_16x16x32_bf16 v[52:55], a[112:115], v[148:151], v[52:55]
v_rcp_f32 v30, v30
v_mfma_f32_16x16x32_bf16 v[56:59], a[116:119], v[148:151], v[56:59]
buffer_load_dwordx4 v1, s[32:35], s67 offen sc1 lds
v_mfma_f32_16x16x32_bf16 v[60:63], a[120:123], v[148:151], v[60:63]
s_add_u32 s67, s69, s70
v_mul_f32 v46, v46, v30
s_add_u32 m0, s72, 49152
v_mfma_f32_16x16x32_bf16 v[64:67], a[124:127], v[148:151], v[64:67]
s_waitcnt lgkmcnt(2)
ds_read_b64_tr_b16 v[160:161], v223 offset:16384
ds_read_b64_tr_b16 v[162:163], v223 offset:20480
v_mfma_f32_16x16x32_bf16 v[68:71], a[112:115], v[152:155], v[68:71]
s_add_u32 s69, s69, 4096
buffer_store_dwordx4 v[232:235], v1, s[32:35], s50 offen offset:2048 sc1
v_mfma_f32_16x16x32_bf16 v[72:75], a[116:119], v[152:155], v[72:75]
s_sub_u32 s0, s69, 147456
ds_read_b64_tr_b16 v[148:149], v220 offset:24576
ds_read_b64_tr_b16 v[150:151], v220 offset:28672
v_mfma_f32_16x16x32_bf16 v[76:79], a[120:123], v[152:155], v[76:79]
s_min_u32 s69, s69, s0
v_add_u32 v220, 4294852608, v220
v_mfma_f32_16x16x32_bf16 v[80:83], a[124:127], v[152:155], v[80:83]
s_waitcnt lgkmcnt(4)
v_exp_f32 v31, v31
v_mfma_f32_16x16x32_bf16 v[84:87], v[156:159], a[112:115], v[84:87]
s_add_u32 s68, s20, 96
v_fma_f32 v31, v31, s90, s90
v_mfma_f32_16x16x32_bf16 v[88:91], v[156:159], a[116:119], v[88:91]
ds_read_b64_tr_b16 v[152:153], v221 offset:24576
ds_read_b64_tr_b16 v[154:155], v221 offset:28672
v_mfma_f32_16x16x32_bf16 v[92:95], v[156:159], a[120:123], v[92:95]
v_add_u32 v221, 4294852608, v221
v_mfma_f32_16x16x32_bf16 v[96:99], v[156:159], a[124:127], v[96:99]
s_waitcnt lgkmcnt(4)
v_rcp_f32 v31, v31
v_mfma_f32_16x16x32_bf16 v[100:103], a[112:115], v[160:163], v[100:103]
v_mul_f32 v47, v47, v31
v_cvt_pk_bf16_f32 v25, v46, v47
v_mfma_f32_16x16x32_bf16 v[104:107], a[116:119], v[160:163], v[104:107]
s_waitcnt lgkmcnt(2)
ds_read_b64_tr_b16 v[156:157], v222 offset:24576
ds_read_b64_tr_b16 v[158:159], v222 offset:28672
v_mfma_f32_16x16x32_bf16 v[52:55], a[128:131], v[148:151], v[52:55]
v_add_u32 v222, 4294852608, v222
v_mfma_f32_16x16x32_bf16 v[56:59], a[132:135], v[148:151], v[56:59]
buffer_load_dwordx4 v1, s[32:35], s67 offen sc1 lds
v_mfma_f32_16x16x32_bf16 v[60:63], a[136:139], v[148:151], v[60:63]
s_add_u32 s67, s69, s70
v_exp_f32 v32, v32
v_mfma_f32_16x16x32_bf16 v[64:67], a[140:143], v[148:151], v[64:67]
s_waitcnt vmcnt(7) lgkmcnt(2)
ds_read_b64_tr_b16 v[160:161], v223 offset:24576
ds_read_b64_tr_b16 v[162:163], v223 offset:28672
v_mfma_f32_16x16x32_bf16 v[68:71], a[128:131], v[152:155], v[68:71]
s_add_u32 m0, s72, 53248
v_add_u32 v223, 4294852608, v223
s_add_u32 s69, s69, 4096
s_barrier
v_mfma_f32_16x16x32_bf16 v[72:75], a[132:135], v[152:155], v[72:75]
s_sub_u32 s0, s69, 147456
ds_read_b64_tr_b16 v[148:149], v220 offset:0
ds_read_b64_tr_b16 v[150:151], v220 offset:4096
v_mfma_f32_16x16x32_bf16 v[76:79], a[136:139], v[152:155], v[76:79]
s_min_u32 s69, s69, s0
buffer_load_dwordx4 v1, s[32:35], s67 offen sc1 lds
v_mfma_f32_16x16x32_bf16 v[80:83], a[140:143], v[152:155], v[80:83]
s_waitcnt lgkmcnt(4)
v_fma_f32 v32, v32, s90, s90
s_add_u32 s67, s69, s70
v_mfma_f32_16x16x32_bf16 v[84:87], v[156:159], a[128:131], v[84:87]
s_add_u32 m0, s72, 57344
v_rcp_f32 v32, v32
v_mfma_f32_16x16x32_bf16 v[88:91], v[156:159], a[132:135], v[88:91]
s_add_u32 s69, s69, 4096
ds_read_b64_tr_b16 v[152:153], v221 offset:0
ds_read_b64_tr_b16 v[154:155], v221 offset:4096
v_mfma_f32_16x16x32_bf16 v[92:95], v[156:159], a[136:139], v[92:95]
s_sub_u32 s0, s69, 147456
buffer_load_dwordx4 v1, s[32:35], s67 offen sc1 lds
v_mfma_f32_16x16x32_bf16 v[96:99], v[156:159], a[140:143], v[96:99]
s_waitcnt lgkmcnt(4)
v_mul_f32 v48, v48, v32
s_min_u32 s69, s69, s0
v_mfma_f32_16x16x32_bf16 v[100:103], a[128:131], v[160:163], v[100:103]
s_add_u32 s67, s69, s70
v_exp_f32 v33, v33
v_mfma_f32_16x16x32_bf16 v[104:107], a[132:135], v[160:163], v[104:107]
s_waitcnt lgkmcnt(2)
ds_read_b64_tr_b16 v[156:157], v222 offset:0
ds_read_b64_tr_b16 v[158:159], v222 offset:4096
v_mfma_f32_16x16x32_bf16 v[52:55], a[144:147], v[148:151], v[52:55]
s_add_u32 m0, s72, 61440
v_fma_f32 v33, v33, s90, s90
s_add_u32 s69, s69, 4096
v_mfma_f32_16x16x32_bf16 v[56:59], a[148:151], v[148:151], v[56:59]
s_sub_u32 s0, s69, 147456
buffer_load_dwordx4 v1, s[32:35], s67 offen sc1 lds
v_mfma_f32_16x16x32_bf16 v[60:63], a[152:155], v[148:151], v[60:63]
s_min_u32 s69, s69, s0
v_rcp_f32 v33, v33
v_mfma_f32_16x16x32_bf16 v[64:67], a[156:159], v[148:151], v[64:67]
s_waitcnt lgkmcnt(2)
ds_read_b64_tr_b16 v[160:161], v223 offset:0
ds_read_b64_tr_b16 v[162:163], v223 offset:4096
v_mfma_f32_16x16x32_bf16 v[68:71], a[144:147], v[152:155], v[68:71]
s_add_u32 s67, s69, s70
v_mul_f32 v49, v49, v33
s_add_u32 m0, s72, 65536
v_mfma_f32_16x16x32_bf16 v[72:75], a[148:151], v[152:155], v[72:75]
s_add_u32 s69, s69, 4096
ds_read_b64_tr_b16 v[148:149], v220 offset:8192
ds_read_b64_tr_b16 v[150:151], v220 offset:12288
v_mfma_f32_16x16x32_bf16 v[76:79], a[152:155], v[152:155], v[76:79]
s_sub_u32 s0, s69, 147456
buffer_load_dwordx4 v1, s[32:35], s67 offen sc1 lds
v_mfma_f32_16x16x32_bf16 v[80:83], a[156:159], v[152:155], v[80:83]
s_waitcnt lgkmcnt(4)
v_exp_f32 v34, v34
v_mfma_f32_16x16x32_bf16 v[84:87], v[156:159], a[144:147], v[84:87]
s_min_u32 s69, s69, s0
v_fma_f32 v34, v34, s90, s90
s_add_u32 s67, s69, s70
v_mfma_f32_16x16x32_bf16 v[88:91], v[156:159], a[148:151], v[88:91]
s_add_u32 m0, s72, 69632
ds_read_b64_tr_b16 v[152:153], v221 offset:8192
ds_read_b64_tr_b16 v[154:155], v221 offset:12288
v_mfma_f32_16x16x32_bf16 v[92:95], v[156:159], a[152:155], v[92:95]
s_mul_i32 s69, s71, 589824
buffer_load_dwordx4 v1, s[32:35], s67 offen sc1 lds
v_mfma_f32_16x16x32_bf16 v[96:99], v[156:159], a[156:159], v[96:99]
s_waitcnt lgkmcnt(4)
v_rcp_f32 v34, v34
v_mfma_f32_16x16x32_bf16 v[100:103], a[144:147], v[160:163], v[100:103]
s_add_u32 m0, s40, 0
v_mul_f32 v50, v50, v34
s_add_u32 s67, s69, 36864
v_mfma_f32_16x16x32_bf16 v[104:107], a[148:151], v[160:163], v[104:107]
s_waitcnt lgkmcnt(2)
ds_read_b64_tr_b16 v[156:157], v222 offset:8192
ds_read_b64_tr_b16 v[158:159], v222 offset:12288
v_mfma_f32_16x16x32_bf16 v[52:55], a[160:163], v[148:151], v[52:55]
buffer_load_dwordx4 v164, s[12:15], s68 offen  lds
v_mfma_f32_16x16x32_bf16 v[56:59], a[164:167], v[148:151], v[56:59]
s_add_u32 m0, s40, 1024
v_exp_f32 v35, v35
v_mfma_f32_16x16x32_bf16 v[60:63], a[168:171], v[148:151], v[60:63]
s_add_u32 s68, s20, 96
v_fma_f32 v35, v35, s90, s90
v_cvt_pk_bf16_f32 v26, v48, v49
v_mfma_f32_16x16x32_bf16 v[64:67], a[172:175], v[148:151], v[64:67]
s_waitcnt lgkmcnt(2)
ds_read_b64_tr_b16 v[160:161], v223 offset:8192
ds_read_b64_tr_b16 v[162:163], v223 offset:12288
v_mfma_f32_16x16x32_bf16 v[68:71], a[160:163], v[152:155], v[68:71]
v_rcp_f32 v35, v35
v_mfma_f32_16x16x32_bf16 v[72:75], a[164:167], v[152:155], v[72:75]
ds_read_b64_tr_b16 v[148:149], v220 offset:16384
ds_read_b64_tr_b16 v[150:151], v220 offset:20480
v_mfma_f32_16x16x32_bf16 v[76:79], a[168:171], v[152:155], v[76:79]
buffer_load_dwordx4 v165, s[12:15], s68 offen  lds
v_mfma_f32_16x16x32_bf16 v[80:83], a[172:175], v[152:155], v[80:83]
s_waitcnt lgkmcnt(4)
v_mul_f32 v51, v51, v35
s_add_u32 m0, s40, 2048
v_mfma_f32_16x16x32_bf16 v[84:87], v[156:159], a[160:163], v[84:87]
s_add_u32 s68, s20, 96
v_cvt_pk_bf16_f32 v27, v50, v51
v_mfma_f32_16x16x32_bf16 v[88:91], v[156:159], a[164:167], v[88:91]
ds_read_b64_tr_b16 v[152:153], v221 offset:16384
ds_read_b64_tr_b16 v[154:155], v221 offset:20480
v_mfma_f32_16x16x32_bf16 v[92:95], v[156:159], a[168:171], v[92:95]
v_mfma_f32_16x16x32_bf16 v[96:99], v[156:159], a[172:175], v[96:99]
s_waitcnt lgkmcnt(4)
buffer_load_dwordx4 v166, s[12:15], s68 offen  lds
v_mfma_f32_16x16x32_bf16 v[100:103], a[160:163], v[160:163], v[100:103]
s_add_u32 m0, s72, 73728
v_mfma_f32_16x16x32_bf16 v[104:107], a[164:167], v[160:163], v[104:107]
s_waitcnt lgkmcnt(2)
ds_read_b64_tr_b16 v[156:157], v222 offset:16384
ds_read_b64_tr_b16 v[158:159], v222 offset:20480
v_mfma_f32_16x16x32_bf16 v[52:55], a[176:179], v[148:151], v[52:55]
v_mfma_f32_16x16x32_bf16 v[56:59], a[180:183], v[148:151], v[56:59]
v_mfma_f32_16x16x32_bf16 v[60:63], a[184:187], v[148:151], v[60:63]
buffer_load_dwordx4 v2, s[16:19], s69 offen  lds
v_mfma_f32_16x16x32_bf16 v[64:67], a[188:191], v[148:151], v[64:67]
s_waitcnt lgkmcnt(2)
ds_read_b64_tr_b16 v[160:161], v223 offset:16384
ds_read_b64_tr_b16 v[162:163], v223 offset:20480
v_mfma_f32_16x16x32_bf16 v[68:71], a[176:179], v[152:155], v[68:71]
s_add_u32 m0, s72, 77824
v_mfma_f32_16x16x32_bf16 v[72:75], a[180:183], v[152:155], v[72:75]
s_add_u32 s69, s69, 294912
ds_read_b64_tr_b16 v[148:149], v220 offset:24576
ds_read_b64_tr_b16 v[150:151], v220 offset:28672
v_mfma_f32_16x16x32_bf16 v[76:79], a[184:187], v[152:155], v[76:79]
s_sub_u32 s0, s69, 5308416
buffer_load_dword v12, v14, s[28:31], 0 offen sc1
v_mfma_f32_16x16x32_bf16 v[80:83], a[188:191], v[152:155], v[80:83]
s_waitcnt lgkmcnt(4)
v_mfma_f32_16x16x32_bf16 v[84:87], v[156:159], a[176:179], v[84:87]
s_min_u32 s69, s69, s0
buffer_load_dwordx4 v2, s[16:19], s67 offen  lds
v_mfma_f32_16x16x32_bf16 v[88:91], v[156:159], a[180:183], v[88:91]
s_add_u32 m0, s72, 81920
ds_read_b64_tr_b16 v[152:153], v221 offset:24576
ds_read_b64_tr_b16 v[154:155], v221 offset:28672
v_mfma_f32_16x16x32_bf16 v[92:95], v[156:159], a[184:187], v[92:95]
s_add_u32 s67, s69, 36864
v_mfma_f32_16x16x32_bf16 v[96:99], v[156:159], a[188:191], v[96:99]
s_waitcnt lgkmcnt(4)
buffer_load_dwordx4 v2, s[16:19], s69 offen  lds
v_mfma_f32_16x16x32_bf16 v[100:103], a[176:179], v[160:163], v[100:103]
s_add_u32 m0, s72, 86016
v_mfma_f32_16x16x32_bf16 v[104:107], a[180:183], v[160:163], v[104:107]
s_waitcnt lgkmcnt(2)
ds_read_b64_tr_b16 v[156:157], v222 offset:24576
ds_read_b64_tr_b16 v[158:159], v222 offset:28672
v_mfma_f32_16x16x32_bf16 v[52:55], a[192:195], v[148:151], v[52:55]
s_add_u32 s69, s69, 294912
buffer_load_dwordx4 v2, s[16:19], s67 offen  lds
v_mfma_f32_16x16x32_bf16 v[56:59], a[196:199], v[148:151], v[56:59]
s_sub_u32 s0, s69, 5308416
v_mfma_f32_16x16x32_bf16 v[60:63], a[200:203], v[148:151], v[60:63]
s_min_u32 s69, s69, s0
v_mfma_f32_16x16x32_bf16 v[64:67], a[204:207], v[148:151], v[64:67]
s_waitcnt vmcnt(8) lgkmcnt(2)
ds_read_b64_tr_b16 v[160:161], v223 offset:24576
ds_read_b64_tr_b16 v[162:163], v223 offset:28672
v_mfma_f32_16x16x32_bf16 v[68:71], a[192:195], v[152:155], v[68:71]
s_add_u32 m0, s72, 90112
s_barrier
v_mfma_f32_16x16x32_bf16 v[72:75], a[196:199], v[152:155], v[72:75]
s_add_u32 s67, s69, 36864
ds_read_b64_tr_b16 v[148:149], v220 offset:32768
ds_read_b64_tr_b16 v[150:151], v220 offset:36864
v_mfma_f32_16x16x32_bf16 v[76:79], a[200:203], v[152:155], v[76:79]
buffer_load_dwordx4 v2, s[16:19], s69 offen  lds
v_mfma_f32_16x16x32_bf16 v[80:83], a[204:207], v[152:155], v[80:83]
s_waitcnt lgkmcnt(4)
v_mfma_f32_16x16x32_bf16 v[84:87], v[156:159], a[192:195], v[84:87]
s_add_u32 m0, s72, 94208
v_mfma_f32_16x16x32_bf16 v[88:91], v[156:159], a[196:199], v[88:91]
s_add_u32 s69, s69, 294912
ds_read_b64_tr_b16 v[152:153], v221 offset:32768
ds_read_b64_tr_b16 v[154:155], v221 offset:36864
v_mfma_f32_16x16x32_bf16 v[92:95], v[156:159], a[200:203], v[92:95]
s_sub_u32 s0, s69, 5308416
buffer_load_dwordx4 v2, s[16:19], s67 offen  lds
v_mfma_f32_16x16x32_bf16 v[96:99], v[156:159], a[204:207], v[96:99]
s_waitcnt lgkmcnt(4)
v_mfma_f32_16x16x32_bf16 v[100:103], a[192:195], v[160:163], v[100:103]
s_min_u32 s69, s69, s0
v_mfma_f32_16x16x32_bf16 v[104:107], a[196:199], v[160:163], v[104:107]
s_waitcnt lgkmcnt(2)
ds_read_b64_tr_b16 v[156:157], v222 offset:32768
ds_read_b64_tr_b16 v[158:159], v222 offset:36864
v_mfma_f32_16x16x32_bf16 v[52:55], a[208:211], v[148:151], v[52:55]
s_add_u32 m0, s72, 98304
v_mfma_f32_16x16x32_bf16 v[56:59], a[212:215], v[148:151], v[56:59]
s_add_u32 s67, s69, 36864
buffer_load_dwordx4 v2, s[16:19], s69 offen  lds
v_mfma_f32_16x16x32_bf16 v[60:63], a[216:219], v[148:151], v[60:63]
s_add_u32 m0, s72, 102400
v_mfma_f32_16x16x32_bf16 v[64:67], a[220:223], v[148:151], v[64:67]
s_waitcnt lgkmcnt(2)
ds_read_b64_tr_b16 v[160:161], v223 offset:32768
ds_read_b64_tr_b16 v[162:163], v223 offset:36864
v_mfma_f32_16x16x32_bf16 v[68:71], a[208:211], v[152:155], v[68:71]
s_add_u32 s69, s69, 294912
buffer_load_dwordx4 v2, s[16:19], s67 offen  lds
v_mfma_f32_16x16x32_bf16 v[72:75], a[212:215], v[152:155], v[72:75]
s_sub_u32 s0, s69, 5308416
ds_read_b64_tr_b16 v[148:149], v220 offset:40960
ds_read_b64_tr_b16 v[150:151], v220 offset:45056
v_mfma_f32_16x16x32_bf16 v[76:79], a[216:219], v[152:155], v[76:79]
s_min_u32 s69, s69, s0
v_mfma_f32_16x16x32_bf16 v[80:83], a[220:223], v[152:155], v[80:83]
s_waitcnt lgkmcnt(4)
v_mfma_f32_16x16x32_bf16 v[84:87], v[156:159], a[208:211], v[84:87]
s_add_u32 m0, s72, 106496
v_mfma_f32_16x16x32_bf16 v[88:91], v[156:159], a[212:215], v[88:91]
s_add_u32 s67, s69, 36864
ds_read_b64_tr_b16 v[152:153], v221 offset:40960
ds_read_b64_tr_b16 v[154:155], v221 offset:45056
v_mfma_f32_16x16x32_bf16 v[92:95], v[156:159], a[216:219], v[92:95]
s_add_u32 s68, s20, 192
buffer_load_dwordx4 v2, s[16:19], s69 offen  lds
v_mfma_f32_16x16x32_bf16 v[96:99], v[156:159], a[220:223], v[96:99]
s_waitcnt lgkmcnt(4)
v_mfma_f32_16x16x32_bf16 v[100:103], a[208:211], v[160:163], v[100:103]
s_add_u32 m0, s72, 110592
v_mfma_f32_16x16x32_bf16 v[104:107], a[212:215], v[160:163], v[104:107]
s_waitcnt lgkmcnt(2)
ds_read_b64_tr_b16 v[156:157], v222 offset:40960
ds_read_b64_tr_b16 v[158:159], v222 offset:45056
v_mfma_f32_16x16x32_bf16 v[52:55], a[224:227], v[148:151], v[52:55]
s_add_u32 s69, s69, 294912
v_mfma_f32_16x16x32_bf16 v[56:59], a[228:231], v[148:151], v[56:59]
s_sub_u32 s0, s69, 5308416
buffer_load_dwordx4 v2, s[16:19], s67 offen  lds
v_mfma_f32_16x16x32_bf16 v[60:63], a[232:235], v[148:151], v[60:63]
s_min_u32 s69, s69, s0
v_mfma_f32_16x16x32_bf16 v[64:67], a[236:239], v[148:151], v[64:67]
s_waitcnt lgkmcnt(2)
ds_read_b64_tr_b16 v[160:161], v223 offset:40960
ds_read_b64_tr_b16 v[162:163], v223 offset:45056
v_mfma_f32_16x16x32_bf16 v[68:71], a[224:227], v[152:155], v[68:71]
s_add_u32 m0, s72, 114688
v_mfma_f32_16x16x32_bf16 v[72:75], a[228:231], v[152:155], v[72:75]
s_add_u32 s67, s69, 36864
ds_read_b64_tr_b16 v[148:149], v220 offset:49152
ds_read_b64_tr_b16 v[150:151], v220 offset:53248
v_mfma_f32_16x16x32_bf16 v[76:79], a[232:235], v[152:155], v[76:79]
s_add_u32 s50, s21, 3072
buffer_load_dwordx4 v2, s[16:19], s69 offen  lds
v_mfma_f32_16x16x32_bf16 v[80:83], a[236:239], v[152:155], v[80:83]
s_waitcnt lgkmcnt(4)
v_add_u32 v220, 57344, v220
s_add_u32 m0, s72, 118784
v_mfma_f32_16x16x32_bf16 v[84:87], v[156:159], a[224:227], v[84:87]
s_add_u32 s69, s69, 294912
v_mfma_f32_16x16x32_bf16 v[88:91], v[156:159], a[228:231], v[88:91]
s_sub_u32 s0, s69, 5308416
ds_read_b64_tr_b16 v[152:153], v221 offset:49152
ds_read_b64_tr_b16 v[154:155], v221 offset:53248
v_mfma_f32_16x16x32_bf16 v[92:95], v[156:159], a[232:235], v[92:95]
s_min_u32 s69, s69, s0
v_add_u32 v221, 57344, v221
v_mfma_f32_16x16x32_bf16 v[96:99], v[156:159], a[236:239], v[96:99]
s_waitcnt lgkmcnt(4)
buffer_load_dwordx4 v2, s[16:19], s67 offen  lds
v_mfma_f32_16x16x32_bf16 v[100:103], a[224:227], v[160:163], v[100:103]
s_add_u32 m0, s72, 122880
v_mfma_f32_16x16x32_bf16 v[104:107], a[228:231], v[160:163], v[104:107]
s_waitcnt lgkmcnt(2)
ds_read_b64_tr_b16 v[156:157], v222 offset:49152
ds_read_b64_tr_b16 v[158:159], v222 offset:53248
v_mfma_f32_16x16x32_bf16 v[52:55], a[240:243], v[148:151], v[52:55]
s_add_u32 s67, s69, 36864
v_add_u32 v222, 57344, v222
v_mfma_f32_16x16x32_bf16 v[56:59], a[244:247], v[148:151], v[56:59]
v_mfma_f32_16x16x32_bf16 v[60:63], a[248:251], v[148:151], v[60:63]
buffer_load_dwordx4 v2, s[16:19], s69 offen  lds
v_mfma_f32_16x16x32_bf16 v[64:67], a[252:255], v[148:151], v[64:67]
s_waitcnt lgkmcnt(2)
ds_read_b64_tr_b16 v[160:161], v223 offset:49152
ds_read_b64_tr_b16 v[162:163], v223 offset:53248
v_mfma_f32_16x16x32_bf16 v[68:71], a[240:243], v[152:155], v[68:71]
s_add_u32 m0, s72, 126976
v_add_u32 v223, 57344, v223
s_add_u32 s69, s69, 294912
v_mfma_f32_16x16x32_bf16 v[72:75], a[244:247], v[152:155], v[72:75]
s_sub_u32 s0, s69, 5308416
ds_read_b64_tr_b16 v[148:149], v220 offset:0
ds_read_b64_tr_b16 v[150:151], v220 offset:4096
v_mfma_f32_16x16x32_bf16 v[76:79], a[248:251], v[152:155], v[76:79]
s_min_u32 s69, s69, s0
v_mfma_f32_16x16x32_bf16 v[80:83], a[252:255], v[152:155], v[80:83]
s_waitcnt lgkmcnt(4)
buffer_load_dwordx4 v2, s[16:19], s67 offen  lds
v_mfma_f32_16x16x32_bf16 v[84:87], v[156:159], a[240:243], v[84:87]
s_add_u32 m0, s72, 131072
v_mfma_f32_16x16x32_bf16 v[88:91], v[156:159], a[244:247], v[88:91]
s_add_u32 s67, s69, 36864
ds_read_b64_tr_b16 v[152:153], v221 offset:0
ds_read_b64_tr_b16 v[154:155], v221 offset:4096
v_mfma_f32_16x16x32_bf16 v[92:95], v[156:159], a[248:251], v[92:95]
v_mfma_f32_16x16x32_bf16 v[96:99], v[156:159], a[252:255], v[96:99]
s_waitcnt lgkmcnt(4)
v_mfma_f32_16x16x32_bf16 v[100:103], a[240:243], v[160:163], v[100:103]
buffer_store_dwordx4 v[20:23], v1, s[32:35], s73 offen sc1
v_mfma_f32_16x16x32_bf16 v[104:107], a[244:247], v[160:163], v[104:107]
s_waitcnt lgkmcnt(2)
ds_read_b64_tr_b16 v[156:157], v222 offset:0
ds_read_b64_tr_b16 v[158:159], v222 offset:4096
v_mfma_f32_16x16x32_bf16 v[52:55], v[168:171], v[148:151], v[52:55]
s_xor_b32 s73, s73, 2048
v_mfma_f32_16x16x32_bf16 v[56:59], v[172:175], v[148:151], v[56:59]
v_mfma_f32_16x16x32_bf16 v[60:63], v[176:179], v[148:151], v[60:63]
v_mfma_f32_16x16x32_bf16 v[64:67], v[180:183], v[148:151], v[64:67]
s_waitcnt lgkmcnt(2)
ds_read_b64_tr_b16 v[160:161], v223 offset:0
ds_read_b64_tr_b16 v[162:163], v223 offset:4096
v_mfma_f32_16x16x32_bf16 v[68:71], v[168:171], v[152:155], v[68:71]
v_mfma_f32_16x16x32_bf16 v[72:75], v[172:175], v[152:155], v[72:75]
ds_read_b64_tr_b16 v[148:149], v220 offset:8192
ds_read_b64_tr_b16 v[150:151], v220 offset:12288
v_mfma_f32_16x16x32_bf16 v[76:79], v[176:179], v[152:155], v[76:79]
v_mfma_f32_16x16x32_bf16 v[80:83], v[180:183], v[152:155], v[80:83]
s_waitcnt vmcnt(14) lgkmcnt(4)
ds_read_b64_tr_b16 v[236:237], v167 offset:0
v_cmp_ge_u32 s[86:87], v12, 16
v_mfma_f32_16x16x32_bf16 v[84:87], v[156:159], v[168:171], v[84:87]
ds_read_b64_tr_b16 v[238:239], v167 offset:1536
ds_read_b64_tr_b16 v[240:241], v167 offset:32
s_cmp_eq_u64 s[86:87], -1
s_cbranch_scc0 L_slow1
L_back1:
v_mfma_f32_16x16x32_bf16 v[88:91], v[156:159], v[172:175], v[88:91]
ds_read_b64_tr_b16 v[152:153], v221 offset:8192
ds_read_b64_tr_b16 v[154:155], v221 offset:12288
v_mfma_f32_16x16x32_bf16 v[92:95], v[156:159], v[176:179], v[92:95]
ds_read_b64_tr_b16 v[242:243], v167 offset:1568
ds_read_b64_tr_b16 v[244:245], v167 offset:64
v_mfma_f32_16x16x32_bf16 v[96:99], v[156:159], v[180:183], v[96:99]
s_waitcnt lgkmcnt(9)
ds_read_b64_tr_b16 v[246:247], v167 offset:1600
v_lshrrev_b32 v14, 2, v0
v_mfma_f32_16x16x32_bf16 v[100:103], v[168:171], v[160:163], v[100:103]
buffer_load_dwordx4 v2, s[16:19], s69 offen  lds
v_mfma_f32_16x16x32_bf16 v[104:107], v[172:175], v[160:163], v[104:107]
s_waitcnt lgkmcnt(8)
ds_read_b64_tr_b16 v[156:157], v222 offset:8192
ds_read_b64_tr_b16 v[158:159], v222 offset:12288
v_mfma_f32_16x16x32_bf16 v[52:55], v[184:187], v[148:151], v[52:55]
s_add_u32 m0, s72, 135168
v_lshlrev_b32 v14, 11, v14
s_add_u32 s69, s69, 294912
v_mfma_f32_16x16x32_bf16 v[56:59], v[188:191], v[148:151], v[56:59]
s_sub_u32 s0, s69, 5308416
buffer_store_dwordx4 v[24:27], v1, s[32:35], s73 offen sc1
v_mfma_f32_16x16x32_bf16 v[60:63], v[192:195], v[148:151], v[60:63]
s_min_u32 s69, s69, s0
v_mfma_f32_16x16x32_bf16 v[64:67], v[196:199], v[148:151], v[64:67]
s_waitcnt lgkmcnt(5)
ds_read_b64_tr_b16 v[160:161], v223 offset:8192
ds_read_b64_tr_b16 v[162:163], v223 offset:12288
v_mfma_f32_16x16x32_bf16 v[68:71], v[184:187], v[152:155], v[68:71]
s_waitcnt lgkmcnt(6)
s_waitcnt vmcnt(8)
s_barrier
v_mfma_f32_16x16x32_bf16 v[72:75], v[188:191], v[152:155], v[72:75]
s_waitcnt lgkmcnt(4)
ds_read_b64_tr_b16 v[148:149], v6 offset:24576
ds_read_b64_tr_b16 v[150:151], v6 offset:28672
v_mfma_f32_16x16x32_bf16 v[76:79], v[192:195], v[152:155], v[76:79]
v_cvt_pk_bf16_f32 v232, v68, v69
v_cvt_pk_bf16_f32 v233, v70, v71
v_mfma_f32_16x16x32_bf16 v[80:83], v[196:199], v[152:155], v[80:83]
s_waitcnt lgkmcnt(4)
v_cvt_pk_bf16_f32 v234, v72, v73
v_cvt_pk_bf16_f32 v235, v74, v75
v_mfma_f32_16x16x32_bf16 v[84:87], v[156:159], v[184:187], v[84:87]
v_exp_f32 v68, -v52 clamp
v_mfma_f32_16x16x32_bf16 v[88:91], v[156:159], v[188:191], v[88:91]
ds_read_b64_tr_b16 v[152:153], v6 offset:26624
ds_read_b64_tr_b16 v[154:155], v6 offset:30720
v_mfma_f32_16x16x32_bf16 v[92:95], v[156:159], v[192:195], v[92:95]
v_max_f32 v52, -v52, s92
v_fma_f32 v52, v52, s91, v68
v_mfma_f32_16x16x32_bf16 v[96:99], v[156:159], v[196:199], v[96:99]
s_waitcnt lgkmcnt(4)
v_exp_f32 v69, -v53 clamp
v_mfma_f32_16x16x32_bf16 v[100:103], v[184:187], v[160:163], v[100:103]
buffer_load_dwordx4 v2, s[16:19], s67 offen  lds
v_mfma_f32_16x16x32_bf16 v[104:107], v[188:191], v[160:163], v[104:107]
s_waitcnt lgkmcnt(2)
ds_read_b64_tr_b16 v[156:157], v7 offset:24576
ds_read_b64_tr_b16 v[158:159], v7 offset:28672
v_mfma_f32_16x16x32_bf16 v[116:119], v[148:151], a[0:3], 0
s_add_u32 m0, s40, 0
v_max_f32 v53, -v53, s92
s_add_u32 s67, s69, 36864
v_mfma_f32_16x16x32_bf16 v[120:123], v[148:151], a[4:7], 0
buffer_load_dwordx4 v164, s[12:15], s68 offen  lds
v_mfma_f32_16x16x32_bf16 v[124:127], v[148:151], a[8:11], 0
s_add_u32 m0, s40, 1024
v_exp_f32 v248, -v100 clamp
v_mfma_f32_16x16x32_bf16 v[128:131], v[148:151], a[12:15], 0
s_waitcnt lgkmcnt(2)
ds_read_b64_tr_b16 v[160:161], v7 offset:26624
ds_read_b64_tr_b16 v[162:163], v7 offset:30720
v_mfma_f32_16x16x32_bf16 v[132:135], v[152:155], a[0:3], 0
s_add_u32 s68, s20, 192
v_max_f32 v108, -v100, s92
v_fma_f32 v108, v108, s91, v248
v_mfma_f32_16x16x32_bf16 v[136:139], v[152:155], a[4:7], 0
v_cndmask_b32 v100, v108, v100, s[78:79]
v_max_f32 v109, -v101, s92
v_mfma_f32_16x16x32_bf16 v[140:143], v[152:155], a[8:11], 0
buffer_load_dwordx4 v165, s[12:15], s68 offen  lds
v_mfma_f32_16x16x32_bf16 v[144:147], v[152:155], a[12:15], 0
s_waitcnt lgkmcnt(2)
ds_read_b64_tr_b16 v[148:149], v6 offset:32768
ds_read_b64_tr_b16 v[150:151], v6 offset:36864
v_mfma_f32_16x16x32_bf16 v[20:23], v[156:159], a[0:3], 0
s_add_u32 m0, s40, 2048
v_exp_f32 v249, -v101 clamp
v_mfma_f32_16x16x32_bf16 v[24:27], v[156:159], a[4:7], 0
s_add_u32 s68, s20, 192
v_fma_f32 v109, v109, s91, v249
v_cndmask_b32 v101, v109, v101, s[78:79]
v_mfma_f32_16x16x32_bf16 v[28:31], v[156:159], a[8:11], 0
s_mov_b32 s20, 0xffff0000
v_exp_f32 v250, -v102 clamp
v_mfma_f32_16x16x32_bf16 v[32:35], v[156:159], a[12:15], 0
s_waitcnt lgkmcnt(2)
ds_read_b64_tr_b16 v[152:153], v6 offset:34816
ds_read_b64_tr_b16 v[154:155], v6 offset:38912
v_mfma_f32_16x16x32_bf16 v[36:39], v[160:163], a[0:3], 0
buffer_load_dwordx4 v166, s[12:15], s68 offen  lds
v_mfma_f32_16x16x32_bf16 v[40:43], v[160:163], a[4:7], 0
s_add_u32 m0, s72, 139264
v_max_f32 v110, -v102, s92
v_fma_f32 v110, v110, s91, v250
v_mfma_f32_16x16x32_bf16 v[44:47], v[160:163], a[8:11], 0
v_cndmask_b32 v102, v110, v102, s[78:79]
v_max_f32 v111, -v103, s92
v_mfma_f32_16x16x32_bf16 v[48:51], v[160:163], a[12:15], 0
s_waitcnt lgkmcnt(2)
ds_read_b64_tr_b16 v[156:157], v7 offset:32768
ds_read_b64_tr_b16 v[158:159], v7 offset:36864
v_mfma_f32_16x16x32_bf16 v[116:119], v[148:151], a[16:19], v[116:119]
v_exp_f32 v251, -v103 clamp
v_mfma_f32_16x16x32_bf16 v[120:123], v[148:151], a[20:23], v[120:123]
buffer_load_dwordx4 v2, s[16:19], s69 offen  lds
v_mfma_f32_16x16x32_bf16 v[124:127], v[148:151], a[24:27], v[124:127]
s_add_u32 m0, s72, 143360
v_fma_f32 v111, v111, s91, v251
s_add_u32 s69, s69, 294912
v_mfma_f32_16x16x32_bf16 v[128:131], v[148:151], a[28:31], v[128:131]
s_waitcnt lgkmcnt(2)
ds_read_b64_tr_b16 v[160:161], v7 offset:34816
ds_read_b64_tr_b16 v[162:163], v7 offset:38912
v_mfma_f32_16x16x32_bf16 v[132:135], v[152:155], a[16:19], v[132:135]
s_sub_u32 s0, s69, 5308416
buffer_load_dwordx4 v2, s[16:19], s67 offen  lds
v_mfma_f32_16x16x32_bf16 v[136:139], v[152:155], a[20:23], v[136:139]
s_min_u32 s69, s69, s0
v_cndmask_b32 v103, v111, v103, s[78:79]
s_add_u32 m0, s72, 0
v_mfma_f32_16x16x32_bf16 v[140:143], v[152:155], a[24:27], v[140:143]
s_add_u32 s67, s69, 36864
v_exp_f32 v252, -v104 clamp
v_mfma_f32_16x16x32_bf16 v[144:147], v[152:155], a[28:31], v[144:147]
s_waitcnt lgkmcnt(2)
ds_read_b64_tr_b16 v[148:149], v6 offset:40960
ds_read_b64_tr_b16 v[150:151], v6 offset:45056
v_mfma_f32_16x16x32_bf16 v[20:23], v[156:159], a[16:19], v[20:23]
buffer_store_dwordx4 v[236:239], v1, s[32:35], s50 offen offset:0 sc1
v_mfma_f32_16x16x32_bf16 v[24:27], v[156:159], a[20:23], v[24:27]
v_max_f32 v112, -v104, s92
v_cvt_pk_bf16_f32 v236, v76, v77
v_cvt_pk_bf16_f32 v237, v78, v79
v_cvt_pk_bf16_f32 v238, v80, v81
v_mfma_f32_16x16x32_bf16 v[28:31], v[156:159], a[24:27], v[28:31]
v_cvt_pk_bf16_f32 v239, v82, v83
v_fma_f32 v112, v112, s91, v252
v_mfma_f32_16x16x32_bf16 v[32:35], v[156:159], a[28:31], v[32:35]
s_waitcnt lgkmcnt(2)
ds_read_b64_tr_b16 v[152:153], v6 offset:43008
ds_read_b64_tr_b16 v[154:155], v6 offset:47104
v_mfma_f32_16x16x32_bf16 v[36:39], v[160:163], a[16:19], v[36:39]
v_cndmask_b32 v104, v112, v104, s[78:79]
v_max_f32 v113, -v105, s92
v_mfma_f32_16x16x32_bf16 v[40:43], v[160:163], a[20:23], v[40:43]
v_exp_f32 v253, -v105 clamp
v_mfma_f32_16x16x32_bf16 v[44:47], v[160:163], a[24:27], v[44:47]
v_fma_f32 v113, v113, s91, v253
v_cndmask_b32 v105, v113, v105, s[78:79]
v_mfma_f32_16x16x32_bf16 v[48:51], v[160:163], a[28:31], v[48:51]
s_waitcnt lgkmcnt(2)
ds_read_b64_tr_b16 v[156:157], v7 offset:40960
ds_read_b64_tr_b16 v[158:159], v7 offset:45056
v_mfma_f32_16x16x32_bf16 v[116:119], v[148:151], a[32:35], v[116:119]
v_exp_f32 v254, -v106 clamp
v_mfma_f32_16x16x32_bf16 v[120:123], v[148:151], a[36:39], v[120:123]
v_max_f32 v114, -v106, s92
v_fma_f32 v114, v114, s91, v254
v_mfma_f32_16x16x32_bf16 v[124:127], v[148:151], a[40:43], v[124:127]
v_cndmask_b32 v106, v114, v106, s[78:79]
v_max_f32 v115, -v107, s92
v_mfma_f32_16x16x32_bf16 v[128:131], v[148:151], a[44:47], v[128:131]
s_waitcnt lgkmcnt(2)
ds_read_b64_tr_b16 v[160:161], v7 offset:43008
ds_read_b64_tr_b16 v[162:163], v7 offset:47104
v_mfma_f32_16x16x32_bf16 v[132:135], v[152:155], a[32:35], v[132:135]
buffer_store_dwordx4 v[240:243], v1, s[32:35], s50 offen offset:1024 sc1
v_mfma_f32_16x16x32_bf16 v[136:139], v[152:155], a[36:39], v[136:139]
v_exp_f32 v255, -v107 clamp
v_cvt_pk_bf16_f32 v240, v100, v101
v_mfma_f32_16x16x32_bf16 v[140:143], v[152:155], a[40:43], v[140:143]
v_cvt_pk_bf16_f32 v241, v102, v103
v_cvt_pk_bf16_f32 v242, v104, v105
v_mfma_f32_16x16x32_bf16 v[144:147], v[152:155], a[44:47], v[144:147]
s_waitcnt lgkmcnt(2)
ds_read_b64_tr_b16 v[148:149], v8 offset:0
ds_read_b64_tr_b16 v[150:151], v8 offset:4096
v_mfma_f32_16x16x32_bf16 v[20:23], v[156:159], a[32:35], v[20:23]
v_fma_f32 v115, v115, s91, v255
v_cndmask_b32 v107, v115, v107, s[78:79]
v_mfma_f32_16x16x32_bf16 v[24:27], v[156:159], a[36:39], v[24:27]
v_cvt_pk_bf16_f32 v243, v106, v107
v_fma_f32 v53, v53, s91, v69
v_mfma_f32_16x16x32_bf16 v[28:31], v[156:159], a[40:43], v[28:31]
ds_write_b64 v16, v[240:241] offset:0
v_mfma_f32_16x16x32_bf16 v[32:35], v[156:159], a[44:47], v[32:35]
s_waitcnt lgkmcnt(3)
ds_read_b64_tr_b16 v[152:153], v8 offset:2048
ds_read_b64_tr_b16 v[154:155], v8 offset:6144
v_mfma_f32_16x16x32_bf16 v[36:39], v[160:163], a[32:35], v[36:39]
ds_write_b64 v16, v[242:243] offset:32
v_mfma_f32_16x16x32_bf16 v[40:43], v[160:163], a[36:39], v[40:43]
v_cndmask_b32 v240, v240, v15, s[80:81]
v_cndmask_b32 v241, v241, v15, s[80:81]
v_mfma_f32_16x16x32_bf16 v[44:47], v[160:163], a[40:43], v[44:47]
v_cndmask_b32 v242, v242, v15, s[80:81]
v_cndmask_b32 v243, v243, v15, s[80:81]
v_mfma_f32_16x16x32_bf16 v[48:51], v[160:163], a[44:47], v[48:51]
s_waitcnt lgkmcnt(4)
ds_read_b64_tr_b16 v[156:157], v9 offset:0
ds_read_b64_tr_b16 v[158:159], v9 offset:4096
v_mfma_f32_16x16x32_bf16 v[116:119], v[148:151], a[48:51], v[116:119]
buffer_store_dwordx4 v[244:247], v1, s[32:35], s50 offen offset:2048 sc1
v_mfma_f32_16x16x32_bf16 v[120:123], v[148:151], a[52:55], v[120:123]
v_add_u32 v15, s40, v1
s_add_u32 s50, s21, 6144
v_mfma_f32_16x16x32_bf16 v[124:127], v[148:151], a[56:59], v[124:127]
s_mov_b32 s21, 0xffff0000
v_cvt_pk_bf16_f32 v224, v52, v53
v_add_u32 v16, s40, v1
v_mfma_f32_16x16x32_bf16 v[128:131], v[148:151], a[60:63], v[128:131]
s_waitcnt lgkmcnt(3)
ds_read_b64_tr_b16 v[160:161], v9 offset:2048
ds_read_b64_tr_b16 v[162:163], v9 offset:6144
v_mfma_f32_16x16x32_bf16 v[132:135], v[152:155], a[48:51], v[132:135]
s_waitcnt vmcnt(3)
ds_read_b64_tr_b16 v[200:201], v167 offset:0
ds_read_b64_tr_b16 v[202:203], v167 offset:1536
v_mfma_f32_16x16x32_bf16 v[136:139], v[152:155], a[52:55], v[136:139]
s_barrier
ds_read_b64_tr_b16 v[204:205], v167 offset:32
ds_read_b64_tr_b16 v[206:207], v167 offset:1568
v_mfma_f32_16x16x32_bf16 v[140:143], v[152:155], a[56:59], v[140:143]
ds_read_b64_tr_b16 v[208:209], v167 offset:64
ds_read_b64_tr_b16 v[210:211], v167 offset:1600
v_mfma_f32_16x16x32_bf16 v[144:147], v[152:155], a[60:63], v[144:147]
s_waitcnt lgkmcnt(8)
ds_read_b64_tr_b16 v[148:149], v8 offset:8192
ds_read_b64_tr_b16 v[150:151], v8 offset:12288
v_mfma_f32_16x16x32_bf16 v[20:23], v[156:159], a[48:51], v[20:23]
v_exp_f32 v70, -v54 clamp
v_mfma_f32_16x16x32_bf16 v[24:27], v[156:159], a[52:55], v[24:27]
v_max_f32 v54, -v54, s92
v_fma_f32 v54, v54, s91, v70
v_mfma_f32_16x16x32_bf16 v[28:31], v[156:159], a[56:59], v[28:31]
s_waitcnt lgkmcnt(6)
v_exp_f32 v71, -v55 clamp
v_mfma_f32_16x16x32_bf16 v[32:35], v[156:159], a[60:63], v[32:35]
s_waitcnt lgkmcnt(4)
ds_read_b64_tr_b16 v[152:153], v8 offset:10240
ds_read_b64_tr_b16 v[154:155], v8 offset:14336
v_mfma_f32_16x16x32_bf16 v[36:39], v[160:163], a[48:51], v[36:39]
s_waitcnt lgkmcnt(4)
buffer_load_dwordx4 v2, s[16:19], s69 offen  lds
v_mfma_f32_16x16x32_bf16 v[40:43], v[160:163], a[52:55], v[40:43]
s_add_u32 m0, s72, 4096
ds_write_b128 v15, v[240:243] offset:2048
v_mfma_f32_16x16x32_bf16 v[44:47], v[160:163], a[56:59], v[44:47]
s_add_u32 s69, s69, 294912
v_max_f32 v55, -v55, s92
s_sub_u32 s0, s69, 5308416
v_mfma_f32_16x16x32_bf16 v[48:51], v[160:163], a[60:63], v[48:51]
s_waitcnt lgkmcnt(3)
ds_read_b64_tr_b16 v[156:157], v9 offset:8192
ds_read_b64_tr_b16 v[158:159], v9 offset:12288
v_mfma_f32_16x16x32_bf16 v[116:119], v[148:151], a[64:67], v[116:119]
s_min_u32 s69, s69, s0
buffer_load_dwordx4 v2, s[16:19], s67 offen  lds
v_mfma_f32_16x16x32_bf16 v[120:123], v[148:151], a[68:71], v[120:123]
s_add_u32 m0, s72, 8192
v_fma_f32 v55, v55, s91, v71
s_add_u32 s67, s69, 36864
v_mfma_f32_16x16x32_bf16 v[124:127], v[148:151], a[72:75], v[124:127]
v_cvt_pk_bf16_f32 v225, v54, v55
v_xor_b32 v15, 4096, v15
v_mfma_f32_16x16x32_bf16 v[128:131], v[148:151], a[76:79], v[128:131]
s_waitcnt lgkmcnt(3)
ds_read_b64_tr_b16 v[160:161], v9 offset:10240
ds_read_b64_tr_b16 v[162:163], v9 offset:14336
v_mfma_f32_16x16x32_bf16 v[132:135], v[152:155], a[64:67], v[132:135]
buffer_load_dwordx4 v2, s[16:19], s69 offen  lds
v_mfma_f32_16x16x32_bf16 v[136:139], v[152:155], a[68:71], v[136:139]
s_add_u32 m0, s72, 12288
v_exp_f32 v72, -v56 clamp
v_mfma_f32_16x16x32_bf16 v[140:143], v[152:155], a[72:75], v[140:143]
s_add_u32 s69, s69, 294912
v_max_f32 v56, -v56, s92
s_sub_u32 s0, s69, 5308416
v_mfma_f32_16x16x32_bf16 v[144:147], v[152:155], a[76:79], v[144:147]
s_waitcnt lgkmcnt(2)
ds_read_b64_tr_b16 v[148:149], v8 offset:16384
ds_read_b64_tr_b16 v[150:151], v8 offset:20480
v_mfma_f32_16x16x32_bf16 v[20:23], v[156:159], a[64:67], v[20:23]
s_min_u32 s69, s69, s0
buffer_load_dwordx4 v2, s[16:19], s67 offen  lds
v_mfma_f32_16x16x32_bf16 v[24:27], v[156:159], a[68:71], v[24:27]
s_add_u32 m0, s72, 16384
v_fma_f32 v56, v56, s91, v72
s_add_u32 s67, s69, 36864
v_mfma_f32_16x16x32_bf16 v[28:31], v[156:159], a[72:75], v[28:31]
v_exp_f32 v73, -v57 clamp
v_mfma_f32_16x16x32_bf16 v[32:35], v[156:159], a[76:79], v[32:35]
s_waitcnt lgkmcnt(2)
ds_read_b64_tr_b16 v[152:153], v8 offset:18432
ds_read_b64_tr_b16 v[154:155], v8 offset:22528
v_mfma_f32_16x16x32_bf16 v[36:39], v[160:163], a[64:67], v[36:39]
buffer_load_dwordx4 v2, s[16:19], s69 offen  lds
v_mfma_f32_16x16x32_bf16 v[40:43], v[160:163], a[68:71], v[40:43]
s_add_u32 m0, s72, 20480
v_max_f32 v57, -v57, s92
s_add_u32 s69, s69, 294912
v_mfma_f32_16x16x32_bf16 v[44:47], v[160:163], a[72:75], v[44:47]
s_sub_u32 s0, s69, 5308416
v_fma_f32 v57, v57, s91, v73
s_min_u32 s69, s69, s0
v_mfma_f32_16x16x32_bf16 v[48:51], v[160:163], a[76:79], v[48:51]
s_waitcnt lgkmcnt(2)
ds_read_b64_tr_b16 v[156:157], v9 offset:16384
ds_read_b64_tr_b16 v[158:159], v9 offset:20480
v_mfma_f32_16x16x32_bf16 v[116:119], v[148:151], a[80:83], v[116:119]
buffer_load_dwordx4 v2, s[16:19], s67 offen  lds
v_mfma_f32_16x16x32_bf16 v[120:123], v[148:151], a[84:87], v[120:123]
s_add_u32 m0, s72, 24576
v_cvt_pk_bf16_f32 v226, v56, v57
s_add_u32 s67, s69, 36864
v_mfma_f32_16x16x32_bf16 v[124:127], v[148:151], a[88:91], v[124:127]
v_exp_f32 v74, -v58 clamp
v_mfma_f32_16x16x32_bf16 v[128:131], v[148:151], a[92:95], v[128:131]
s_waitcnt lgkmcnt(2)
ds_read_b64_tr_b16 v[160:161], v9 offset:18432
ds_read_b64_tr_b16 v[162:163], v9 offset:22528
v_mfma_f32_16x16x32_bf16 v[132:135], v[152:155], a[80:83], v[132:135]
buffer_load_dwordx4 v2, s[16:19], s69 offen  lds
v_mfma_f32_16x16x32_bf16 v[136:139], v[152:155], a[84:87], v[136:139]
s_add_u32 m0, s72, 28672
v_max_f32 v58, -v58, s92
s_add_u32 s69, s69, 294912
v_mfma_f32_16x16x32_bf16 v[140:143], v[152:155], a[88:91], v[140:143]
s_sub_u32 s0, s69, 5308416
v_fma_f32 v58, v58, s91, v74
s_min_u32 s69, s69, s0
v_mfma_f32_16x16x32_bf16 v[144:147], v[152:155], a[92:95], v[144:147]
s_waitcnt lgkmcnt(2)
ds_read_b64_tr_b16 v[148:149], v8 offset:24576
ds_read_b64_tr_b16 v[150:151], v8 offset:28672
v_mfma_f32_16x16x32_bf16 v[20:23], v[156:159], a[80:83], v[20:23]
buffer_load_dwordx4 v2, s[16:19], s67 offen  lds
v_mfma_f32_16x16x32_bf16 v[24:27], v[156:159], a[84:87], v[24:27]
s_add_u32 m0, s72, 32768
v_exp_f32 v75, -v59 clamp
v_mfma_f32_16x16x32_bf16 v[28:31], v[156:159], a[88:91], v[28:31]
s_add_u32 s67, s69, 36864
v_max_f32 v59, -v59, s92
v_fma_f32 v59, v59, s91, v75
v_mfma_f32_16x16x32_bf16 v[32:35], v[156:159], a[92:95], v[32:35]
s_waitcnt lgkmcnt(2)
ds_read_b64_tr_b16 v[152:153], v8 offset:26624
ds_read_b64_tr_b16 v[154:155], v8 offset:30720
v_mfma_f32_16x16x32_bf16 v[36:39], v[160:163], a[80:83], v[36:39]
buffer_load_dwordx4 v2, s[16:19], s69 offen  lds
v_mfma_f32_16x16x32_bf16 v[40:43], v[160:163], a[84:87], v[40:43]
s_add_u32 m0, s72, 36864
v_cvt_pk_bf16_f32 v227, v58, v59
s_add_u32 s69, s69, 294912
v_mfma_f32_16x16x32_bf16 v[44:47], v[160:163], a[88:91], v[44:47]
s_sub_u32 s0, s69, 5308416
v_exp_f32 v68, -v60 clamp
v_mfma_f32_16x16x32_bf16 v[48:51], v[160:163], a[92:95], v[48:51]
s_waitcnt lgkmcnt(2)
ds_read_b64_tr_b16 v[156:157], v9 offset:24576
ds_read_b64_tr_b16 v[158:159], v9 offset:28672
v_mfma_f32_16x16x32_bf16 v[116:119], v[148:151], a[96:99], v[116:119]
s_min_u32 s69, s69, s0
buffer_store_dwordx4 v[200:203], v1, s[32:35], s50 offen offset:0 sc1
v_mfma_f32_16x16x32_bf16 v[120:123], v[148:151], a[100:103], v[120:123]
v_max_f32 v60, -v60, s92
v_fma_f32 v60, v60, s91, v68
v_mfma_f32_16x16x32_bf16 v[124:127], v[148:151], a[104:107], v[124:127]
v_exp_f32 v69, -v61 clamp
v_mfma_f32_16x16x32_bf16 v[128:131], v[148:151], a[108:111], v[128:131]
s_waitcnt lgkmcnt(2)
ds_read_b64_tr_b16 v[160:161], v9 offset:26624
ds_read_b64_tr_b16 v[162:163], v9 offset:30720
v_mfma_f32_16x16x32_bf16 v[132:135], v[152:155], a[96:99], v[132:135]
v_max_f32 v61, -v61, s92
v_fma_f32 v61, v61, s91, v69
v_mfma_f32_16x16x32_bf16 v[136:139], v[152:155], a[100:103], v[136:139]
v_cvt_pk_bf16_f32 v228, v60, v61
v_mfma_f32_16x16x32_bf16 v[140:143], v[152:155], a[104:107], v[140:143]
v_exp_f32 v70, -v62 clamp
v_mfma_f32_16x16x32_bf16 v[144:147], v[152:155], a[108:111], v[144:147]
s_waitcnt lgkmcnt(2)
ds_read_b64_tr_b16 v[148:149], v8 offset:32768
ds_read_b64_tr_b16 v[150:151], v8 offset:36864
v_mfma_f32_16x16x32_bf16 v[20:23], v[156:159], a[96:99], v[20:23]
v_max_f32 v62, -v62, s92
v_fma_f32 v62, v62, s91, v70
v_mfma_f32_16x16x32_bf16 v[24:27], v[156:159], a[100:103], v[24:27]
v_exp_f32 v71, -v63 clamp
v_mfma_f32_16x16x32_bf16 v[28:31], v[156:159], a[104:107], v[28:31]
v_max_f32 v63, -v63, s92
v_fma_f32 v63, v63, s91, v71
v_mfma_f32_16x16x32_bf16 v[32:35], v[156:159], a[108:111], v[32:35]
s_waitcnt lgkmcnt(2)
ds_read_b64_tr_b16 v[152:153], v8 offset:34816
ds_read_b64_tr_b16 v[154:155], v8 offset:38912
v_mfma_f32_16x16x32_bf16 v[36:39], v[160:163], a[96:99], v[36:39]
buffer_store_dwordx4 v[204:207], v1, s[32:35], s50 offen offset:1024 sc1
v_mfma_f32_16x16x32_bf16 v[40:43], v[160:163], a[100:103], v[40:43]
v_cvt_pk_bf16_f32 v229, v62, v63
v_mfma_f32_16x16x32_bf16 v[44:47], v[160:163], a[104:107], v[44:47]
v_exp_f32 v72, -v64 clamp
v_mfma_f32_16x16x32_bf16 v[48:51], v[160:163], a[108:111], v[48:51]
s_waitcnt lgkmcnt(2)
ds_read_b64_tr_b16 v[156:157], v9 offset:32768
ds_read_b64_tr_b16 v[158:159], v9 offset:36864
v_mfma_f32_16x16x32_bf16 v[116:119], v[148:151], a[112:115], v[116:119]
v_max_f32 v64, -v64, s92
v_fma_f32 v64, v64, s91, v72
v_mfma_f32_16x16x32_bf16 v[120:123], v[148:151], a[116:119], v[120:123]
v_exp_f32 v73, -v65 clamp
v_mfma_f32_16x16x32_bf16 v[124:127], v[148:151], a[120:123], v[124:127]
v_max_f32 v65, -v65, s92
v_fma_f32 v65, v65, s91, v73
v_mfma_f32_16x16x32_bf16 v[128:131], v[148:151], a[124:127], v[128:131]
s_waitcnt lgkmcnt(2)
ds_read_b64_tr_b16 v[160:161], v9 offset:34816
ds_read_b64_tr_b16 v[162:163], v9 offset:38912
v_mfma_f32_16x16x32_bf16 v[132:135], v[152:155], a[112:115], v[132:135]
v_cvt_pk_bf16_f32 v230, v64, v65
v_mfma_f32_16x16x32_bf16 v[136:139], v[152:155], a[116:119], v[136:139]
v_exp_f32 v74, -v66 clamp
v_mfma_f32_16x16x32_bf16 v[140:143], v[152:155], a[120:123], v[140:143]
v_max_f32 v66, -v66, s92
v_fma_f32 v66, v66, s91, v74
v_mfma_f32_16x16x32_bf16 v[144:147], v[152:155], a[124:127], v[144:147]
s_waitcnt lgkmcnt(2)
ds_read_b64_tr_b16 v[148:149], v8 offset:40960
ds_read_b64_tr_b16 v[150:151], v8 offset:45056
v_mfma_f32_16x16x32_bf16 v[20:23], v[156:159], a[112:115], v[20:23]
buffer_store_dwordx4 v[208:211], v1, s[32:35], s50 offen offset:2048 sc1
v_mfma_f32_16x16x32_bf16 v[24:27], v[156:159], a[116:119], v[24:27]
v_exp_f32 v75, -v67 clamp
v_mfma_f32_16x16x32_bf16 v[28:31], v[156:159], a[120:123], v[28:31]
v_max_f32 v67, -v67, s92
v_fma_f32 v67, v67, s91, v75
v_mfma_f32_16x16x32_bf16 v[32:35], v[156:159], a[124:127], v[32:35]
s_waitcnt lgkmcnt(2)
ds_read_b64_tr_b16 v[152:153], v8 offset:43008
ds_read_b64_tr_b16 v[154:155], v8 offset:47104
v_mfma_f32_16x16x32_bf16 v[36:39], v[160:163], a[112:115], v[36:39]
v_cvt_pk_bf16_f32 v231, v66, v67
v_mfma_f32_16x16x32_bf16 v[40:43], v[160:163], a[116:119], v[40:43]
v_exp_f32 v68, -v84 clamp
v_mfma_f32_16x16x32_bf16 v[44:47], v[160:163], a[120:123], v[44:47]
v_max_f32 v84, -v84, s92
v_fma_f32 v84, v84, s91, v68
v_mfma_f32_16x16x32_bf16 v[48:51], v[160:163], a[124:127], v[48:51]
s_waitcnt lgkmcnt(2)
ds_read_b64_tr_b16 v[156:157], v9 offset:40960
ds_read_b64_tr_b16 v[158:159], v9 offset:45056
v_mfma_f32_16x16x32_bf16 v[116:119], v[148:151], a[128:131], v[116:119]
v_exp_f32 v69, -v85 clamp
v_mfma_f32_16x16x32_bf16 v[120:123], v[148:151], a[132:135], v[120:123]
v_max_f32 v85, -v85, s92
v_fma_f32 v85, v85, s91, v69
v_mfma_f32_16x16x32_bf16 v[124:127], v[148:151], a[136:139], v[124:127]
v_cvt_pk_bf16_f32 v208, v84, v85
v_mfma_f32_16x16x32_bf16 v[128:131], v[148:151], a[140:143], v[128:131]
s_waitcnt lgkmcnt(2)
ds_read_b64_tr_b16 v[160:161], v9 offset:43008
ds_read_b64_tr_b16 v[162:163], v9 offset:47104
v_mfma_f32_16x16x32_bf16 v[132:135], v[152:155], a[128:131], v[132:135]
s_waitcnt vmcnt(3)
buffer_load_dwordx4 v2, s[16:19], s67 offen  lds
v_mfma_f32_16x16x32_bf16 v[136:139], v[152:155], a[132:135], v[136:139]
s_add_u32 m0, s72, 40960
v_exp_f32 v70, -v86 clamp
v_mfma_f32_16x16x32_bf16 v[140:143], v[152:155], a[136:139], v[140:143]
s_add_u32 s67, s69, 36864
v_max_f32 v86, -v86, s92
v_fma_f32 v86, v86, s91, v70
s_barrier
v_mfma_f32_16x16x32_bf16 v[144:147], v[152:155], a[140:143], v[144:147]
s_waitcnt lgkmcnt(2)
ds_read_b64_tr_b16 v[148:149], v4 offset:0
ds_read_b64_tr_b16 v[150:151], v4 offset:4096
v_mfma_f32_16x16x32_bf16 v[20:23], v[156:159], a[128:131], v[20:23]
buffer_load_dwordx4 v2, s[16:19], s69 offen  lds
v_mfma_f32_16x16x32_bf16 v[24:27], v[156:159], a[132:135], v[24:27]
s_add_u32 m0, s72, 45056
ds_read_b64_tr_b16 v[210:211], v17 offset:0
s_add_u32 s69, s69, 294912
v_mfma_f32_16x16x32_bf16 v[28:31], v[156:159], a[136:139], v[28:31]
s_sub_u32 s0, s69, 5308416
ds_read_b64_tr_b16 v[214:215], v17 offset:32
s_min_u32 s69, s69, s0
v_mfma_f32_16x16x32_bf16 v[32:35], v[156:159], a[140:143], v[32:35]
s_waitcnt lgkmcnt(4)
ds_read_b64_tr_b16 v[152:153], v4 offset:2048
ds_read_b64_tr_b16 v[154:155], v4 offset:6144
v_mfma_f32_16x16x32_bf16 v[36:39], v[160:163], a[128:131], v[36:39]
buffer_load_dwordx4 v2, s[16:19], s67 offen  lds
v_mfma_f32_16x16x32_bf16 v[40:43], v[160:163], a[132:135], v[40:43]
s_add_u32 m0, s72, 49152
ds_read_b128 v[244:247], v15 offset:2048
s_add_u32 s67, s69, 36864
v_mfma_f32_16x16x32_bf16 v[44:47], v[160:163], a[136:139], v[44:47]
v_xor_b32 v17, 4096, v17
v_and_b32 v15, 12, v10
v_mfma_f32_16x16x32_bf16 v[48:51], v[160:163], a[140:143], v[48:51]
s_waitcnt lgkmcnt(5)
ds_read_b64_tr_b16 v[156:157], v5 offset:0
ds_read_b64_tr_b16 v[158:159], v5 offset:4096
v_mfma_f32_16x16x32_bf16 v[116:119], v[148:151], a[144:147], v[116:119]
buffer_load_dwordx4 v2, s[16:19], s69 offen  lds
v_mfma_f32_16x16x32_bf16 v[120:123], v[148:151], a[148:151], v[120:123]
s_add_u32 m0, s72, 53248
ds_read_b64_tr_b16 v[218:219], v17 offset:0
s_add_u32 s69, s69, 294912
v_mfma_f32_16x16x32_bf16 v[124:127], v[148:151], a[152:155], v[124:127]
s_sub_u32 s0, s69, 5308416
ds_read_b64_tr_b16 v[222:223], v17 offset:32
s_min_u32 s69, s69, s0
v_mfma_f32_16x16x32_bf16 v[128:131], v[148:151], a[156:159], v[128:131]
s_waitcnt lgkmcnt(5)
ds_read_b64_tr_b16 v[160:161], v5 offset:2048
ds_read_b64_tr_b16 v[162:163], v5 offset:6144
v_mfma_f32_16x16x32_bf16 v[132:135], v[152:155], a[144:147], v[132:135]
buffer_load_dwordx4 v2, s[16:19], s67 offen  lds
v_mfma_f32_16x16x32_bf16 v[136:139], v[152:155], a[148:151], v[136:139]
s_add_u32 m0, s72, 57344
v_exp_f32 v71, -v87 clamp
v_mfma_f32_16x16x32_bf16 v[140:143], v[152:155], a[152:155], v[140:143]
s_add_u32 s67, s69, 36864
v_max_f32 v87, -v87, s92
v_fma_f32 v87, v87, s91, v71
v_mfma_f32_16x16x32_bf16 v[144:147], v[152:155], a[156:159], v[144:147]
s_waitcnt lgkmcnt(4)
ds_read_b64_tr_b16 v[148:149], v4 offset:8192
ds_read_b64_tr_b16 v[150:151], v4 offset:12288
v_mfma_f32_16x16x32_bf16 v[20:23], v[156:159], a[144:147], v[20:23]
buffer_load_dwordx4 v2, s[16:19], s69 offen  lds
v_mfma_f32_16x16x32_bf16 v[24:27], v[156:159], a[148:151], v[24:27]
s_add_u32 m0, s72, 61440
v_cvt_pk_bf16_f32 v209, v86, v87
s_add_u32 s69, s69, 294912
v_mfma_f32_16x16x32_bf16 v[28:31], v[156:159], a[152:155], v[28:31]
s_sub_u32 s0, s69, 5308416
v_exp_f32 v72, -v88 clamp
v_mfma_f32_16x16x32_bf16 v[32:35], v[156:159], a[156:159], v[32:35]
s_waitcnt lgkmcnt(2)
ds_read_b64_tr_b16 v[152:153], v4 offset:10240
ds_read_b64_tr_b16 v[154:155], v4 offset:14336
v_mfma_f32_16x16x32_bf16 v[36:39], v[160:163], a[144:147], v[36:39]
s_min_u32 s69, s69, s0
buffer_load_dwordx4 v2, s[16:19], s67 offen  lds
v_mfma_f32_16x16x32_bf16 v[40:43], v[160:163], a[148:151], v[40:43]
s_add_u32 m0, s72, 65536
v_max_f32 v88, -v88, s92
s_add_u32 s67, s69, 36864
v_mfma_f32_16x16x32_bf16 v[44:47], v[160:163], a[152:155], v[44:47]
v_fma_f32 v88, v88, s91, v72
v_add_u32 v17, s48, v1
v_mfma_f32_16x16x32_bf16 v[48:51], v[160:163], a[156:159], v[48:51]
s_waitcnt lgkmcnt(2)
ds_read_b64_tr_b16 v[156:157], v5 offset:8192
ds_read_b64_tr_b16 v[158:159], v5 offset:12288
v_mfma_f32_16x16x32_bf16 v[116:119], v[148:151], a[160:163], v[116:119]
s_mul_i32 s48, s66, 4294893568
buffer_load_dwordx4 v2, s[16:19], s69 offen  lds
v_mfma_f32_16x16x32_bf16 v[120:123], v[148:151], a[164:167], v[120:123]
s_add_u32 m0, s72, 69632
v_exp_f32 v73, -v89 clamp
v_mfma_f32_16x16x32_bf16 v[124:127], v[148:151], a[168:171], v[124:127]
s_mul_i32 s69, s71, 589824
v_max_f32 v89, -v89, s92
v_fma_f32 v89, v89, s91, v73
v_mfma_f32_16x16x32_bf16 v[128:131], v[148:151], a[172:175], v[128:131]
s_waitcnt lgkmcnt(2)
ds_read_b64_tr_b16 v[160:161], v5 offset:10240
ds_read_b64_tr_b16 v[162:163], v5 offset:14336
v_mfma_f32_16x16x32_bf16 v[132:135], v[152:155], a[160:163], v[132:135]
s_add_u32 s48, s48, 36864
buffer_load_dwordx4 v2, s[16:19], s67 offen  lds
v_add_u32 v2, 128, v2
v_mfma_f32_16x16x32_bf16 v[136:139], v[152:155], a[164:167], v[136:139]
s_add_u32 m0, s72, 73728
v_cvt_pk_bf16_f32 v212, v88, v89
s_add_u32 s67, s69, 36864
v_mfma_f32_16x16x32_bf16 v[140:143], v[152:155], a[168:171], v[140:143]
v_exp_f32 v74, -v90 clamp
v_mfma_f32_16x16x32_bf16 v[144:147], v[152:155], a[172:175], v[144:147]
s_waitcnt lgkmcnt(2)
buffer_load_dwordx4 v2, s[16:19], s69 offen  lds
v_mfma_f32_16x16x32_bf16 v[20:23], v[156:159], a[160:163], v[20:23]
s_add_u32 m0, s72, 77824
v_max_f32 v90, -v90, s92
s_add_u32 s69, s69, 294912
v_mfma_f32_16x16x32_bf16 v[24:27], v[156:159], a[164:167], v[24:27]
s_sub_u32 s0, s69, 5308416
v_fma_f32 v90, v90, s91, v74
s_min_u32 s69, s69, s0
v_mfma_f32_16x16x32_bf16 v[28:31], v[156:159], a[168:171], v[28:31]
buffer_load_dwordx4 v2, s[16:19], s67 offen  lds
v_mfma_f32_16x16x32_bf16 v[32:35], v[156:159], a[172:175], v[32:35]
s_waitcnt lgkmcnt(0)
v_exp_f32 v75, -v91 clamp
v_mfma_f32_16x16x32_bf16 v[36:39], v[160:163], a[160:163], v[36:39]
s_add_u32 m0, s72, 81920
v_max_f32 v91, -v91, s92
s_add_u32 s67, s69, 36864
v_mfma_f32_16x16x32_bf16 v[40:43], v[160:163], a[164:167], v[40:43]
buffer_load_dwordx4 v2, s[16:19], s69 offen  lds
v_mfma_f32_16x16x32_bf16 v[44:47], v[160:163], a[168:171], v[44:47]
s_add_u32 m0, s72, 86016
v_fma_f32 v91, v91, s91, v75
s_add_u32 s69, s69, 294912
v_mfma_f32_16x16x32_bf16 v[48:51], v[160:163], a[172:175], v[48:51]
s_sub_u32 s0, s69, 5308416
ds_read_b64_tr_b16 v[148:149], v4 offset:16384
ds_read_b64_tr_b16 v[150:151], v4 offset:20480
v_mfma_f32_16x16x32_bf16 v[248:251], v[224:227], v[232:235], 0
s_min_u32 s69, s69, s0
buffer_load_dwordx4 v2, s[16:19], s67 offen  lds
v_mfma_f32_16x16x32_bf16 v[252:255], v[240:243], v[224:227], 0
s_add_u32 m0, s72, 90112
v_cvt_pk_bf16_f32 v213, v90, v91
s_add_u32 s67, s69, 36864
v_mfma_f32_16x16x32_bf16 v[224:227], v[240:243], v[232:235], 0
v_exp_f32 v68, -v92 clamp
v_mfma_f32_16x16x32_bf16 v[232:235], v[240:243], v[240:243], 0
ds_read_b64_tr_b16 v[152:153], v4 offset:18432
ds_read_b64_tr_b16 v[154:155], v4 offset:22528
v_mfma_f32_16x16x32_bf16 v[248:251], v[228:231], v[236:239], v[248:251]
v_max_f32 v92, -v92, s92
v_fma_f32 v92, v92, s91, v68
v_mfma_f32_16x16x32_bf16 v[252:255], v[244:247], v[228:231], v[252:255]
buffer_load_dwordx4 v2, s[16:19], s69 offen  lds
v_mfma_f32_16x16x32_bf16 v[224:227], v[244:247], v[236:239], v[224:227]
s_add_u32 m0, s72, 94208
v_exp_f32 v69, -v93 clamp
v_mfma_f32_16x16x32_bf16 v[232:235], v[244:247], v[244:247], v[232:235]
s_waitcnt lgkmcnt(2)
ds_read_b64_tr_b16 v[156:157], v5 offset:16384
ds_read_b64_tr_b16 v[158:159], v5 offset:20480
v_mfma_f32_16x16x32_bf16 v[116:119], v[148:151], a[176:179], v[116:119]
s_add_u32 s69, s69, 294912
ds_write_b128 v16, v[248:251] offset:0
v_mfma_f32_16x16x32_bf16 v[120:123], v[148:151], a[180:183], v[120:123]
s_sub_u32 s0, s69, 5308416
v_permlane32_swap_b32 v224, v232
s_min_u32 s69, s69, s0
v_mfma_f32_16x16x32_bf16 v[124:127], v[148:151], a[184:187], v[124:127]
buffer_load_dwordx4 v2, s[16:19], s67 offen  lds
v_mfma_f32_16x16x32_bf16 v[128:131], v[148:151], a[188:191], v[128:131]
s_waitcnt lgkmcnt(3)
ds_read_b64_tr_b16 v[160:161], v5 offset:18432
ds_read_b64_tr_b16 v[162:163], v5 offset:22528
v_mfma_f32_16x16x32_bf16 v[132:135], v[152:155], a[176:179], v[132:135]
s_add_u32 m0, s72, 98304
v_permlane32_swap_b32 v225, v233
s_add_u32 s67, s69, 36864
v_mfma_f32_16x16x32_bf16 v[136:139], v[152:155], a[180:183], v[136:139]
v_permlane32_swap_b32 v226, v234
v_permlane32_swap_b32 v227, v235
v_mfma_f32_16x16x32_bf16 v[140:143], v[152:155], a[184:187], v[140:143]
v_cndmask_b32 v252, v224, v252, s[20:21]
v_cndmask_b32 v253, v225, v253, s[20:21]
v_mfma_f32_16x16x32_bf16 v[144:147], v[152:155], a[188:191], v[144:147]
s_waitcnt lgkmcnt(3)
ds_read_b64_tr_b16 v[148:149], v4 offset:24576
ds_read_b64_tr_b16 v[150:151], v4 offset:28672
v_mfma_f32_16x16x32_bf16 v[20:23], v[156:159], a[176:179], v[20:23]
buffer_load_dwordx4 v2, s[16:19], s69 offen  lds
v_mfma_f32_16x16x32_bf16 v[24:27], v[156:159], a[180:183], v[24:27]
s_add_u32 m0, s72, 102400
v_cndmask_b32 v254, v226, v254, s[20:21]
s_add_u32 s69, s69, 294912
v_mfma_f32_16x16x32_bf16 v[28:31], v[156:159], a[184:187], v[28:31]
s_sub_u32 s0, s69, 5308416
v_cndmask_b32 v255, v227, v255, s[20:21]
s_min_u32 s69, s69, s0
v_mfma_f32_16x16x32_bf16 v[32:35], v[156:159], a[188:191], v[32:35]
s_waitcnt lgkmcnt(2)
ds_read_b64_tr_b16 v[152:153], v4 offset:26624
ds_read_b64_tr_b16 v[154:155], v4 offset:30720
v_mfma_f32_16x16x32_bf16 v[36:39], v[160:163], a[176:179], v[36:39]
buffer_load_dwordx4 v2, s[16:19], s67 offen  lds
v_mfma_f32_16x16x32_bf16 v[40:43], v[160:163], a[180:183], v[40:43]
s_add_u32 m0, s72, 106496
ds_write_b128 v16, v[252:255] offset:1024
v_mfma_f32_16x16x32_bf16 v[44:47], v[160:163], a[184:187], v[44:47]
v_max_f32 v93, -v93, s92
v_fma_f32 v93, v93, s91, v69
v_mfma_f32_16x16x32_bf16 v[48:51], v[160:163], a[188:191], v[48:51]
s_waitcnt lgkmcnt(3)
ds_read_b64_tr_b16 v[156:157], v5 offset:24576
ds_read_b64_tr_b16 v[158:159], v5 offset:28672
v_mfma_f32_16x16x32_bf16 v[116:119], v[148:151], a[192:195], v[116:119]
v_cvt_pk_bf16_f32 v216, v92, v93
v_add_u32 v14, v14, v15
v_mfma_f32_16x16x32_bf16 v[120:123], v[148:151], a[196:199], v[120:123]
buffer_load_dwordx4 v2, s[16:19], s69 offen  lds
v_mfma_f32_16x16x32_bf16 v[124:127], v[148:151], a[200:203], v[124:127]
v_exp_f32 v70, -v94 clamp
v_mfma_f32_16x16x32_bf16 v[128:131], v[148:151], a[204:207], v[128:131]
s_waitcnt lgkmcnt(3)
ds_read_b64_tr_b16 v[160:161], v5 offset:26624
ds_read_b64_tr_b16 v[162:163], v5 offset:30720
v_mfma_f32_16x16x32_bf16 v[132:135], v[152:155], a[192:195], v[132:135]
s_waitcnt vmcnt(9) lgkmcnt(4)
v_max_f32 v94, -v94, s92
v_fma_f32 v94, v94, s91, v70
v_mfma_f32_16x16x32_bf16 v[136:139], v[152:155], a[196:199], v[136:139]
s_barrier
v_exp_f32 v71, -v95 clamp
v_mfma_f32_16x16x32_bf16 v[140:143], v[152:155], a[200:203], v[140:143]
s_add_u32 s67, s69, 36864
v_max_f32 v95, -v95, s92
s_add_u32 m0, s72, 110592
v_mfma_f32_16x16x32_bf16 v[144:147], v[152:155], a[204:207], v[144:147]
s_waitcnt lgkmcnt(2)
ds_read_b64_tr_b16 v[148:149], v4 offset:32768
ds_read_b64_tr_b16 v[150:151], v4 offset:36864
v_mfma_f32_16x16x32_bf16 v[20:23], v[156:159], a[192:195], v[20:23]
buffer_load_dwordx4 v2, s[16:19], s67 offen  lds
v_mfma_f32_16x16x32_bf16 v[24:27], v[156:159], a[196:199], v[24:27]
s_add_u32 s69, s69, 294912
v_fma_f32 v95, v95, s91, v71
v_cvt_pk_bf16_f32 v217, v94, v95
v_mfma_f32_16x16x32_bf16 v[28:31], v[156:159], a[200:203], v[28:31]
s_sub_u32 s0, s69, 5308416
v_exp_f32 v72, -v96 clamp
v_mfma_f32_16x16x32_bf16 v[32:35], v[156:159], a[204:207], v[32:35]
s_waitcnt lgkmcnt(2)
ds_read_b64_tr_b16 v[152:153], v4 offset:34816
ds_read_b64_tr_b16 v[154:155], v4 offset:38912
v_mfma_f32_16x16x32_bf16 v[36:39], v[160:163], a[192:195], v[36:39]
s_min_u32 s69, s69, s0
v_max_f32 v96, -v96, s92
s_add_u32 m0, s72, 114688
v_mfma_f32_16x16x32_bf16 v[40:43], v[160:163], a[196:199], v[40:43]
buffer_load_dwordx4 v2, s[16:19], s69 offen  lds
v_mfma_f32_16x16x32_bf16 v[44:47], v[160:163], a[200:203], v[44:47]
s_add_u32 s67, s69, 36864
v_fma_f32 v96, v96, s91, v72
v_mfma_f32_16x16x32_bf16 v[48:51], v[160:163], a[204:207], v[48:51]
s_waitcnt lgkmcnt(2)
ds_read_b64_tr_b16 v[156:157], v5 offset:32768
ds_read_b64_tr_b16 v[158:159], v5 offset:36864
v_mfma_f32_16x16x32_bf16 v[116:119], v[148:151], a[208:211], v[116:119]
s_add_u32 m0, s72, 118784
v_exp_f32 v73, -v97 clamp
v_mfma_f32_16x16x32_bf16 v[120:123], v[148:151], a[212:215], v[120:123]
v_max_f32 v97, -v97, s92
v_fma_f32 v97, v97, s91, v73
v_mfma_f32_16x16x32_bf16 v[124:127], v[148:151], a[216:219], v[124:127]
buffer_load_dwordx4 v2, s[16:19], s67 offen  lds
v_mfma_f32_16x16x32_bf16 v[128:131], v[148:151], a[220:223], v[128:131]
s_waitcnt lgkmcnt(2)
ds_read_b64_tr_b16 v[160:161], v5 offset:34816
ds_read_b64_tr_b16 v[162:163], v5 offset:38912
v_mfma_f32_16x16x32_bf16 v[132:135], v[152:155], a[208:211], v[132:135]
s_add_u32 s69, s69, 294912
v_cvt_pk_bf16_f32 v220, v96, v97
v_lshrrev_b32 v245, 5, v0
v_mfma_f32_16x16x32_bf16 v[136:139], v[152:155], a[212:215], v[136:139]
s_sub_u32 s0, s69, 5308416
v_exp_f32 v74, -v98 clamp
v_mfma_f32_16x16x32_bf16 v[140:143], v[152:155], a[216:219], v[140:143]
s_min_u32 s69, s69, s0
v_max_f32 v98, -v98, s92
s_add_u32 m0, s72, 122880
v_mfma_f32_16x16x32_bf16 v[144:147], v[152:155], a[220:223], v[144:147]
s_waitcnt lgkmcnt(2)
ds_read_b64_tr_b16 v[148:149], v4 offset:40960
ds_read_b64_tr_b16 v[150:151], v4 offset:45056
v_mfma_f32_16x16x32_bf16 v[20:23], v[156:159], a[208:211], v[20:23]
s_add_u32 s67, s69, 36864
buffer_load_dwordx4 v2, s[16:19], s69 offen  lds
v_mfma_f32_16x16x32_bf16 v[24:27], v[156:159], a[212:215], v[24:27]
s_add_u32 m0, s72, 126976
ds_read_b128 v[228:231], v17 offset:0
v_cmp_eq_u32 s[86:87], s65, v245
v_mfma_f32_16x16x32_bf16 v[28:31], v[156:159], a[216:219], v[28:31]
v_fma_f32 v98, v98, s91, v74
v_mov_b32 v244, 2147483648
v_mfma_f32_16x16x32_bf16 v[32:35], v[156:159], a[220:223], v[32:35]
s_waitcnt lgkmcnt(3)
ds_read_b64_tr_b16 v[152:153], v4 offset:43008
ds_read_b64_tr_b16 v[154:155], v4 offset:47104
v_mfma_f32_16x16x32_bf16 v[36:39], v[160:163], a[208:211], v[36:39]
v_exp_f32 v75, -v99 clamp
v_mfma_f32_16x16x32_bf16 v[40:43], v[160:163], a[212:215], v[40:43]
s_add_u32 s69, s69, 294912
buffer_load_dwordx4 v2, s[16:19], s67 offen  lds
v_mfma_f32_16x16x32_bf16 v[44:47], v[160:163], a[216:219], v[44:47]
s_sub_u32 s0, s69, 5308416
ds_read_b128 v[236:239], v17 offset:1024
v_max_f32 v99, -v99, s92
v_mfma_f32_16x16x32_bf16 v[48:51], v[160:163], a[220:223], v[48:51]
s_waitcnt lgkmcnt(4)
ds_read_b64_tr_b16 v[156:157], v5 offset:40960
ds_read_b64_tr_b16 v[158:159], v5 offset:45056
v_mfma_f32_16x16x32_bf16 v[116:119], v[148:151], a[224:227], v[116:119]
s_min_u32 s69, s69, s0
v_cndmask_b32 v244, v244, v1, s[86:87]
s_add_u32 m0, s72, 131072
v_mfma_f32_16x16x32_bf16 v[120:123], v[148:151], a[228:231], v[120:123]
s_waitcnt lgkmcnt(5)
v_fma_f32 v99, v99, s91, v75
v_cvt_pk_bf16_f32 v221, v98, v99
v_mfma_f32_16x16x32_bf16 v[124:127], v[148:151], a[232:235], v[124:127]
s_add_u32 s67, s69, 36864
buffer_load_dwordx4 v2, s[16:19], s69 offen  lds
v_mfma_f32_16x16x32_bf16 v[128:131], v[148:151], a[236:239], v[128:131]
s_waitcnt lgkmcnt(3)
ds_read_b64_tr_b16 v[160:161], v5 offset:43008
ds_read_b64_tr_b16 v[162:163], v5 offset:47104
v_mfma_f32_16x16x32_bf16 v[132:135], v[152:155], a[224:227], v[132:135]
s_add_u32 m0, s72, 135168
v_add_f32 v228, v228, v248
v_add_f32 v229, v229, v249
v_mfma_f32_16x16x32_bf16 v[136:139], v[152:155], a[228:231], v[136:139]
v_add_f32 v230, v230, v250
v_add_f32 v231, v231, v251
v_mfma_f32_16x16x32_bf16 v[140:143], v[152:155], a[232:235], v[140:143]
v_mfma_f32_16x16x32_bf16 v[144:147], v[152:155], a[236:239], v[144:147]
s_waitcnt lgkmcnt(2)
ds_read_b64_tr_b16 v[148:149], v6 offset:0
ds_read_b64_tr_b16 v[150:151], v6 offset:4096
v_mfma_f32_16x16x32_bf16 v[20:23], v[156:159], a[224:227], v[20:23]
s_add_u32 s69, s69, 294912
buffer_load_dwordx4 v2, s[16:19], s67 offen  lds
v_mfma_f32_16x16x32_bf16 v[24:27], v[156:159], a[228:231], v[24:27]
s_sub_u32 s0, s69, 5308416
v_mfma_f32_16x16x32_bf16 v[28:31], v[156:159], a[232:235], v[28:31]
s_min_u32 s69, s69, s0
v_add_f32 v236, v236, v252
s_add_u32 m0, s72, 139264
v_mfma_f32_16x16x32_bf16 v[32:35], v[156:159], a[236:239], v[32:35]
s_waitcnt lgkmcnt(2)
ds_read_b64_tr_b16 v[152:153], v6 offset:2048
ds_read_b64_tr_b16 v[154:155], v6 offset:6144
v_mfma_f32_16x16x32_bf16 v[36:39], v[160:163], a[224:227], v[36:39]
s_add_u32 s67, s69, 36864
v_mfma_f32_16x16x32_bf16 v[40:43], v[160:163], a[228:231], v[40:43]
buffer_load_dwordx4 v2, s[16:19], s69 offen  lds
v_add_f32 v237, v237, v253
v_mfma_f32_16x16x32_bf16 v[44:47], v[160:163], a[232:235], v[44:47]
s_add_u32 m0, s72, 143360
v_mfma_f32_16x16x32_bf16 v[48:51], v[160:163], a[236:239], v[48:51]
s_waitcnt lgkmcnt(2)
ds_read_b64_tr_b16 v[156:157], v7 offset:0
ds_read_b64_tr_b16 v[158:159], v7 offset:4096
v_add_f32 v238, v238, v254
v_mfma_f32_16x16x32_bf16 v[116:119], v[148:151], a[240:243], v[116:119]
v_mfma_f32_16x16x32_bf16 v[120:123], v[148:151], a[244:247], v[120:123]
v_mfma_f32_16x16x32_bf16 v[124:127], v[148:151], a[248:251], v[124:127]
buffer_store_dwordx4 v[228:231], v244, s[32:35], s22 offen offset:0 sc1
v_add_f32 v239, v239, v255
v_mfma_f32_16x16x32_bf16 v[128:131], v[148:151], a[252:255], v[128:131]
s_waitcnt lgkmcnt(2)
ds_read_b64_tr_b16 v[160:161], v7 offset:2048
ds_read_b64_tr_b16 v[162:163], v7 offset:6144
v_mfma_f32_16x16x32_bf16 v[132:135], v[152:155], a[240:243], v[132:135]
v_mfma_f32_16x16x32_bf16 v[136:139], v[152:155], a[244:247], v[136:139]
v_mfma_f32_16x16x32_bf16 v[140:143], v[152:155], a[248:251], v[140:143]
v_mfma_f32_16x16x32_bf16 v[144:147], v[152:155], a[252:255], v[144:147]
s_waitcnt lgkmcnt(2)
ds_read_b64_tr_b16 v[148:149], v6 offset:8192
ds_read_b64_tr_b16 v[150:151], v6 offset:12288
v_mfma_f32_16x16x32_bf16 v[20:23], v[156:159], a[240:243], v[20:23]
v_mfma_f32_16x16x32_bf16 v[24:27], v[156:159], a[244:247], v[24:27]
v_mfma_f32_16x16x32_bf16 v[28:31], v[156:159], a[248:251], v[28:31]
v_mfma_f32_16x16x32_bf16 v[32:35], v[156:159], a[252:255], v[32:35]
s_waitcnt lgkmcnt(2)
ds_read_b64_tr_b16 v[152:153], v6 offset:10240
ds_read_b64_tr_b16 v[154:155], v6 offset:14336
v_mfma_f32_16x16x32_bf16 v[36:39], v[160:163], a[240:243], v[36:39]
v_mfma_f32_16x16x32_bf16 v[40:43], v[160:163], a[244:247], v[40:43]
v_mfma_f32_16x16x32_bf16 v[44:47], v[160:163], a[248:251], v[44:47]
v_mfma_f32_16x16x32_bf16 v[48:51], v[160:163], a[252:255], v[48:51]
s_waitcnt lgkmcnt(2)
ds_read_b64_tr_b16 v[156:157], v7 offset:8192
ds_read_b64_tr_b16 v[158:159], v7 offset:12288
v_mfma_f32_16x16x32_bf16 v[116:119], v[148:151], v[168:171], v[116:119]
v_mfma_f32_16x16x32_bf16 v[120:123], v[148:151], v[172:175], v[120:123]
v_mfma_f32_16x16x32_bf16 v[124:127], v[148:151], v[176:179], v[124:127]
v_mfma_f32_16x16x32_bf16 v[128:131], v[148:151], v[180:183], v[128:131]
s_waitcnt lgkmcnt(2)
ds_read_b64_tr_b16 v[160:161], v7 offset:10240
ds_read_b64_tr_b16 v[162:163], v7 offset:14336
v_mfma_f32_16x16x32_bf16 v[132:135], v[152:155], v[168:171], v[132:135]
buffer_store_dwordx4 v[236:239], v244, s[32:35], s22 offen offset:1024 sc1
v_mfma_f32_16x16x32_bf16 v[136:139], v[152:155], v[172:175], v[136:139]
v_mfma_f32_16x16x32_bf16 v[140:143], v[152:155], v[176:179], v[140:143]
v_mfma_f32_16x16x32_bf16 v[144:147], v[152:155], v[180:183], v[144:147]
s_waitcnt lgkmcnt(2)
ds_read_b64_tr_b16 v[148:149], v6 offset:16384
ds_read_b64_tr_b16 v[150:151], v6 offset:20480
v_mfma_f32_16x16x32_bf16 v[20:23], v[156:159], v[168:171], v[20:23]
v_mfma_f32_16x16x32_bf16 v[24:27], v[156:159], v[172:175], v[24:27]
v_mfma_f32_16x16x32_bf16 v[28:31], v[156:159], v[176:179], v[28:31]
v_mfma_f32_16x16x32_bf16 v[32:35], v[156:159], v[180:183], v[32:35]
s_waitcnt lgkmcnt(2)
ds_read_b64_tr_b16 v[152:153], v6 offset:18432
ds_read_b64_tr_b16 v[154:155], v6 offset:22528
v_mfma_f32_16x16x32_bf16 v[36:39], v[160:163], v[168:171], v[36:39]
v_mfma_f32_16x16x32_bf16 v[40:43], v[160:163], v[172:175], v[40:43]
v_mfma_f32_16x16x32_bf16 v[44:47], v[160:163], v[176:179], v[44:47]
v_mfma_f32_16x16x32_bf16 v[48:51], v[160:163], v[180:183], v[48:51]
s_waitcnt lgkmcnt(2)
ds_read_b64_tr_b16 v[156:157], v7 offset:16384
ds_read_b64_tr_b16 v[158:159], v7 offset:20480
v_mfma_f32_16x16x32_bf16 v[116:119], v[148:151], v[184:187], v[116:119]
buffer_load_dwordx4 v2, s[16:19], s67 offen  lds
v_mfma_f32_16x16x32_bf16 v[120:123], v[148:151], v[188:191], v[120:123]
v_mfma_f32_16x16x32_bf16 v[124:127], v[148:151], v[192:195], v[124:127]
v_mfma_f32_16x16x32_bf16 v[128:131], v[148:151], v[196:199], v[128:131]
s_waitcnt lgkmcnt(2)
ds_read_b64_tr_b16 v[160:161], v7 offset:18432
ds_read_b64_tr_b16 v[162:163], v7 offset:22528
v_mfma_f32_16x16x32_bf16 v[132:135], v[152:155], v[184:187], v[132:135]
s_waitcnt vmcnt(11)
v_exp_f32 v116, v116
v_mfma_f32_16x16x32_bf16 v[136:139], v[152:155], v[188:191], v[136:139]
s_barrier
v_fma_f32 v116, v116, s90, s90
v_mfma_f32_16x16x32_bf16 v[140:143], v[152:155], v[192:195], v[140:143]
s_add_u32 s69, s69, 294912
v_rcp_f32 v116, v116
v_mfma_f32_16x16x32_bf16 v[144:147], v[152:155], v[196:199], v[144:147]
s_waitcnt lgkmcnt(2)
ds_read_b64_tr_b16 v[148:149], v6 offset:24576
ds_read_b64_tr_b16 v[150:151], v6 offset:28672
v_mfma_f32_16x16x32_bf16 v[20:23], v[156:159], v[184:187], v[20:23]
s_sub_u32 s0, s69, 5308416
v_mul_f32 v132, v132, v116
s_min_u32 s69, s69, s0
v_mfma_f32_16x16x32_bf16 v[24:27], v[156:159], v[188:191], v[24:27]
s_add_u32 m0, s72, 0
v_exp_f32 v117, v117
v_mfma_f32_16x16x32_bf16 v[28:31], v[156:159], v[192:195], v[28:31]
s_add_u32 s67, s69, 36864
buffer_load_dwordx4 v2, s[16:19], s69 offen  lds
v_mfma_f32_16x16x32_bf16 v[32:35], v[156:159], v[196:199], v[32:35]
s_waitcnt lgkmcnt(2)
ds_read_b64_tr_b16 v[152:153], v6 offset:26624
ds_read_b64_tr_b16 v[154:155], v6 offset:30720
v_mfma_f32_16x16x32_bf16 v[36:39], v[160:163], v[184:187], v[36:39]
s_add_u32 m0, s72, 4096
v_fma_f32 v117, v117, s90, s90
v_mfma_f32_16x16x32_bf16 v[40:43], v[160:163], v[188:191], v[40:43]
v_rcp_f32 v117, v117
v_mfma_f32_16x16x32_bf16 v[44:47], v[160:163], v[192:195], v[44:47]
s_add_u32 s69, s69, 294912
v_mul_f32 v133, v133, v117
v_cvt_pk_bf16_f32 v116, v132, v133
v_mfma_f32_16x16x32_bf16 v[48:51], v[160:163], v[196:199], v[48:51]
s_waitcnt lgkmcnt(2)
ds_read_b64_tr_b16 v[156:157], v7 offset:24576
ds_read_b64_tr_b16 v[158:159], v7 offset:28672
v_mfma_f32_16x16x32_bf16 v[52:55], v[148:151], a[0:3], 0
s_sub_u32 s0, s69, 5308416
buffer_load_dwordx4 v2, s[16:19], s67 offen  lds
v_mfma_f32_16x16x32_bf16 v[56:59], v[148:151], a[4:7], 0
s_min_u32 s69, s69, s0
v_exp_f32 v118, v118
v_mfma_f32_16x16x32_bf16 v[60:63], v[148:151], a[8:11], 0
s_add_u32 m0, s72, 8192
v_fma_f32 v118, v118, s90, s90
v_mfma_f32_16x16x32_bf16 v[64:67], v[148:151], a[12:15], 0
s_waitcnt lgkmcnt(2)
ds_read_b64_tr_b16 v[160:161], v7 offset:26624
ds_read_b64_tr_b16 v[162:163], v7 offset:30720
v_mfma_f32_16x16x32_bf16 v[68:71], v[152:155], a[0:3], 0
s_add_u32 s67, s69, 36864
v_rcp_f32 v118, v118
v_mfma_f32_16x16x32_bf16 v[72:75], v[152:155], a[4:7], 0
buffer_load_dwordx4 v2, s[16:19], s69 offen  lds
v_mfma_f32_16x16x32_bf16 v[76:79], v[152:155], a[8:11], 0
s_add_u32 m0, s72, 12288
v_mul_f32 v134, v134, v118
v_mfma_f32_16x16x32_bf16 v[80:83], v[152:155], a[12:15], 0
s_waitcnt lgkmcnt(2)
ds_read_b64_tr_b16 v[148:149], v6 offset:32768
ds_read_b64_tr_b16 v[150:151], v6 offset:36864
v_mfma_f32_16x16x32_bf16 v[84:87], v[156:159], a[0:3], 0
s_add_u32 s69, s69, 294912
v_exp_f32 v119, v119
v_mfma_f32_16x16x32_bf16 v[88:91], v[156:159], a[4:7], 0
s_sub_u32 s0, s69, 5308416
v_fma_f32 v119, v119, s90, s90
v_mfma_f32_16x16x32_bf16 v[92:95], v[156:159], a[8:11], 0
s_min_u32 s69, s69, s0
buffer_load_dwordx4 v2, s[16:19], s67 offen  lds
v_mfma_f32_16x16x32_bf16 v[96:99], v[156:159], a[12:15], 0
s_waitcnt lgkmcnt(2)
ds_read_b64_tr_b16 v[152:153], v6 offset:34816
ds_read_b64_tr_b16 v[154:155], v6 offset:38912
v_mfma_f32_16x16x32_bf16 v[100:103], v[160:163], a[0:3], 0
s_add_u32 m0, s72, 16384
v_rcp_f32 v119, v119
v_mfma_f32_16x16x32_bf16 v[104:107], v[160:163], a[4:7], 0
s_add_u32 s67, s69, 36864
v_mul_f32 v135, v135, v119
v_cvt_pk_bf16_f32 v117, v134, v135
v_mfma_f32_16x16x32_bf16 v[108:111], v[160:163], a[8:11], 0
v_exp_f32 v120, v120
v_mfma_f32_16x16x32_bf16 v[112:115], v[160:163], a[12:15], 0
s_waitcnt lgkmcnt(2)
ds_read_b64_tr_b16 v[156:157], v7 offset:32768
ds_read_b64_tr_b16 v[158:159], v7 offset:36864
v_mfma_f32_16x16x32_bf16 v[52:55], v[148:151], a[16:19], v[52:55]
buffer_load_dwordx4 v2, s[16:19], s69 offen  lds
v_mfma_f32_16x16x32_bf16 v[56:59], v[148:151], a[20:23], v[56:59]
s_add_u32 m0, s72, 20480
v_fma_f32 v120, v120, s90, s90
v_mfma_f32_16x16x32_bf16 v[60:63], v[148:151], a[24:27], v[60:63]
s_add_u32 s69, s69, 294912
v_rcp_f32 v120, v120
v_mfma_f32_16x16x32_bf16 v[64:67], v[148:151], a[28:31], v[64:67]
s_waitcnt lgkmcnt(2)
ds_read_b64_tr_b16 v[160:161], v7 offset:34816
ds_read_b64_tr_b16 v[162:163], v7 offset:38912
v_mfma_f32_16x16x32_bf16 v[68:71], v[152:155], a[16:19], v[68:71]
s_sub_u32 s0, s69, 5308416
v_mul_f32 v136, v136, v120
s_min_u32 s69, s69, s0
v_mfma_f32_16x16x32_bf16 v[72:75], v[152:155], a[20:23], v[72:75]
buffer_load_dwordx4 v2, s[16:19], s67 offen  lds
v_mfma_f32_16x16x32_bf16 v[76:79], v[152:155], a[24:27], v[76:79]
s_add_u32 m0, s72, 24576
v_exp_f32 v121, v121
v_mfma_f32_16x16x32_bf16 v[80:83], v[152:155], a[28:31], v[80:83]
s_waitcnt lgkmcnt(2)
ds_read_b64_tr_b16 v[148:149], v6 offset:40960
ds_read_b64_tr_b16 v[150:151], v6 offset:45056
v_mfma_f32_16x16x32_bf16 v[84:87], v[156:159], a[16:19], v[84:87]
s_add_u32 s67, s69, 36864
v_fma_f32 v121, v121, s90, s90
v_mfma_f32_16x16x32_bf16 v[88:91], v[156:159], a[20:23], v[88:91]
v_rcp_f32 v121, v121
v_mfma_f32_16x16x32_bf16 v[92:95], v[156:159], a[24:27], v[92:95]
buffer_load_dwordx4 v2, s[16:19], s69 offen  lds
v_mfma_f32_16x16x32_bf16 v[96:99], v[156:159], a[28:31], v[96:99]
s_waitcnt lgkmcnt(2)
ds_read_b64_tr_b16 v[152:153], v6 offset:43008
ds_read_b64_tr_b16 v[154:155], v6 offset:47104
v_mfma_f32_16x16x32_bf16 v[100:103], v[160:163], a[16:19], v[100:103]
s_add_u32 m0, s72, 28672
v_mul_f32 v137, v137, v121
v_cvt_pk_bf16_f32 v120, v136, v137
v_mfma_f32_16x16x32_bf16 v[104:107], v[160:163], a[20:23], v[104:107]
s_add_u32 s69, s69, 294912
v_exp_f32 v122, v122
v_mfma_f32_16x16x32_bf16 v[108:111], v[160:163], a[24:27], v[108:111]
s_sub_u32 s0, s69, 5308416
v_fma_f32 v122, v122, s90, s90
s_min_u32 s69, s69, s0
v_mfma_f32_16x16x32_bf16 v[112:115], v[160:163], a[28:31], v[112:115]
s_waitcnt lgkmcnt(2)
ds_read_b64_tr_b16 v[156:157], v7 offset:40960
ds_read_b64_tr_b16 v[158:159], v7 offset:45056
v_mfma_f32_16x16x32_bf16 v[52:55], v[148:151], a[32:35], v[52:55]
buffer_load_dwordx4 v2, s[16:19], s67 offen  lds
v_mfma_f32_16x16x32_bf16 v[56:59], v[148:151], a[36:39], v[56:59]
s_add_u32 m0, s72, 32768
v_rcp_f32 v122, v122
v_mfma_f32_16x16x32_bf16 v[60:63], v[148:151], a[40:43], v[60:63]
v_mul_f32 v138, v138, v122
v_mfma_f32_16x16x32_bf16 v[64:67], v[148:151], a[44:47], v[64:67]
s_waitcnt lgkmcnt(2)
ds_read_b64_tr_b16 v[160:161], v7 offset:43008
ds_read_b64_tr_b16 v[162:163], v7 offset:47104
v_mfma_f32_16x16x32_bf16 v[68:71], v[152:155], a[32:35], v[68:71]
v_exp_f32 v123, v123
v_mfma_f32_16x16x32_bf16 v[72:75], v[152:155], a[36:39], v[72:75]
buffer_load_dwordx4 v2, s[16:19], s69 offen  lds
v_mfma_f32_16x16x32_bf16 v[76:79], v[152:155], a[40:43], v[76:79]
v_fma_f32 v123, v123, s90, s90
v_mfma_f32_16x16x32_bf16 v[80:83], v[152:155], a[44:47], v[80:83]
s_waitcnt lgkmcnt(2)
ds_read_b64_tr_b16 v[148:149], v8 offset:0
ds_read_b64_tr_b16 v[150:151], v8 offset:4096
v_mfma_f32_16x16x32_bf16 v[84:87], v[156:159], a[32:35], v[84:87]
v_rcp_f32 v123, v123
v_mfma_f32_16x16x32_bf16 v[88:91], v[156:159], a[36:39], v[88:91]
v_mul_f32 v139, v139, v123
v_cvt_pk_bf16_f32 v121, v138, v139
v_mfma_f32_16x16x32_bf16 v[92:95], v[156:159], a[40:43], v[92:95]
v_exp_f32 v124, v124
v_mfma_f32_16x16x32_bf16 v[96:99], v[156:159], a[44:47], v[96:99]
s_waitcnt lgkmcnt(2)
ds_read_b64_tr_b16 v[152:153], v8 offset:2048
ds_read_b64_tr_b16 v[154:155], v8 offset:6144
v_mfma_f32_16x16x32_bf16 v[100:103], v[160:163], a[32:35], v[100:103]
v_fma_f32 v124, v124, s90, s90
v_mfma_f32_16x16x32_bf16 v[104:107], v[160:163], a[36:39], v[104:107]
v_rcp_f32 v124, v124
v_mfma_f32_16x16x32_bf16 v[108:111], v[160:163], a[40:43], v[108:111]
v_mul_f32 v140, v140, v124
v_mfma_f32_16x16x32_bf16 v[112:115], v[160:163], a[44:47], v[112:115]
s_waitcnt lgkmcnt(2)
ds_read_b64_tr_b16 v[156:157], v9 offset:0
ds_read_b64_tr_b16 v[158:159], v9 offset:4096
v_mfma_f32_16x16x32_bf16 v[52:55], v[148:151], a[48:51], v[52:55]
v_mov_b32 v12, 1
v_mfma_f32_16x16x32_bf16 v[56:59], v[148:151], a[52:55], v[56:59]
v_exp_f32 v125, v125
v_mfma_f32_16x16x32_bf16 v[60:63], v[148:151], a[56:59], v[60:63]
v_fma_f32 v125, v125, s90, s90
v_mfma_f32_16x16x32_bf16 v[64:67], v[148:151], a[60:63], v[64:67]
s_waitcnt lgkmcnt(2)
ds_read_b64_tr_b16 v[160:161], v9 offset:2048
ds_read_b64_tr_b16 v[162:163], v9 offset:6144
v_mfma_f32_16x16x32_bf16 v[68:71], v[152:155], a[48:51], v[68:71]
s_waitcnt vmcnt(9)
buffer_store_dword v12, v13, s[32:35], s77 offen sc1
v_mfma_f32_16x16x32_bf16 v[72:75], v[152:155], a[52:55], v[72:75]
s_barrier
v_rcp_f32 v125, v125
v_mfma_f32_16x16x32_bf16 v[76:79], v[152:155], a[56:59], v[76:79]
s_add_u32 s67, s69, 36864
v_mul_f32 v141, v141, v125
s_add_u32 m0, s72, 36864
v_mfma_f32_16x16x32_bf16 v[80:83], v[152:155], a[60:63], v[80:83]
s_waitcnt lgkmcnt(2)
ds_read_b64_tr_b16 v[148:149], v8 offset:8192
ds_read_b64_tr_b16 v[150:151], v8 offset:12288
v_mfma_f32_16x16x32_bf16 v[84:87], v[156:159], a[48:51], v[84:87]
v_exp_f32 v126, v126
v_mfma_f32_16x16x32_bf16 v[88:91], v[156:159], a[52:55], v[88:91]
s_add_u32 s69, s69, 294912
v_fma_f32 v126, v126, s90, s90
v_cvt_pk_bf16_f32 v124, v140, v141
v_mfma_f32_16x16x32_bf16 v[92:95], v[156:159], a[56:59], v[92:95]
s_sub_u32 s0, s69, 5308416
v_rcp_f32 v126, v126
v_mfma_f32_16x16x32_bf16 v[96:99], v[156:159], a[60:63], v[96:99]
s_waitcnt lgkmcnt(2)
ds_read_b64_tr_b16 v[152:153], v8 offset:10240
ds_read_b64_tr_b16 v[154:155], v8 offset:14336
v_mfma_f32_16x16x32_bf16 v[100:103], v[160:163], a[48:51], v[100:103]
s_min_u32 s69, s69, s0
buffer_load_dwordx4 v2, s[16:19], s67 offen  lds
v_mfma_f32_16x16x32_bf16 v[104:107], v[160:163], a[52:55], v[104:107]
s_add_u32 m0, s72, 40960
v_mul_f32 v142, v142, v126
v_mfma_f32_16x16x32_bf16 v[108:111], v[160:163], a[56:59], v[108:111]
s_add_u32 s67, s69, 36864
v_exp_f32 v127, v127
v_mfma_f32_16x16x32_bf16 v[112:115], v[160:163], a[60:63], v[112:115]
s_waitcnt lgkmcnt(2)
ds_read_b64_tr_b16 v[156:157], v9 offset:8192
ds_read_b64_tr_b16 v[158:159], v9 offset:12288
v_mfma_f32_16x16x32_bf16 v[52:55], v[148:151], a[64:67], v[52:55]
v_fma_f32 v127, v127, s90, s90
v_mfma_f32_16x16x32_bf16 v[56:59], v[148:151], a[68:71], v[56:59]
buffer_load_dwordx4 v2, s[16:19], s69 offen  lds
v_mfma_f32_16x16x32_bf16 v[60:63], v[148:151], a[72:75], v[60:63]
s_add_u32 m0, s72, 45056
v_rcp_f32 v127, v127
v_mfma_f32_16x16x32_bf16 v[64:67], v[148:151], a[76:79], v[64:67]
s_waitcnt lgkmcnt(2)
ds_read_b64_tr_b16 v[160:161], v9 offset:10240
ds_read_b64_tr_b16 v[162:163], v9 offset:14336
v_mfma_f32_16x16x32_bf16 v[68:71], v[152:155], a[64:67], v[68:71]
s_add_u32 s69, s69, 294912
v_mul_f32 v143, v143, v127
v_cvt_pk_bf16_f32 v125, v142, v143
v_mfma_f32_16x16x32_bf16 v[72:75], v[152:155], a[68:71], v[72:75]
s_sub_u32 s0, s69, 5308416
v_exp_f32 v128, v128
v_mfma_f32_16x16x32_bf16 v[76:79], v[152:155], a[72:75], v[76:79]
s_min_u32 s69, s69, s0
buffer_load_dwordx4 v2, s[16:19], s67 offen  lds
v_mfma_f32_16x16x32_bf16 v[80:83], v[152:155], a[76:79], v[80:83]
s_waitcnt lgkmcnt(2)
ds_read_b64_tr_b16 v[148:149], v8 offset:16384
ds_read_b64_tr_b16 v[150:151], v8 offset:20480
v_mfma_f32_16x16x32_bf16 v[84:87], v[156:159], a[64:67], v[84:87]
s_add_u32 m0, s72, 49152
v_fma_f32 v128, v128, s90, s90
v_mfma_f32_16x16x32_bf16 v[88:91], v[156:159], a[68:71], v[88:91]
s_add_u32 s67, s69, 36864
v_rcp_f32 v128, v128
v_mfma_f32_16x16x32_bf16 v[92:95], v[156:159], a[72:75], v[92:95]
v_mul_f32 v144, v144, v128
v_mfma_f32_16x16x32_bf16 v[96:99], v[156:159], a[76:79], v[96:99]
s_waitcnt lgkmcnt(2)
ds_read_b64_tr_b16 v[152:153], v8 offset:18432
ds_read_b64_tr_b16 v[154:155], v8 offset:22528
v_mfma_f32_16x16x32_bf16 v[100:103], v[160:163], a[64:67], v[100:103]
buffer_load_dwordx4 v2, s[16:19], s69 offen  lds
v_mfma_f32_16x16x32_bf16 v[104:107], v[160:163], a[68:71], v[104:107]
s_add_u32 m0, s72, 53248
v_exp_f32 v129, v129
v_mfma_f32_16x16x32_bf16 v[108:111], v[160:163], a[72:75], v[108:111]
s_add_u32 s69, s69, 294912
v_fma_f32 v129, v129, s90, s90
v_mfma_f32_16x16x32_bf16 v[112:115], v[160:163], a[76:79], v[112:115]
s_waitcnt lgkmcnt(2)
ds_read_b64_tr_b16 v[156:157], v9 offset:16384
ds_read_b64_tr_b16 v[158:159], v9 offset:20480
v_mfma_f32_16x16x32_bf16 v[52:55], v[148:151], a[80:83], v[52:55]
s_sub_u32 s0, s69, 5308416
v_rcp_f32 v129, v129
v_mfma_f32_16x16x32_bf16 v[56:59], v[148:151], a[84:87], v[56:59]
s_min_u32 s69, s69, s0
buffer_load_dwordx4 v2, s[16:19], s67 offen  lds
v_mfma_f32_16x16x32_bf16 v[60:63], v[148:151], a[88:91], v[60:63]
s_add_u32 m0, s72, 57344
v_mul_f32 v145, v145, v129
v_cvt_pk_bf16_f32 v128, v144, v145
v_mfma_f32_16x16x32_bf16 v[64:67], v[148:151], a[92:95], v[64:67]
s_waitcnt lgkmcnt(2)
ds_read_b64_tr_b16 v[160:161], v9 offset:18432
ds_read_b64_tr_b16 v[162:163], v9 offset:22528
v_mfma_f32_16x16x32_bf16 v[68:71], v[152:155], a[80:83], v[68:71]
s_add_u32 s67, s69, 36864
v_exp_f32 v130, v130
v_mfma_f32_16x16x32_bf16 v[72:75], v[152:155], a[84:87], v[72:75]
v_fma_f32 v130, v130, s90, s90
v_mfma_f32_16x16x32_bf16 v[76:79], v[152:155], a[88:91], v[76:79]
buffer_load_dwordx4 v2, s[16:19], s69 offen  lds
v_mfma_f32_16x16x32_bf16 v[80:83], v[152:155], a[92:95], v[80:83]
s_waitcnt lgkmcnt(2)
ds_read_b64_tr_b16 v[148:149], v8 offset:24576
ds_read_b64_tr_b16 v[150:151], v8 offset:28672
v_mfma_f32_16x16x32_bf16 v[84:87], v[156:159], a[80:83], v[84:87]
s_add_u32 m0, s72, 61440
v_rcp_f32 v130, v130
v_mfma_f32_16x16x32_bf16 v[88:91], v[156:159], a[84:87], v[88:91]
s_add_u32 s69, s69, 294912
v_mul_f32 v146, v146, v130
s_sub_u32 s0, s69, 5308416
v_mfma_f32_16x16x32_bf16 v[92:95], v[156:159], a[88:91], v[92:95]
s_min_u32 s69, s69, s0
v_exp_f32 v131, v131
v_mfma_f32_16x16x32_bf16 v[96:99], v[156:159], a[92:95], v[96:99]
s_waitcnt lgkmcnt(2)
ds_read_b64_tr_b16 v[152:153], v8 offset:26624
ds_read_b64_tr_b16 v[154:155], v8 offset:30720
v_mfma_f32_16x16x32_bf16 v[100:103], v[160:163], a[80:83], v[100:103]
buffer_load_dwordx4 v2, s[16:19], s67 offen  lds
v_mfma_f32_16x16x32_bf16 v[104:107], v[160:163], a[84:87], v[104:107]
s_add_u32 m0, s72, 65536
v_fma_f32 v131, v131, s90, s90
v_mfma_f32_16x16x32_bf16 v[108:111], v[160:163], a[88:91], v[108:111]
s_add_u32 s67, s69, 36864
v_rcp_f32 v131, v131
v_mfma_f32_16x16x32_bf16 v[112:115], v[160:163], a[92:95], v[112:115]
s_waitcnt lgkmcnt(2)
ds_read_b64_tr_b16 v[156:157], v9 offset:24576
ds_read_b64_tr_b16 v[158:159], v9 offset:28672
v_mfma_f32_16x16x32_bf16 v[52:55], v[148:151], a[96:99], v[52:55]
v_mul_f32 v147, v147, v131
v_cvt_pk_bf16_f32 v129, v146, v147
v_mfma_f32_16x16x32_bf16 v[56:59], v[148:151], a[100:103], v[56:59]
buffer_load_dwordx4 v2, s[16:19], s69 offen  lds
v_mfma_f32_16x16x32_bf16 v[60:63], v[148:151], a[104:107], v[60:63]
s_add_u32 m0, s72, 69632
v_exp_f32 v20, v20
v_mfma_f32_16x16x32_bf16 v[64:67], v[148:151], a[108:111], v[64:67]
s_waitcnt lgkmcnt(2)
ds_read_b64_tr_b16 v[160:161], v9 offset:26624
ds_read_b64_tr_b16 v[162:163], v9 offset:30720
v_mfma_f32_16x16x32_bf16 v[68:71], v[152:155], a[96:99], v[68:71]
v_fma_f32 v20, v20, s90, s90
v_mfma_f32_16x16x32_bf16 v[72:75], v[152:155], a[100:103], v[72:75]
v_rcp_f32 v20, v20
v_mfma_f32_16x16x32_bf16 v[76:79], v[152:155], a[104:107], v[76:79]
buffer_load_dwordx4 v2, s[16:19], s67 offen  lds
v_mfma_f32_16x16x32_bf16 v[80:83], v[152:155], a[108:111], v[80:83]
s_waitcnt lgkmcnt(2)
ds_read_b64_tr_b16 v[148:149], v8 offset:32768
ds_read_b64_tr_b16 v[150:151], v8 offset:36864
v_mfma_f32_16x16x32_bf16 v[84:87], v[156:159], a[96:99], v[84:87]
v_mul_f32 v36, v36, v20
v_mfma_f32_16x16x32_bf16 v[88:91], v[156:159], a[100:103], v[88:91]
v_exp_f32 v21, v21
v_mfma_f32_16x16x32_bf16 v[92:95], v[156:159], a[104:107], v[92:95]
v_fma_f32 v21, v21, s90, s90
v_mfma_f32_16x16x32_bf16 v[96:99], v[156:159], a[108:111], v[96:99]
s_waitcnt lgkmcnt(2)
ds_read_b64_tr_b16 v[152:153], v8 offset:34816
ds_read_b64_tr_b16 v[154:155], v8 offset:38912
v_mfma_f32_16x16x32_bf16 v[100:103], v[160:163], a[96:99], v[100:103]
v_rcp_f32 v21, v21
v_mfma_f32_16x16x32_bf16 v[104:107], v[160:163], a[100:103], v[104:107]
v_mul_f32 v37, v37, v21
v_cvt_pk_bf16_f32 v118, v36, v37
v_mfma_f32_16x16x32_bf16 v[108:111], v[160:163], a[104:107], v[108:111]
v_exp_f32 v22, v22
v_mfma_f32_16x16x32_bf16 v[112:115], v[160:163], a[108:111], v[112:115]
s_waitcnt lgkmcnt(2)
ds_read_b64_tr_b16 v[156:157], v9 offset:32768
ds_read_b64_tr_b16 v[158:159], v9 offset:36864
v_mfma_f32_16x16x32_bf16 v[52:55], v[148:151], a[112:115], v[52:55]
v_fma_f32 v22, v22, s90, s90
v_mfma_f32_16x16x32_bf16 v[56:59], v[148:151], a[116:119], v[56:59]
v_rcp_f32 v22, v22
v_mfma_f32_16x16x32_bf16 v[60:63], v[148:151], a[120:123], v[60:63]
v_mul_f32 v38, v38, v22
v_mfma_f32_16x16x32_bf16 v[64:67], v[148:151], a[124:127], v[64:67]
s_waitcnt lgkmcnt(2)
ds_read_b64_tr_b16 v[160:161], v9 offset:34816
ds_read_b64_tr_b16 v[162:163], v9 offset:38912
v_mfma_f32_16x16x32_bf16 v[68:71], v[152:155], a[112:115], v[68:71]
v_exp_f32 v23, v23
v_mfma_f32_16x16x32_bf16 v[72:75], v[152:155], a[116:119], v[72:75]
v_fma_f32 v23, v23, s90, s90
v_mfma_f32_16x16x32_bf16 v[76:79], v[152:155], a[120:123], v[76:79]
v_rcp_f32 v23, v23
v_mfma_f32_16x16x32_bf16 v[80:83], v[152:155], a[124:127], v[80:83]
s_waitcnt lgkmcnt(2)
ds_read_b64_tr_b16 v[148:149], v8 offset:40960
ds_read_b64_tr_b16 v[150:151], v8 offset:45056
v_mfma_f32_16x16x32_bf16 v[84:87], v[156:159], a[112:115], v[84:87]
v_mul_f32 v39, v39, v23
v_cvt_pk_bf16_f32 v119, v38, v39
v_mfma_f32_16x16x32_bf16 v[88:91], v[156:159], a[116:119], v[88:91]
buffer_store_dwordx4 v[116:119], v1, s[32:35], s101 offen offset:0 sc1
v_mfma_f32_16x16x32_bf16 v[92:95], v[156:159], a[120:123], v[92:95]
v_exp_f32 v24, v24
v_mfma_f32_16x16x32_bf16 v[96:99], v[156:159], a[124:127], v[96:99]
s_waitcnt lgkmcnt(2)
ds_read_b64_tr_b16 v[152:153], v8 offset:43008
ds_read_b64_tr_b16 v[154:155], v8 offset:47104
v_mfma_f32_16x16x32_bf16 v[100:103], v[160:163], a[112:115], v[100:103]
v_fma_f32 v24, v24, s90, s90
v_mfma_f32_16x16x32_bf16 v[104:107], v[160:163], a[116:119], v[104:107]
v_rcp_f32 v24, v24
v_mfma_f32_16x16x32_bf16 v[108:111], v[160:163], a[120:123], v[108:111]
v_mul_f32 v40, v40, v24
v_mfma_f32_16x16x32_bf16 v[112:115], v[160:163], a[124:127], v[112:115]
s_waitcnt lgkmcnt(2)
ds_read_b64_tr_b16 v[156:157], v9 offset:40960
ds_read_b64_tr_b16 v[158:159], v9 offset:45056
v_mfma_f32_16x16x32_bf16 v[52:55], v[148:151], a[128:131], v[52:55]
v_exp_f32 v25, v25
v_mfma_f32_16x16x32_bf16 v[56:59], v[148:151], a[132:135], v[56:59]
v_fma_f32 v25, v25, s90, s90
v_mfma_f32_16x16x32_bf16 v[60:63], v[148:151], a[136:139], v[60:63]
v_rcp_f32 v25, v25
v_mfma_f32_16x16x32_bf16 v[64:67], v[148:151], a[140:143], v[64:67]
s_waitcnt lgkmcnt(2)
ds_read_b64_tr_b16 v[160:161], v9 offset:43008
ds_read_b64_tr_b16 v[162:163], v9 offset:47104
v_mfma_f32_16x16x32_bf16 v[68:71], v[152:155], a[128:131], v[68:71]
s_waitcnt vmcnt(11)
v_mul_f32 v41, v41, v25
v_cvt_pk_bf16_f32 v122, v40, v41
v_mfma_f32_16x16x32_bf16 v[72:75], v[152:155], a[132:135], v[72:75]
s_barrier
v_add_u32 v2, 128, v2
v_mfma_f32_16x16x32_bf16 v[76:79], v[152:155], a[136:139], v[76:79]
s_mul_i32 s69, s71, 589824
v_exp_f32 v26, v26
v_mfma_f32_16x16x32_bf16 v[80:83], v[152:155], a[140:143], v[80:83]
s_waitcnt lgkmcnt(2)
ds_read_b64_tr_b16 v[148:149], v4 offset:0
ds_read_b64_tr_b16 v[150:151], v4 offset:4096
v_mfma_f32_16x16x32_bf16 v[84:87], v[156:159], a[128:131], v[84:87]
s_add_u32 m0, s72, 73728
v_fma_f32 v26, v26, s90, s90
v_mfma_f32_16x16x32_bf16 v[88:91], v[156:159], a[132:135], v[88:91]
s_add_u32 s67, s69, 36864
v_rcp_f32 v26, v26
v_mfma_f32_16x16x32_bf16 v[92:95], v[156:159], a[136:139], v[92:95]
v_mul_f32 v42, v42, v26
v_mfma_f32_16x16x32_bf16 v[96:99], v[156:159], a[140:143], v[96:99]
s_waitcnt lgkmcnt(2)
ds_read_b64_tr_b16 v[152:153], v4 offset:2048
ds_read_b64_tr_b16 v[154:155], v4 offset:6144
v_mfma_f32_16x16x32_bf16 v[100:103], v[160:163], a[128:131], v[100:103]
buffer_load_dwordx4 v2, s[16:19], s69 offen  lds
v_mfma_f32_16x16x32_bf16 v[104:107], v[160:163], a[132:135], v[104:107]
s_add_u32 m0, s72, 77824
v_exp_f32 v27, v27
v_mfma_f32_16x16x32_bf16 v[108:111], v[160:163], a[136:139], v[108:111]
s_add_u32 s69, s69, 294912
v_fma_f32 v27, v27, s90, s90
v_mfma_f32_16x16x32_bf16 v[112:115], v[160:163], a[140:143], v[112:115]
s_waitcnt lgkmcnt(2)
ds_read_b64_tr_b16 v[156:157], v5 offset:0
ds_read_b64_tr_b16 v[158:159], v5 offset:4096
v_mfma_f32_16x16x32_bf16 v[52:55], v[148:151], a[144:147], v[52:55]
s_sub_u32 s0, s69, 5308416
v_rcp_f32 v27, v27
v_mfma_f32_16x16x32_bf16 v[56:59], v[148:151], a[148:151], v[56:59]
s_min_u32 s69, s69, s0
buffer_load_dwordx4 v2, s[16:19], s67 offen  lds
v_mfma_f32_16x16x32_bf16 v[60:63], v[148:151], a[152:155], v[60:63]
s_add_u32 m0, s72, 81920
v_mul_f32 v43, v43, v27
v_cvt_pk_bf16_f32 v123, v42, v43
v_mfma_f32_16x16x32_bf16 v[64:67], v[148:151], a[156:159], v[64:67]
s_waitcnt lgkmcnt(2)
ds_read_b64_tr_b16 v[160:161], v5 offset:2048
ds_read_b64_tr_b16 v[162:163], v5 offset:6144
v_mfma_f32_16x16x32_bf16 v[68:71], v[152:155], a[144:147], v[68:71]
s_add_u32 s67, s69, 36864
v_exp_f32 v28, v28
v_mfma_f32_16x16x32_bf16 v[72:75], v[152:155], a[148:151], v[72:75]
v_fma_f32 v28, v28, s90, s90
v_mfma_f32_16x16x32_bf16 v[76:79], v[152:155], a[152:155], v[76:79]
buffer_load_dwordx4 v2, s[16:19], s69 offen  lds
v_mfma_f32_16x16x32_bf16 v[80:83], v[152:155], a[156:159], v[80:83]
s_waitcnt lgkmcnt(2)
ds_read_b64_tr_b16 v[148:149], v4 offset:8192
ds_read_b64_tr_b16 v[150:151], v4 offset:12288
v_mfma_f32_16x16x32_bf16 v[84:87], v[156:159], a[144:147], v[84:87]
s_add_u32 m0, s72, 86016
v_rcp_f32 v28, v28
v_mfma_f32_16x16x32_bf16 v[88:91], v[156:159], a[148:151], v[88:91]
s_add_u32 s69, s69, 294912
v_mul_f32 v44, v44, v28
v_mfma_f32_16x16x32_bf16 v[92:95], v[156:159], a[152:155], v[92:95]
s_sub_u32 s0, s69, 5308416
v_exp_f32 v29, v29
v_mfma_f32_16x16x32_bf16 v[96:99], v[156:159], a[156:159], v[96:99]
s_waitcnt lgkmcnt(2)
ds_read_b64_tr_b16 v[152:153], v4 offset:10240
ds_read_b64_tr_b16 v[154:155], v4 offset:14336
v_mfma_f32_16x16x32_bf16 v[100:103], v[160:163], a[144:147], v[100:103]
s_min_u32 s69, s69, s0
buffer_load_dwordx4 v2, s[16:19], s67 offen  lds
v_mfma_f32_16x16x32_bf16 v[104:107], v[160:163], a[148:151], v[104:107]
s_add_u32 m0, s72, 90112
v_fma_f32 v29, v29, s90, s90
v_mfma_f32_16x16x32_bf16 v[108:111], v[160:163], a[152:155], v[108:111]
s_add_u32 s67, s69, 36864
v_rcp_f32 v29, v29
v_mfma_f32_16x16x32_bf16 v[112:115], v[160:163], a[156:159], v[112:115]
s_waitcnt lgkmcnt(2)
ds_read_b64_tr_b16 v[156:157], v5 offset:8192
ds_read_b64_tr_b16 v[158:159], v5 offset:12288
v_mfma_f32_16x16x32_bf16 v[52:55], v[148:151], a[160:163], v[52:55]
v_mul_f32 v45, v45, v29
v_cvt_pk_bf16_f32 v126, v44, v45
v_mfma_f32_16x16x32_bf16 v[56:59], v[148:151], a[164:167], v[56:59]
buffer_load_dwordx4 v2, s[16:19], s69 offen  lds
v_mfma_f32_16x16x32_bf16 v[60:63], v[148:151], a[168:171], v[60:63]
s_add_u32 m0, s72, 94208
v_exp_f32 v30, v30
v_mfma_f32_16x16x32_bf16 v[64:67], v[148:151], a[172:175], v[64:67]
s_waitcnt lgkmcnt(2)
ds_read_b64_tr_b16 v[160:161], v5 offset:10240
ds_read_b64_tr_b16 v[162:163], v5 offset:14336
v_mfma_f32_16x16x32_bf16 v[68:71], v[152:155], a[160:163], v[68:71]
s_add_u32 s69, s69, 294912
v_fma_f32 v30, v30, s90, s90
s_sub_u32 s0, s69, 5308416
v_mfma_f32_16x16x32_bf16 v[72:75], v[152:155], a[164:167], v[72:75]
s_min_u32 s69, s69, s0
v_rcp_f32 v30, v30
v_mfma_f32_16x16x32_bf16 v[76:79], v[152:155], a[168:171], v[76:79]
buffer_load_dwordx4 v2, s[16:19], s67 offen  lds
v_mfma_f32_16x16x32_bf16 v[80:83], v[152:155], a[172:175], v[80:83]
s_waitcnt lgkmcnt(2)
ds_read_b64_tr_b16 v[148:149], v4 offset:16384
ds_read_b64_tr_b16 v[150:151], v4 offset:20480
v_mfma_f32_16x16x32_bf16 v[84:87], v[156:159], a[160:163], v[84:87]
s_add_u32 m0, s72, 98304
v_mul_f32 v46, v46, v30
v_mfma_f32_16x16x32_bf16 v[88:91], v[156:159], a[164:167], v[88:91]
s_add_u32 s67, s69, 36864
v_exp_f32 v31, v31
v_mfma_f32_16x16x32_bf16 v[92:95], v[156:159], a[168:171], v[92:95]
v_fma_f32 v31, v31, s90, s90
v_mfma_f32_16x16x32_bf16 v[96:99], v[156:159], a[172:175], v[96:99]
s_waitcnt lgkmcnt(2)
ds_read_b64_tr_b16 v[152:153], v4 offset:18432
ds_read_b64_tr_b16 v[154:155], v4 offset:22528
v_mfma_f32_16x16x32_bf16 v[100:103], v[160:163], a[160:163], v[100:103]
buffer_load_dwordx4 v2, s[16:19], s69 offen  lds
v_mfma_f32_16x16x32_bf16 v[104:107], v[160:163], a[164:167], v[104:107]
s_add_u32 m0, s72, 102400
v_rcp_f32 v31, v31
v_mfma_f32_16x16x32_bf16 v[108:111], v[160:163], a[168:171], v[108:111]
s_add_u32 s69, s69, 294912
v_mul_f32 v47, v47, v31
s_sub_u32 s0, s69, 5308416
v_mfma_f32_16x16x32_bf16 v[112:115], v[160:163], a[172:175], v[112:115]
s_waitcnt lgkmcnt(2)
ds_read_b64_tr_b16 v[156:157], v5 offset:16384
ds_read_b64_tr_b16 v[158:159], v5 offset:20480
v_mfma_f32_16x16x32_bf16 v[52:55], v[148:151], a[176:179], v[52:55]
s_min_u32 s69, s69, s0
v_cvt_pk_bf16_f32 v127, v46, v47
v_mfma_f32_16x16x32_bf16 v[56:59], v[148:151], a[180:183], v[56:59]
buffer_load_dwordx4 v2, s[16:19], s67 offen  lds
v_mfma_f32_16x16x32_bf16 v[60:63], v[148:151], a[184:187], v[60:63]
s_add_u32 m0, s72, 106496
v_exp_f32 v32, v32
v_mfma_f32_16x16x32_bf16 v[64:67], v[148:151], a[188:191], v[64:67]
s_waitcnt lgkmcnt(2)
ds_read_b64_tr_b16 v[160:161], v5 offset:18432
ds_read_b64_tr_b16 v[162:163], v5 offset:22528
v_mfma_f32_16x16x32_bf16 v[68:71], v[152:155], a[176:179], v[68:71]
v_fma_f32 v32, v32, s90, s90
v_mfma_f32_16x16x32_bf16 v[72:75], v[152:155], a[180:183], v[72:75]
v_rcp_f32 v32, v32
v_mfma_f32_16x16x32_bf16 v[76:79], v[152:155], a[184:187], v[76:79]
buffer_load_dwordx4 v2, s[16:19], s69 offen  lds
v_mfma_f32_16x16x32_bf16 v[80:83], v[152:155], a[188:191], v[80:83]
s_waitcnt lgkmcnt(2)
ds_read_b64_tr_b16 v[148:149], v4 offset:24576
ds_read_b64_tr_b16 v[150:151], v4 offset:28672
v_mfma_f32_16x16x32_bf16 v[84:87], v[156:159], a[176:179], v[84:87]
v_mul_f32 v48, v48, v32
v_mfma_f32_16x16x32_bf16 v[88:91], v[156:159], a[180:183], v[88:91]
v_exp_f32 v33, v33
v_mfma_f32_16x16x32_bf16 v[92:95], v[156:159], a[184:187], v[92:95]
v_fma_f32 v33, v33, s90, s90
v_mfma_f32_16x16x32_bf16 v[96:99], v[156:159], a[188:191], v[96:99]
s_waitcnt lgkmcnt(2)
ds_read_b64_tr_b16 v[152:153], v4 offset:26624
ds_read_b64_tr_b16 v[154:155], v4 offset:30720
v_mfma_f32_16x16x32_bf16 v[100:103], v[160:163], a[176:179], v[100:103]
buffer_store_dwordx4 v[120:123], v1, s[32:35], s101 offen offset:1024 sc1
v_mfma_f32_16x16x32_bf16 v[104:107], v[160:163], a[180:183], v[104:107]
v_rcp_f32 v33, v33
v_mfma_f32_16x16x32_bf16 v[108:111], v[160:163], a[184:187], v[108:111]
s_xor_b32 s101, s101, 2048
v_mul_f32 v49, v49, v33
v_cvt_pk_bf16_f32 v130, v48, v49
v_mfma_f32_16x16x32_bf16 v[112:115], v[160:163], a[188:191], v[112:115]
s_waitcnt lgkmcnt(2)
ds_read_b64_tr_b16 v[156:157], v5 offset:24576
ds_read_b64_tr_b16 v[158:159], v5 offset:28672
v_mfma_f32_16x16x32_bf16 v[52:55], v[148:151], a[192:195], v[52:55]
v_exp_f32 v34, v34
v_mfma_f32_16x16x32_bf16 v[56:59], v[148:151], a[196:199], v[56:59]
v_fma_f32 v34, v34, s90, s90
v_mfma_f32_16x16x32_bf16 v[60:63], v[148:151], a[200:203], v[60:63]
v_rcp_f32 v34, v34
v_mfma_f32_16x16x32_bf16 v[64:67], v[148:151], a[204:207], v[64:67]
s_waitcnt lgkmcnt(2)
ds_read_b64_tr_b16 v[160:161], v5 offset:26624
ds_read_b64_tr_b16 v[162:163], v5 offset:30720
v_mfma_f32_16x16x32_bf16 v[68:71], v[152:155], a[192:195], v[68:71]
s_waitcnt vmcnt(11)
v_mul_f32 v50, v50, v34
v_mfma_f32_16x16x32_bf16 v[72:75], v[152:155], a[196:199], v[72:75]
s_barrier
v_exp_f32 v35, v35
v_mfma_f32_16x16x32_bf16 v[76:79], v[152:155], a[200:203], v[76:79]
s_add_u32 s67, s69, 36864
v_fma_f32 v35, v35, s90, s90
s_add_u32 m0, s72, 110592
v_mfma_f32_16x16x32_bf16 v[80:83], v[152:155], a[204:207], v[80:83]
s_waitcnt lgkmcnt(2)
ds_read_b64_tr_b16 v[148:149], v4 offset:32768
ds_read_b64_tr_b16 v[150:151], v4 offset:36864
v_mfma_f32_16x16x32_bf16 v[84:87], v[156:159], a[192:195], v[84:87]
v_rcp_f32 v35, v35
v_mfma_f32_16x16x32_bf16 v[88:91], v[156:159], a[196:199], v[88:91]
s_add_u32 s69, s69, 294912
v_mul_f32 v51, v51, v35
v_cvt_pk_bf16_f32 v131, v50, v51
v_mfma_f32_16x16x32_bf16 v[92:95], v[156:159], a[200:203], v[92:95]
s_sub_u32 s0, s69, 5308416
v_mfma_f32_16x16x32_bf16 v[96:99], v[156:159], a[204:207], v[96:99]
s_waitcnt lgkmcnt(2)
ds_read_b64_tr_b16 v[152:153], v4 offset:34816
ds_read_b64_tr_b16 v[154:155], v4 offset:38912
v_mfma_f32_16x16x32_bf16 v[100:103], v[160:163], a[192:195], v[100:103]
s_min_u32 s69, s69, s0
v_mfma_f32_16x16x32_bf16 v[104:107], v[160:163], a[196:199], v[104:107]
v_mfma_f32_16x16x32_bf16 v[108:111], v[160:163], a[200:203], v[108:111]
buffer_load_dwordx4 v2, s[16:19], s67 offen  lds
v_mfma_f32_16x16x32_bf16 v[112:115], v[160:163], a[204:207], v[112:115]
s_waitcnt lgkmcnt(2)
ds_read_b64_tr_b16 v[156:157], v5 offset:32768
ds_read_b64_tr_b16 v[158:159], v5 offset:36864
v_mfma_f32_16x16x32_bf16 v[52:55], v[148:151], a[208:211], v[52:55]
s_add_u32 m0, s72, 114688
v_mfma_f32_16x16x32_bf16 v[56:59], v[148:151], a[212:215], v[56:59]
s_add_u32 s67, s69, 36864
v_mfma_f32_16x16x32_bf16 v[60:63], v[148:151], a[216:219], v[60:63]
v_mfma_f32_16x16x32_bf16 v[64:67], v[148:151], a[220:223], v[64:67]
s_waitcnt lgkmcnt(2)
ds_read_b64_tr_b16 v[160:161], v5 offset:34816
ds_read_b64_tr_b16 v[162:163], v5 offset:38912
v_mfma_f32_16x16x32_bf16 v[68:71], v[152:155], a[208:211], v[68:71]
buffer_load_dwordx4 v2, s[16:19], s69 offen  lds
v_mfma_f32_16x16x32_bf16 v[72:75], v[152:155], a[212:215], v[72:75]
s_add_u32 m0, s72, 118784
v_mfma_f32_16x16x32_bf16 v[76:79], v[152:155], a[216:219], v[76:79]
s_add_u32 s69, s69, 294912
v_mfma_f32_16x16x32_bf16 v[80:83], v[152:155], a[220:223], v[80:83]
s_waitcnt lgkmcnt(2)
ds_read_b64_tr_b16 v[148:149], v4 offset:40960
ds_read_b64_tr_b16 v[150:151], v4 offset:45056
v_mfma_f32_16x16x32_bf16 v[84:87], v[156:159], a[208:211], v[84:87]
s_sub_u32 s0, s69, 5308416
v_mfma_f32_16x16x32_bf16 v[88:91], v[156:159], a[212:215], v[88:91]
s_min_u32 s69, s69, s0
buffer_load_dwordx4 v2, s[16:19], s67 offen  lds
v_mfma_f32_16x16x32_bf16 v[92:95], v[156:159], a[216:219], v[92:95]
s_add_u32 m0, s72, 122880
v_mfma_f32_16x16x32_bf16 v[96:99], v[156:159], a[220:223], v[96:99]
s_waitcnt lgkmcnt(2)
ds_read_b64_tr_b16 v[152:153], v4 offset:43008
ds_read_b64_tr_b16 v[154:155], v4 offset:47104
v_mfma_f32_16x16x32_bf16 v[100:103], v[160:163], a[208:211], v[100:103]
s_add_u32 s67, s69, 36864
v_mfma_f32_16x16x32_bf16 v[104:107], v[160:163], a[212:215], v[104:107]
v_mfma_f32_16x16x32_bf16 v[108:111], v[160:163], a[216:219], v[108:111]
buffer_load_dwordx4 v2, s[16:19], s69 offen  lds
v_mfma_f32_16x16x32_bf16 v[112:115], v[160:163], a[220:223], v[112:115]
s_waitcnt lgkmcnt(2)
ds_read_b64_tr_b16 v[156:157], v5 offset:40960
ds_read_b64_tr_b16 v[158:159], v5 offset:45056
v_mfma_f32_16x16x32_bf16 v[52:55], v[148:151], a[224:227], v[52:55]
s_add_u32 m0, s72, 126976
v_mfma_f32_16x16x32_bf16 v[56:59], v[148:151], a[228:231], v[56:59]
s_add_u32 s69, s69, 294912
v_mfma_f32_16x16x32_bf16 v[60:63], v[148:151], a[232:235], v[60:63]
s_sub_u32 s0, s69, 5308416
v_mfma_f32_16x16x32_bf16 v[64:67], v[148:151], a[236:239], v[64:67]
s_waitcnt lgkmcnt(2)
ds_read_b64_tr_b16 v[160:161], v5 offset:43008
ds_read_b64_tr_b16 v[162:163], v5 offset:47104
v_mfma_f32_16x16x32_bf16 v[68:71], v[152:155], a[224:227], v[68:71]
s_min_u32 s69, s69, s0
buffer_load_dword v12, v14, s[32:35], s57 offen sc1
v_mfma_f32_16x16x32_bf16 v[72:75], v[152:155], a[228:231], v[72:75]
v_mfma_f32_16x16x32_bf16 v[76:79], v[152:155], a[232:235], v[76:79]
v_mfma_f32_16x16x32_bf16 v[80:83], v[152:155], a[236:239], v[80:83]
s_waitcnt lgkmcnt(2)
ds_read_b64_tr_b16 v[148:149], v6 offset:0
ds_read_b64_tr_b16 v[150:151], v6 offset:4096
v_mfma_f32_16x16x32_bf16 v[84:87], v[156:159], a[224:227], v[84:87]
buffer_load_dwordx4 v2, s[16:19], s67 offen  lds
v_mfma_f32_16x16x32_bf16 v[88:91], v[156:159], a[228:231], v[88:91]
s_add_u32 m0, s72, 131072
v_mfma_f32_16x16x32_bf16 v[92:95], v[156:159], a[232:235], v[92:95]
s_add_u32 s67, s69, 36864
v_mfma_f32_16x16x32_bf16 v[96:99], v[156:159], a[236:239], v[96:99]
s_waitcnt lgkmcnt(2)
ds_read_b64_tr_b16 v[152:153], v6 offset:2048
ds_read_b64_tr_b16 v[154:155], v6 offset:6144
v_mfma_f32_16x16x32_bf16 v[100:103], v[160:163], a[224:227], v[100:103]
v_mfma_f32_16x16x32_bf16 v[104:107], v[160:163], a[228:231], v[104:107]
buffer_load_dwordx4 v2, s[16:19], s69 offen  lds
v_mfma_f32_16x16x32_bf16 v[108:111], v[160:163], a[232:235], v[108:111]
s_add_u32 m0, s72, 135168
v_mfma_f32_16x16x32_bf16 v[112:115], v[160:163], a[236:239], v[112:115]
s_waitcnt lgkmcnt(2)
ds_read_b64_tr_b16 v[156:157], v7 offset:0
ds_read_b64_tr_b16 v[158:159], v7 offset:4096
v_mfma_f32_16x16x32_bf16 v[52:55], v[148:151], a[240:243], v[52:55]
s_add_u32 s69, s69, 294912
v_mfma_f32_16x16x32_bf16 v[56:59], v[148:151], a[244:247], v[56:59]
s_sub_u32 s0, s69, 5308416
v_mfma_f32_16x16x32_bf16 v[60:63], v[148:151], a[248:251], v[60:63]
s_min_u32 s69, s69, s0
buffer_load_dwordx4 v2, s[16:19], s67 offen  lds
v_mfma_f32_16x16x32_bf16 v[64:67], v[148:151], a[252:255], v[64:67]
s_waitcnt lgkmcnt(2)
ds_read_b64_tr_b16 v[160:161], v7 offset:2048
ds_read_b64_tr_b16 v[162:163], v7 offset:6144
v_mfma_f32_16x16x32_bf16 v[68:71], v[152:155], a[240:243], v[68:71]
s_add_u32 m0, s72, 139264
v_mfma_f32_16x16x32_bf16 v[72:75], v[152:155], a[244:247], v[72:75]
s_add_u32 s67, s69, 36864
v_mfma_f32_16x16x32_bf16 v[76:79], v[152:155], a[248:251], v[76:79]
v_mfma_f32_16x16x32_bf16 v[80:83], v[152:155], a[252:255], v[80:83]
s_waitcnt lgkmcnt(2)
ds_read_b64_tr_b16 v[148:149], v6 offset:8192
ds_read_b64_tr_b16 v[150:151], v6 offset:12288
v_mfma_f32_16x16x32_bf16 v[84:87], v[156:159], a[240:243], v[84:87]
buffer_load_dwordx4 v2, s[16:19], s69 offen  lds
v_mfma_f32_16x16x32_bf16 v[88:91], v[156:159], a[244:247], v[88:91]
s_add_u32 m0, s72, 143360
v_mfma_f32_16x16x32_bf16 v[92:95], v[156:159], a[248:251], v[92:95]
v_mfma_f32_16x16x32_bf16 v[96:99], v[156:159], a[252:255], v[96:99]
s_waitcnt lgkmcnt(2)
ds_read_b64_tr_b16 v[152:153], v6 offset:10240
ds_read_b64_tr_b16 v[154:155], v6 offset:14336
v_mfma_f32_16x16x32_bf16 v[100:103], v[160:163], a[240:243], v[100:103]
v_mfma_f32_16x16x32_bf16 v[104:107], v[160:163], a[244:247], v[104:107]
buffer_load_dwordx4 v2, s[16:19], s67 offen  lds
v_mfma_f32_16x16x32_bf16 v[108:111], v[160:163], a[248:251], v[108:111]
v_mfma_f32_16x16x32_bf16 v[112:115], v[160:163], a[252:255], v[112:115]
s_waitcnt lgkmcnt(2)
ds_read_b64_tr_b16 v[156:157], v7 offset:8192
ds_read_b64_tr_b16 v[158:159], v7 offset:12288
v_mfma_f32_16x16x32_bf16 v[52:55], v[148:151], v[168:171], v[52:55]
v_mfma_f32_16x16x32_bf16 v[56:59], v[148:151], v[172:175], v[56:59]
v_mfma_f32_16x16x32_bf16 v[60:63], v[148:151], v[176:179], v[60:63]
buffer_store_dwordx4 v[124:127], v1, s[32:35], s101 offen offset:0 sc1
v_mfma_f32_16x16x32_bf16 v[64:67], v[148:151], v[180:183], v[64:67]
s_waitcnt lgkmcnt(2)
ds_read_b64_tr_b16 v[160:161], v7 offset:10240
ds_read_b64_tr_b16 v[162:163], v7 offset:14336
v_mfma_f32_16x16x32_bf16 v[68:71], v[152:155], v[168:171], v[68:71]
v_mfma_f32_16x16x32_bf16 v[72:75], v[152:155], v[172:175], v[72:75]
v_mfma_f32_16x16x32_bf16 v[76:79], v[152:155], v[176:179], v[76:79]
v_mfma_f32_16x16x32_bf16 v[80:83], v[152:155], v[180:183], v[80:83]
s_waitcnt lgkmcnt(2)
ds_read_b64_tr_b16 v[148:149], v6 offset:16384
ds_read_b64_tr_b16 v[150:151], v6 offset:20480
v_mfma_f32_16x16x32_bf16 v[84:87], v[156:159], v[168:171], v[84:87]
v_mfma_f32_16x16x32_bf16 v[88:91], v[156:159], v[172:175], v[88:91]
v_mfma_f32_16x16x32_bf16 v[92:95], v[156:159], v[176:179], v[92:95]
v_mfma_f32_16x16x32_bf16 v[96:99], v[156:159], v[180:183], v[96:99]
s_waitcnt lgkmcnt(2)
ds_read_b64_tr_b16 v[152:153], v6 offset:18432
ds_read_b64_tr_b16 v[154:155], v6 offset:22528
v_mfma_f32_16x16x32_bf16 v[100:103], v[160:163], v[168:171], v[100:103]
v_mfma_f32_16x16x32_bf16 v[104:107], v[160:163], v[172:175], v[104:107]
v_mfma_f32_16x16x32_bf16 v[108:111], v[160:163], v[176:179], v[108:111]
v_mfma_f32_16x16x32_bf16 v[112:115], v[160:163], v[180:183], v[112:115]
s_waitcnt lgkmcnt(2)
ds_read_b64_tr_b16 v[156:157], v7 offset:16384
ds_read_b64_tr_b16 v[158:159], v7 offset:20480
v_mfma_f32_16x16x32_bf16 v[52:55], v[148:151], v[184:187], v[52:55]
v_mfma_f32_16x16x32_bf16 v[56:59], v[148:151], v[188:191], v[56:59]
v_mfma_f32_16x16x32_bf16 v[60:63], v[148:151], v[192:195], v[60:63]
v_mfma_f32_16x16x32_bf16 v[64:67], v[148:151], v[196:199], v[64:67]
s_waitcnt lgkmcnt(2)
ds_read_b64_tr_b16 v[160:161], v7 offset:18432
ds_read_b64_tr_b16 v[162:163], v7 offset:22528
v_mfma_f32_16x16x32_bf16 v[68:71], v[152:155], v[184:187], v[68:71]
s_waitcnt vmcnt(12)
buffer_store_dwordx4 v[128:131], v1, s[32:35], s101 offen offset:1024 sc1
v_mfma_f32_16x16x32_bf16 v[72:75], v[152:155], v[188:191], v[72:75]
s_barrier
v_exp_f32 v52, v52
v_mfma_f32_16x16x32_bf16 v[76:79], v[152:155], v[192:195], v[76:79]
s_add_u32 s69, s69, 294912
v_fma_f32 v52, v52, s90, s90
s_sub_u32 s0, s69, 5308416
v_mfma_f32_16x16x32_bf16 v[80:83], v[152:155], v[196:199], v[80:83]
s_waitcnt lgkmcnt(2)
ds_read_b64_tr_b16 v[148:149], v6 offset:24576
ds_read_b64_tr_b16 v[150:151], v6 offset:28672
v_mfma_f32_16x16x32_bf16 v[84:87], v[156:159], v[184:187], v[84:87]
s_min_u32 s69, s69, s0
v_rcp_f32 v52, v52
v_mfma_f32_16x16x32_bf16 v[88:91], v[156:159], v[188:191], v[88:91]
s_add_u32 m0, s72, 0
v_mul_f32 v68, v68, v52
v_mfma_f32_16x16x32_bf16 v[92:95], v[156:159], v[192:195], v[92:95]
s_add_u32 s67, s69, 36864
v_exp_f32 v53, v53
v_mfma_f32_16x16x32_bf16 v[96:99], v[156:159], v[196:199], v[96:99]
s_waitcnt lgkmcnt(2)
ds_read_b64_tr_b16 v[152:153], v6 offset:26624
ds_read_b64_tr_b16 v[154:155], v6 offset:30720
v_mfma_f32_16x16x32_bf16 v[100:103], v[160:163], v[184:187], v[100:103]
s_add_u32 s101, s2, 24576
v_fma_f32 v53, v53, s90, s90
v_mfma_f32_16x16x32_bf16 v[104:107], v[160:163], v[188:191], v[104:107]
v_rcp_f32 v53, v53
v_mfma_f32_16x16x32_bf16 v[108:111], v[160:163], v[192:195], v[108:111]
v_mul_f32 v69, v69, v53
v_cvt_pk_bf16_f32 v52, v68, v69
v_mfma_f32_16x16x32_bf16 v[112:115], v[160:163], v[196:199], v[112:115]
s_waitcnt lgkmcnt(2)
ds_read_b64_tr_b16 v[156:157], v7 offset:24576
ds_read_b64_tr_b16 v[158:159], v7 offset:28672
v_mfma_f32_16x16x32_bf16 v[116:119], v[148:151], a[0:3], 0
v_exp_f32 v54, v54
v_mfma_f32_16x16x32_bf16 v[120:123], v[148:151], a[4:7], 0
v_fma_f32 v54, v54, s90, s90
v_mfma_f32_16x16x32_bf16 v[124:127], v[148:151], a[8:11], 0
v_rcp_f32 v54, v54
v_mfma_f32_16x16x32_bf16 v[128:131], v[148:151], a[12:15], 0
s_waitcnt lgkmcnt(2)
ds_read_b64_tr_b16 v[160:161], v7 offset:26624
ds_read_b64_tr_b16 v[162:163], v7 offset:30720
v_mfma_f32_16x16x32_bf16 v[132:135], v[152:155], a[0:3], 0
v_mul_f32 v70, v70, v54
v_mfma_f32_16x16x32_bf16 v[136:139], v[152:155], a[4:7], 0
v_exp_f32 v55, v55
v_mfma_f32_16x16x32_bf16 v[140:143], v[152:155], a[8:11], 0
buffer_load_dwordx4 v2, s[16:19], s69 offen  lds
v_mfma_f32_16x16x32_bf16 v[144:147], v[152:155], a[12:15], 0
s_waitcnt lgkmcnt(2)
ds_read_b64_tr_b16 v[148:149], v6 offset:32768
ds_read_b64_tr_b16 v[150:151], v6 offset:36864
v_mfma_f32_16x16x32_bf16 v[20:23], v[156:159], a[0:3], 0
s_add_u32 m0, s72, 4096
v_fma_f32 v55, v55, s90, s90
s_add_u32 s69, s69, 294912
v_mfma_f32_16x16x32_bf16 v[24:27], v[156:159], a[4:7], 0
s_sub_u32 s0, s69, 5308416
v_rcp_f32 v55, v55
v_mfma_f32_16x16x32_bf16 v[28:31], v[156:159], a[8:11], 0
s_waitcnt vmcnt(8)
v_cmp_ge_u32 s[86:87], v12, 1
s_min_u32 s69, s69, s0
v_mfma_f32_16x16x32_bf16 v[32:35], v[156:159], a[12:15], 0
s_waitcnt lgkmcnt(2)
ds_read_b64_tr_b16 v[152:153], v6 offset:34816
ds_read_b64_tr_b16 v[154:155], v6 offset:38912
s_cmp_eq_u64 s[86:87], -1
s_cbranch_scc0 L_slow2
L_back2:
v_mfma_f32_16x16x32_bf16 v[36:39], v[160:163], a[0:3], 0
s_add_u32 s50, s23, 0
buffer_load_dwordx4 v2, s[16:19], s67 offen  lds
v_mfma_f32_16x16x32_bf16 v[40:43], v[160:163], a[4:7], 0
s_add_u32 m0, s72, 8192
v_mul_f32 v71, v71, v55
s_add_u32 s67, s69, 36864
v_mfma_f32_16x16x32_bf16 v[44:47], v[160:163], a[8:11], 0
v_cvt_pk_bf16_f32 v53, v70, v71
v_lshrrev_b32 v14, 2, v0
v_mfma_f32_16x16x32_bf16 v[48:51], v[160:163], a[12:15], 0
s_waitcnt lgkmcnt(2)
ds_read_b64_tr_b16 v[156:157], v7 offset:32768
ds_read_b64_tr_b16 v[158:159], v7 offset:36864
v_mfma_f32_16x16x32_bf16 v[116:119], v[148:151], a[16:19], v[116:119]
v_exp_f32 v56, v56
v_mfma_f32_16x16x32_bf16 v[120:123], v[148:151], a[20:23], v[120:123]
buffer_load_dwordx4 v[224:227], v1, s[32:35], s50 offen offset:0 sc1
v_mfma_f32_16x16x32_bf16 v[124:127], v[148:151], a[24:27], v[124:127]
v_fma_f32 v56, v56, s90, s90
v_lshlrev_b32 v14, 7, v14
v_mfma_f32_16x16x32_bf16 v[128:131], v[148:151], a[28:31], v[128:131]
s_waitcnt lgkmcnt(2)
ds_read_b64_tr_b16 v[160:161], v7 offset:34816
ds_read_b64_tr_b16 v[162:163], v7 offset:38912
v_mfma_f32_16x16x32_bf16 v[132:135], v[152:155], a[16:19], v[132:135]
v_rcp_f32 v56, v56
v_mfma_f32_16x16x32_bf16 v[136:139], v[152:155], a[20:23], v[136:139]
v_mul_f32 v72, v72, v56
v_add_u32 v14, v14, v15
v_mfma_f32_16x16x32_bf16 v[140:143], v[152:155], a[24:27], v[140:143]
buffer_load_dwordx4 v[228:231], v1, s[32:35], s50 offen offset:1024 sc1
v_mfma_f32_16x16x32_bf16 v[144:147], v[152:155], a[28:31], v[144:147]
s_waitcnt lgkmcnt(2)
ds_read_b64_tr_b16 v[148:149], v6 offset:40960
ds_read_b64_tr_b16 v[150:151], v6 offset:45056
v_mfma_f32_16x16x32_bf16 v[20:23], v[156:159], a[16:19], v[20:23]
s_add_u32 s50, s23, 2048
v_exp_f32 v57, v57
v_mfma_f32_16x16x32_bf16 v[24:27], v[156:159], a[20:23], v[24:27]
v_fma_f32 v57, v57, s90, s90
v_lshrrev_b32 v15, 4, v0
v_mfma_f32_16x16x32_bf16 v[28:31], v[156:159], a[24:27], v[28:31]
buffer_load_dwordx4 v[232:235], v1, s[32:35], s50 offen offset:0 sc1
v_mfma_f32_16x16x32_bf16 v[32:35], v[156:159], a[28:31], v[32:35]
s_waitcnt lgkmcnt(2)
ds_read_b64_tr_b16 v[152:153], v6 offset:43008
ds_read_b64_tr_b16 v[154:155], v6 offset:47104
v_mfma_f32_16x16x32_bf16 v[36:39], v[160:163], a[16:19], v[36:39]
v_rcp_f32 v57, v57
v_mfma_f32_16x16x32_bf16 v[40:43], v[160:163], a[20:23], v[40:43]
buffer_load_dwordx4 v[236:239], v1, s[32:35], s50 offen offset:1024 sc1
v_mfma_f32_16x16x32_bf16 v[44:47], v[160:163], a[24:27], v[44:47]
s_add_u32 s50, s23, 4096
v_mul_f32 v73, v73, v57
v_cvt_pk_bf16_f32 v56, v72, v73
v_mfma_f32_16x16x32_bf16 v[48:51], v[160:163], a[28:31], v[48:51]
s_waitcnt lgkmcnt(2)
buffer_load_dwordx4 v[240:243], v1, s[32:35], s50 offen offset:0 sc1
v_mfma_f32_16x16x32_bf16 v[116:119], v[148:151], a[32:35], v[116:119]
buffer_load_dwordx4 v[244:247], v1, s[32:35], s50 offen offset:1024 sc1
s_add_u32 s50, s23, 6144
v_mfma_f32_16x16x32_bf16 v[120:123], v[148:151], a[36:39], v[120:123]
ds_read_b64_tr_b16 v[156:157], v7 offset:40960
ds_read_b64_tr_b16 v[158:159], v7 offset:45056
v_mfma_f32_16x16x32_bf16 v[124:127], v[148:151], a[40:43], v[124:127]
buffer_load_dwordx4 v[248:251], v1, s[32:35], s50 offen offset:0 sc1
v_mfma_f32_16x16x32_bf16 v[128:131], v[148:151], a[44:47], v[128:131]
s_waitcnt lgkmcnt(2)
buffer_load_dwordx4 v[252:255], v1, s[32:35], s50 offen offset:1024 sc1
v_mfma_f32_16x16x32_bf16 v[132:135], v[152:155], a[32:35], v[132:135]
s_add_u32 s50, s23, 8192
ds_read_b64_tr_b16 v[160:161], v7 offset:43008
ds_read_b64_tr_b16 v[162:163], v7 offset:47104
v_mfma_f32_16x16x32_bf16 v[136:139], v[152:155], a[36:39], v[136:139]
v_exp_f32 v58, v58
v_mfma_f32_16x16x32_bf16 v[140:143], v[152:155], a[40:43], v[140:143]
buffer_load_dwordx4 v2, s[16:19], s69 offen  lds
v_mfma_f32_16x16x32_bf16 v[144:147], v[152:155], a[44:47], v[144:147]
s_waitcnt lgkmcnt(2)
ds_read_b64_tr_b16 v[148:149], v8 offset:0
ds_read_b64_tr_b16 v[150:151], v8 offset:4096
v_mfma_f32_16x16x32_bf16 v[20:23], v[156:159], a[32:35], v[20:23]
s_add_u32 m0, s72, 12288
v_fma_f32 v58, v58, s90, s90
s_add_u32 s69, s69, 294912
v_mfma_f32_16x16x32_bf16 v[24:27], v[156:159], a[36:39], v[24:27]
s_sub_u32 s0, s69, 5308416
buffer_load_dwordx4 v2, s[16:19], s67 offen  lds
v_mfma_f32_16x16x32_bf16 v[28:31], v[156:159], a[40:43], v[28:31]
s_min_u32 s69, s69, s0
v_rcp_f32 v58, v58
v_mfma_f32_16x16x32_bf16 v[32:35], v[156:159], a[44:47], v[32:35]
s_waitcnt lgkmcnt(2)
ds_read_b64_tr_b16 v[152:153], v8 offset:2048
ds_read_b64_tr_b16 v[154:155], v8 offset:6144
v_mfma_f32_16x16x32_bf16 v[36:39], v[160:163], a[32:35], v[36:39]
s_add_u32 m0, s72, 16384
v_mul_f32 v74, v74, v58
s_add_u32 s67, s69, 36864
v_mfma_f32_16x16x32_bf16 v[40:43], v[160:163], a[36:39], v[40:43]
buffer_load_dwordx4 v2, s[16:19], s69 offen  lds
v_mfma_f32_16x16x32_bf16 v[44:47], v[160:163], a[40:43], v[44:47]
s_add_u32 m0, s72, 20480
v_exp_f32 v59, v59
v_mfma_f32_16x16x32_bf16 v[48:51], v[160:163], a[44:47], v[48:51]
s_waitcnt lgkmcnt(2)
ds_read_b64_tr_b16 v[156:157], v9 offset:0
ds_read_b64_tr_b16 v[158:159], v9 offset:4096
v_mfma_f32_16x16x32_bf16 v[116:119], v[148:151], a[48:51], v[116:119]
s_add_u32 s69, s69, 294912
buffer_load_dwordx4 v2, s[16:19], s67 offen  lds
v_mfma_f32_16x16x32_bf16 v[120:123], v[148:151], a[52:55], v[120:123]
s_sub_u32 s0, s69, 5308416
v_fma_f32 v59, v59, s90, s90
s_min_u32 s69, s69, s0
v_mfma_f32_16x16x32_bf16 v[124:127], v[148:151], a[56:59], v[124:127]
s_add_u32 m0, s72, 24576
v_rcp_f32 v59, v59
v_mfma_f32_16x16x32_bf16 v[128:131], v[148:151], a[60:63], v[128:131]
s_waitcnt lgkmcnt(2)
ds_read_b64_tr_b16 v[160:161], v9 offset:2048
ds_read_b64_tr_b16 v[162:163], v9 offset:6144
v_mfma_f32_16x16x32_bf16 v[132:135], v[152:155], a[48:51], v[132:135]
s_add_u32 s67, s69, 36864
buffer_load_dwordx4 v2, s[16:19], s69 offen  lds
v_mul_f32 v75, v75, v59
v_mfma_f32_16x16x32_bf16 v[136:139], v[152:155], a[52:55], v[136:139]
s_add_u32 m0, s72, 28672
v_cvt_pk_bf16_f32 v57, v74, v75
s_add_u32 s69, s69, 294912
v_mfma_f32_16x16x32_bf16 v[140:143], v[152:155], a[56:59], v[140:143]
s_sub_u32 s0, s69, 5308416
v_exp_f32 v60, v60
s_waitcnt vmcnt(17)
s_barrier
v_mfma_f32_16x16x32_bf16 v[144:147], v[152:155], a[60:63], v[144:147]
s_waitcnt lgkmcnt(2)
ds_read_b64_tr_b16 v[148:149], v8 offset:8192
ds_read_b64_tr_b16 v[150:151], v8 offset:12288
v_mfma_f32_16x16x32_bf16 v[20:23], v[156:159], a[48:51], v[20:23]
s_min_u32 s69, s69, s0
buffer_load_dwordx4 v2, s[16:19], s67 offen  lds
v_mfma_f32_16x16x32_bf16 v[24:27], v[156:159], a[52:55], v[24:27]
s_add_u32 m0, s72, 32768
v_fma_f32 v60, v60, s90, s90
s_add_u32 s67, s69, 36864
v_mfma_f32_16x16x32_bf16 v[28:31], v[156:159], a[56:59], v[28:31]
v_rcp_f32 v60, v60
v_mfma_f32_16x16x32_bf16 v[32:35], v[156:159], a[60:63], v[32:35]
s_waitcnt lgkmcnt(2)
ds_read_b64_tr_b16 v[152:153], v8 offset:10240
ds_read_b64_tr_b16 v[154:155], v8 offset:14336
v_mfma_f32_16x16x32_bf16 v[36:39], v[160:163], a[48:51], v[36:39]
buffer_load_dwordx4 v2, s[16:19], s69 offen  lds
v_mfma_f32_16x16x32_bf16 v[40:43], v[160:163], a[52:55], v[40:43]
s_add_u32 m0, s72, 36864
v_mul_f32 v76, v76, v60
s_add_u32 s69, s69, 294912
v_mfma_f32_16x16x32_bf16 v[44:47], v[160:163], a[56:59], v[44:47]
s_sub_u32 s0, s69, 5308416
v_exp_f32 v61, v61
v_mfma_f32_16x16x32_bf16 v[48:51], v[160:163], a[60:63], v[48:51]
s_waitcnt lgkmcnt(2)
ds_read_b64_tr_b16 v[156:157], v9 offset:8192
ds_read_b64_tr_b16 v[158:159], v9 offset:12288
v_fma_f32 v61, v61, s90, s90
v_mfma_f32_16x16x32_bf16 v[116:119], v[148:151], a[64:67], v[116:119]
s_min_u32 s69, s69, s0
v_rcp_f32 v61, v61
v_mfma_f32_16x16x32_bf16 v[120:123], v[148:151], a[68:71], v[120:123]
buffer_load_dwordx4 v[200:203], v1, s[32:35], s50 offen offset:0 sc1
v_mfma_f32_16x16x32_bf16 v[124:127], v[148:151], a[72:75], v[124:127]
v_mul_f32 v77, v77, v61
v_cvt_pk_bf16_f32 v60, v76, v77
v_mfma_f32_16x16x32_bf16 v[128:131], v[148:151], a[76:79], v[128:131]
s_waitcnt lgkmcnt(2)
ds_read_b64_tr_b16 v[160:161], v9 offset:10240
ds_read_b64_tr_b16 v[162:163], v9 offset:14336
v_mfma_f32_16x16x32_bf16 v[132:135], v[152:155], a[64:67], v[132:135]
v_exp_f32 v62, v62
v_mfma_f32_16x16x32_bf16 v[136:139], v[152:155], a[68:71], v[136:139]
buffer_load_dwordx4 v[204:207], v1, s[32:35], s50 offen offset:1024 sc1
v_fma_f32 v62, v62, s90, s90
v_mfma_f32_16x16x32_bf16 v[140:143], v[152:155], a[72:75], v[140:143]
v_rcp_f32 v62, v62
v_mfma_f32_16x16x32_bf16 v[144:147], v[152:155], a[76:79], v[144:147]
s_waitcnt lgkmcnt(2)
ds_read_b64_tr_b16 v[148:149], v8 offset:16384
ds_read_b64_tr_b16 v[150:151], v8 offset:20480
v_mfma_f32_16x16x32_bf16 v[20:23], v[156:159], a[64:67], v[20:23]
v_mul_f32 v78, v78, v62
v_cmp_eq_u32 s[86:87], 1, v15
v_mfma_f32_16x16x32_bf16 v[24:27], v[156:159], a[68:71], v[24:27]
v_exp_f32 v63, v63
v_mfma_f32_16x16x32_bf16 v[28:31], v[156:159], a[72:75], v[28:31]
buffer_load_dwordx4 v2, s[16:19], s67 offen  lds
v_mfma_f32_16x16x32_bf16 v[32:35], v[156:159], a[76:79], v[32:35]
s_waitcnt lgkmcnt(2)
ds_read_b64_tr_b16 v[152:153], v8 offset:18432
ds_read_b64_tr_b16 v[154:155], v8 offset:22528
v_fma_f32 v63, v63, s90, s90
v_mfma_f32_16x16x32_bf16 v[36:39], v[160:163], a[64:67], v[36:39]
s_add_u32 m0, s72, 40960
v_rcp_f32 v63, v63
v_mfma_f32_16x16x32_bf16 v[40:43], v[160:163], a[68:71], v[40:43]
s_add_u32 s67, s69, 36864
v_mul_f32 v79, v79, v63
v_cvt_pk_bf16_f32 v61, v78, v79
v_mfma_f32_16x16x32_bf16 v[44:47], v[160:163], a[72:75], v[44:47]
v_exp_f32 v64, v64
v_mfma_f32_16x16x32_bf16 v[48:51], v[160:163], a[76:79], v[48:51]
s_waitcnt lgkmcnt(2)
ds_read_b64_tr_b16 v[156:157], v9 offset:16384
ds_read_b64_tr_b16 v[158:159], v9 offset:20480
v_mfma_f32_16x16x32_bf16 v[116:119], v[148:151], a[80:83], v[116:119]
buffer_load_dwordx4 v2, s[16:19], s69 offen  lds
v_mfma_f32_16x16x32_bf16 v[120:123], v[148:151], a[84:87], v[120:123]
s_add_u32 m0, s72, 45056
v_fma_f32 v64, v64, s90, s90
s_add_u32 s69, s69, 294912
v_mfma_f32_16x16x32_bf16 v[124:127], v[148:151], a[88:91], v[124:127]
s_sub_u32 s0, s69, 5308416
v_rcp_f32 v64, v64
v_mfma_f32_16x16x32_bf16 v[128:131], v[148:151], a[92:95], v[128:131]
s_waitcnt lgkmcnt(2)
ds_read_b64_tr_b16 v[160:161], v9 offset:18432
ds_read_b64_tr_b16 v[162:163], v9 offset:22528
v_mfma_f32_16x16x32_bf16 v[132:135], v[152:155], a[80:83], v[132:135]
s_min_u32 s69, s69, s0
v_mul_f32 v80, v80, v64
v_and_b32 v15, 0xf0, v1
v_mfma_f32_16x16x32_bf16 v[136:139], v[152:155], a[84:87], v[136:139]
buffer_load_dwordx4 v2, s[16:19], s67 offen  lds
v_mfma_f32_16x16x32_bf16 v[140:143], v[152:155], a[88:91], v[140:143]
s_add_u32 m0, s72, 49152
v_exp_f32 v65, v65
v_mfma_f32_16x16x32_bf16 v[144:147], v[152:155], a[92:95], v[144:147]
s_waitcnt lgkmcnt(2)
ds_read_b64_tr_b16 v[148:149], v8 offset:24576
ds_read_b64_tr_b16 v[150:151], v8 offset:28672
v_mfma_f32_16x16x32_bf16 v[20:23], v[156:159], a[80:83], v[20:23]
s_add_u32 s67, s69, 36864
v_fma_f32 v65, v65, s90, s90
v_cndmask_b32 v18, v18, v15, s[86:87]
v_mfma_f32_16x16x32_bf16 v[24:27], v[156:159], a[84:87], v[24:27]
v_rcp_f32 v65, v65
v_mfma_f32_16x16x32_bf16 v[28:31], v[156:159], a[88:91], v[28:31]
buffer_load_dwordx4 v2, s[16:19], s69 offen  lds
v_mfma_f32_16x16x32_bf16 v[32:35], v[156:159], a[92:95], v[32:35]
s_waitcnt lgkmcnt(2)
ds_read_b64_tr_b16 v[152:153], v8 offset:26624
ds_read_b64_tr_b16 v[154:155], v8 offset:30720
v_mul_f32 v81, v81, v65
v_mfma_f32_16x16x32_bf16 v[36:39], v[160:163], a[80:83], v[36:39]
s_add_u32 m0, s72, 53248
v_exp_f32 v66, v66
v_mfma_f32_16x16x32_bf16 v[40:43], v[160:163], a[84:87], v[40:43]
s_add_u32 s69, s69, 294912
v_fma_f32 v66, v66, s90, s90
s_sub_u32 s0, s69, 5308416
v_mfma_f32_16x16x32_bf16 v[44:47], v[160:163], a[88:91], v[44:47]
s_min_u32 s69, s69, s0
v_rcp_f32 v66, v66
v_mfma_f32_16x16x32_bf16 v[48:51], v[160:163], a[92:95], v[48:51]
s_waitcnt lgkmcnt(2)
ds_read_b64_tr_b16 v[156:157], v9 offset:24576
ds_read_b64_tr_b16 v[158:159], v9 offset:28672
v_mfma_f32_16x16x32_bf16 v[116:119], v[148:151], a[96:99], v[116:119]
buffer_load_dwordx4 v2, s[16:19], s67 offen  lds
v_mfma_f32_16x16x32_bf16 v[120:123], v[148:151], a[100:103], v[120:123]
s_add_u32 m0, s72, 57344
v_mul_f32 v82, v82, v66
s_add_u32 s67, s69, 36864
v_mfma_f32_16x16x32_bf16 v[124:127], v[148:151], a[104:107], v[124:127]
v_exp_f32 v67, v67
v_mfma_f32_16x16x32_bf16 v[128:131], v[148:151], a[108:111], v[128:131]
s_waitcnt lgkmcnt(2)
ds_read_b64_tr_b16 v[160:161], v9 offset:26624
ds_read_b64_tr_b16 v[162:163], v9 offset:30720
v_mfma_f32_16x16x32_bf16 v[132:135], v[152:155], a[96:99], v[132:135]
s_add_u32 s50, s23, 10240
v_fma_f32 v67, v67, s90, s90
v_cvt_pk_bf16_f32 v64, v80, v81
v_mfma_f32_16x16x32_bf16 v[136:139], v[152:155], a[100:103], v[136:139]
buffer_load_dwordx4 v2, s[16:19], s69 offen  lds
v_rcp_f32 v67, v67
v_mfma_f32_16x16x32_bf16 v[140:143], v[152:155], a[104:107], v[140:143]
s_add_u32 m0, s72, 61440
v_mul_f32 v83, v83, v67
s_add_u32 s69, s69, 294912
v_mfma_f32_16x16x32_bf16 v[144:147], v[152:155], a[108:111], v[144:147]
s_waitcnt lgkmcnt(2)
ds_read_b64_tr_b16 v[148:149], v8 offset:32768
ds_read_b64_tr_b16 v[150:151], v8 offset:36864
v_mfma_f32_16x16x32_bf16 v[20:23], v[156:159], a[96:99], v[20:23]
s_sub_u32 s0, s69, 5308416
v_cvt_pk_bf16_f32 v65, v82, v83
s_min_u32 s69, s69, s0
v_mfma_f32_16x16x32_bf16 v[24:27], v[156:159], a[100:103], v[24:27]
v_exp_f32 v84, v84
v_mfma_f32_16x16x32_bf16 v[28:31], v[156:159], a[104:107], v[28:31]
s_waitcnt vmcnt(20)
v_add_f32 v224, v224, v232
v_add_f32 v225, v225, v233
v_add_f32 v226, v226, v234
v_add_f32 v227, v227, v235
v_mfma_f32_16x16x32_bf16 v[32:35], v[156:159], a[108:111], v[32:35]
s_waitcnt lgkmcnt(2)
ds_read_b64_tr_b16 v[152:153], v8 offset:34816
ds_read_b64_tr_b16 v[154:155], v8 offset:38912
v_mfma_f32_16x16x32_bf16 v[36:39], v[160:163], a[96:99], v[36:39]
buffer_load_dwordx4 v[232:235], v1, s[32:35], s50 offen offset:0 sc1
v_fma_f32 v84, v84, s90, s90
v_mfma_f32_16x16x32_bf16 v[40:43], v[160:163], a[100:103], v[40:43]
s_waitcnt vmcnt(20)
v_add_f32 v228, v228, v236
v_add_f32 v229, v229, v237
v_add_f32 v230, v230, v238
v_add_f32 v231, v231, v239
v_mfma_f32_16x16x32_bf16 v[44:47], v[160:163], a[104:107], v[44:47]
v_rcp_f32 v84, v84
v_mfma_f32_16x16x32_bf16 v[48:51], v[160:163], a[108:111], v[48:51]
s_waitcnt vmcnt(19) lgkmcnt(2)
ds_read_b64_tr_b16 v[156:157], v9 offset:32768
v_add_f32 v224, v224, v240
v_add_f32 v225, v225, v241
v_add_f32 v226, v226, v242
v_mfma_f32_16x16x32_bf16 v[116:119], v[148:151], a[112:115], v[116:119]
s_waitcnt vmcnt(18)
ds_read_b64_tr_b16 v[158:159], v9 offset:36864
v_add_f32 v227, v227, v243
v_add_f32 v228, v228, v244
v_add_f32 v229, v229, v245
v_mfma_f32_16x16x32_bf16 v[120:123], v[148:151], a[116:119], v[120:123]
s_waitcnt vmcnt(17)
v_add_f32 v230, v230, v246
v_add_f32 v231, v231, v247
v_add_f32 v224, v224, v248
v_add_f32 v225, v225, v249
v_mfma_f32_16x16x32_bf16 v[124:127], v[148:151], a[120:123], v[124:127]
s_waitcnt vmcnt(16)
buffer_load_dwordx4 v[236:239], v1, s[32:35], s50 offen offset:1024 sc1
s_add_u32 s50, s23, 12288
v_add_f32 v226, v226, v250
v_mfma_f32_16x16x32_bf16 v[128:131], v[148:151], a[124:127], v[128:131]
s_waitcnt lgkmcnt(2)
ds_read_b64_tr_b16 v[160:161], v9 offset:34816
v_add_f32 v227, v227, v251
v_add_f32 v228, v228, v252
v_add_f32 v229, v229, v253
v_mfma_f32_16x16x32_bf16 v[132:135], v[152:155], a[112:115], v[132:135]
ds_read_b64_tr_b16 v[162:163], v9 offset:38912
v_add_f32 v230, v230, v254
v_add_f32 v231, v231, v255
v_mul_f32 v100, v100, v84
v_mfma_f32_16x16x32_bf16 v[136:139], v[152:155], a[116:119], v[136:139]
buffer_load_dwordx4 v[240:243], v1, s[32:35], s50 offen offset:0 sc1
v_exp_f32 v85, v85
v_mfma_f32_16x16x32_bf16 v[140:143], v[152:155], a[120:123], v[140:143]
buffer_load_dwordx4 v[244:247], v1, s[32:35], s50 offen offset:1024 sc1
v_fma_f32 v85, v85, s90, s90
v_rcp_f32 v85, v85
v_mfma_f32_16x16x32_bf16 v[144:147], v[152:155], a[124:127], v[144:147]
s_waitcnt lgkmcnt(2)
ds_read_b64_tr_b16 v[148:149], v8 offset:40960
s_add_u32 s50, s23, 14336
v_mul_f32 v101, v101, v85
v_exp_f32 v86, v86
v_mfma_f32_16x16x32_bf16 v[20:23], v[156:159], a[112:115], v[20:23]
ds_read_b64_tr_b16 v[150:151], v8 offset:45056
v_fma_f32 v86, v86, s90, s90
v_rcp_f32 v86, v86
v_mfma_f32_16x16x32_bf16 v[24:27], v[156:159], a[116:119], v[24:27]
buffer_load_dwordx4 v[248:251], v1, s[32:35], s50 offen offset:0 sc1
v_mul_f32 v102, v102, v86
v_mfma_f32_16x16x32_bf16 v[28:31], v[156:159], a[120:123], v[28:31]
v_exp_f32 v87, v87
v_mfma_f32_16x16x32_bf16 v[32:35], v[156:159], a[124:127], v[32:35]
s_waitcnt lgkmcnt(2)
ds_read_b64_tr_b16 v[152:153], v8 offset:43008
ds_read_b64_tr_b16 v[154:155], v8 offset:47104
v_fma_f32 v87, v87, s90, s90
v_mfma_f32_16x16x32_bf16 v[36:39], v[160:163], a[112:115], v[36:39]
buffer_load_dwordx4 v[252:255], v1, s[32:35], s50 offen offset:1024 sc1
v_rcp_f32 v87, v87
v_mfma_f32_16x16x32_bf16 v[40:43], v[160:163], a[116:119], v[40:43]
v_mul_f32 v103, v103, v87
v_cvt_pk_bf16_f32 v54, v100, v101
v_mfma_f32_16x16x32_bf16 v[44:47], v[160:163], a[120:123], v[44:47]
v_cvt_pk_bf16_f32 v55, v102, v103
v_mov_b32 v15, s99
v_mfma_f32_16x16x32_bf16 v[48:51], v[160:163], a[124:127], v[48:51]
s_waitcnt lgkmcnt(2)
ds_read_b64_tr_b16 v[156:157], v9 offset:40960
ds_read_b64_tr_b16 v[158:159], v9 offset:45056
v_mfma_f32_16x16x32_bf16 v[116:119], v[148:151], a[128:131], v[116:119]
buffer_load_dwordx4 v2, s[16:19], s67 offen  lds
v_mfma_f32_16x16x32_bf16 v[120:123], v[148:151], a[132:135], v[120:123]
s_add_u32 m0, s72, 65536
v_exp_f32 v88, v88
v_mfma_f32_16x16x32_bf16 v[124:127], v[148:151], a[136:139], v[124:127]
s_add_u32 s67, s69, 36864
v_fma_f32 v88, v88, s90, s90
v_and_b32 v3, 0x1ff, v14
v_mfma_f32_16x16x32_bf16 v[128:131], v[148:151], a[140:143], v[128:131]
s_waitcnt lgkmcnt(2)
ds_read_b64_tr_b16 v[160:161], v9 offset:43008
ds_read_b64_tr_b16 v[162:163], v9 offset:47104
v_mfma_f32_16x16x32_bf16 v[132:135], v[152:155], a[128:131], v[132:135]
s_waitcnt vmcnt(15)
buffer_load_dwordx4 v2, s[16:19], s69 offen  lds
v_mfma_f32_16x16x32_bf16 v[136:139], v[152:155], a[132:135], v[136:139]
s_add_u32 m0, s72, 69632
v_rcp_f32 v88, v88
v_mfma_f32_16x16x32_bf16 v[140:143], v[152:155], a[136:139], v[140:143]
s_barrier
v_mul_f32 v104, v104, v88
s_mul_i32 s69, s71, 589824
v_mfma_f32_16x16x32_bf16 v[144:147], v[152:155], a[140:143], v[144:147]
s_waitcnt lgkmcnt(2)
ds_read_b64_tr_b16 v[148:149], v4 offset:0
ds_read_b64_tr_b16 v[150:151], v4 offset:4096
v_mfma_f32_16x16x32_bf16 v[20:23], v[156:159], a[128:131], v[20:23]
buffer_load_dwordx4 v2, s[16:19], s67 offen  lds
v_mfma_f32_16x16x32_bf16 v[24:27], v[156:159], a[132:135], v[24:27]
s_add_u32 s67, s69, 36864
v_exp_f32 v89, v89
v_add_u32 v2, 128, v2
v_mfma_f32_16x16x32_bf16 v[28:31], v[156:159], a[136:139], v[28:31]
s_add_u32 m0, s72, 73728
v_fma_f32 v89, v89, s90, s90
v_mfma_f32_16x16x32_bf16 v[32:35], v[156:159], a[140:143], v[32:35]
s_waitcnt lgkmcnt(2)
ds_read_b64_tr_b16 v[152:153], v4 offset:2048
ds_read_b64_tr_b16 v[154:155], v4 offset:6144
v_mfma_f32_16x16x32_bf16 v[36:39], v[160:163], a[128:131], v[36:39]
v_rcp_f32 v89, v89
v_mfma_f32_16x16x32_bf16 v[40:43], v[160:163], a[132:135], v[40:43]
buffer_store_dwordx4 v[52:55], v1, s[32:35], s101 offen offset:0 sc1
v_mul_f32 v105, v105, v89
v_mfma_f32_16x16x32_bf16 v[44:47], v[160:163], a[136:139], v[44:47]
v_exp_f32 v90, v90
v_mfma_f32_16x16x32_bf16 v[48:51], v[160:163], a[140:143], v[48:51]
s_waitcnt lgkmcnt(2)
ds_read_b64_tr_b16 v[156:157], v5 offset:0
ds_read_b64_tr_b16 v[158:159], v5 offset:4096
v_mfma_f32_16x16x32_bf16 v[116:119], v[148:151], a[144:147], v[116:119]
v_fma_f32 v90, v90, s90, s90
v_cvt_pk_bf16_f32 v58, v104, v105
v_mfma_f32_16x16x32_bf16 v[120:123], v[148:151], a[148:151], v[120:123]
s_waitcnt vmcnt(17)
v_add_f32 v224, v224, v200
v_add_f32 v225, v225, v201
v_add_f32 v226, v226, v202
v_add_f32 v227, v227, v203
v_mfma_f32_16x16x32_bf16 v[124:127], v[148:151], a[152:155], v[124:127]
v_rcp_f32 v90, v90
v_mfma_f32_16x16x32_bf16 v[128:131], v[148:151], a[156:159], v[128:131]
s_waitcnt lgkmcnt(2)
ds_read_b64_tr_b16 v[160:161], v5 offset:2048
ds_read_b64_tr_b16 v[162:163], v5 offset:6144
v_mul_f32 v106, v106, v90
v_mfma_f32_16x16x32_bf16 v[132:135], v[152:155], a[144:147], v[132:135]
v_exp_f32 v91, v91
v_mfma_f32_16x16x32_bf16 v[136:139], v[152:155], a[148:151], v[136:139]
s_waitcnt vmcnt(16)
v_add_f32 v228, v228, v204
v_add_f32 v229, v229, v205
v_add_f32 v230, v230, v206
v_add_f32 v231, v231, v207
v_mfma_f32_16x16x32_bf16 v[140:143], v[152:155], a[152:155], v[140:143]
v_fma_f32 v91, v91, s90, s90
v_rcp_f32 v91, v91
v_mfma_f32_16x16x32_bf16 v[144:147], v[152:155], a[156:159], v[144:147]
s_waitcnt lgkmcnt(2)
ds_read_b64_tr_b16 v[148:149], v4 offset:8192
ds_read_b64_tr_b16 v[150:151], v4 offset:12288
v_mul_f32 v107, v107, v91
v_mfma_f32_16x16x32_bf16 v[20:23], v[156:159], a[144:147], v[20:23]
v_cvt_pk_bf16_f32 v59, v106, v107
v_mfma_f32_16x16x32_bf16 v[24:27], v[156:159], a[148:151], v[24:27]
v_exp_f32 v92, v92
v_mfma_f32_16x16x32_bf16 v[28:31], v[156:159], a[152:155], v[28:31]
v_fma_f32 v92, v92, s90, s90
v_mfma_f32_16x16x32_bf16 v[32:35], v[156:159], a[156:159], v[32:35]
s_waitcnt lgkmcnt(2)
ds_read_b64_tr_b16 v[152:153], v4 offset:10240
ds_read_b64_tr_b16 v[154:155], v4 offset:14336
v_mfma_f32_16x16x32_bf16 v[36:39], v[160:163], a[144:147], v[36:39]
v_rcp_f32 v92, v92
v_mfma_f32_16x16x32_bf16 v[40:43], v[160:163], a[148:151], v[40:43]
v_mul_f32 v108, v108, v92
v_mfma_f32_16x16x32_bf16 v[44:47], v[160:163], a[152:155], v[44:47]
v_exp_f32 v93, v93
v_mfma_f32_16x16x32_bf16 v[48:51], v[160:163], a[156:159], v[48:51]
s_waitcnt lgkmcnt(2)
ds_read_b64_tr_b16 v[156:157], v5 offset:8192
ds_read_b64_tr_b16 v[158:159], v5 offset:12288
v_mfma_f32_16x16x32_bf16 v[116:119], v[148:151], a[160:163], v[116:119]
buffer_load_dwordx4 v2, s[16:19], s69 offen  lds
v_mfma_f32_16x16x32_bf16 v[120:123], v[148:151], a[164:167], v[120:123]
s_add_u32 m0, s72, 77824
v_fma_f32 v93, v93, s90, s90
s_add_u32 s69, s69, 294912
v_mfma_f32_16x16x32_bf16 v[124:127], v[148:151], a[168:171], v[124:127]
s_sub_u32 s0, s69, 5308416
v_rcp_f32 v93, v93
v_mfma_f32_16x16x32_bf16 v[128:131], v[148:151], a[172:175], v[128:131]
s_waitcnt lgkmcnt(2)
ds_read_b64_tr_b16 v[160:161], v5 offset:10240
ds_read_b64_tr_b16 v[162:163], v5 offset:14336
v_mfma_f32_16x16x32_bf16 v[132:135], v[152:155], a[160:163], v[132:135]
s_min_u32 s69, s69, s0
v_mul_f32 v109, v109, v93
v_cvt_pk_bf16_f32 v62, v108, v109
v_mfma_f32_16x16x32_bf16 v[136:139], v[152:155], a[164:167], v[136:139]
buffer_load_dwordx4 v2, s[16:19], s67 offen  lds
v_mfma_f32_16x16x32_bf16 v[140:143], v[152:155], a[168:171], v[140:143]
s_add_u32 m0, s72, 81920
v_exp_f32 v94, v94
v_mfma_f32_16x16x32_bf16 v[144:147], v[152:155], a[172:175], v[144:147]
s_waitcnt lgkmcnt(2)
ds_read_b64_tr_b16 v[148:149], v4 offset:16384
ds_read_b64_tr_b16 v[150:151], v4 offset:20480
v_mfma_f32_16x16x32_bf16 v[20:23], v[156:159], a[160:163], v[20:23]
s_add_u32 s67, s69, 36864
v_fma_f32 v94, v94, s90, s90
v_mfma_f32_16x16x32_bf16 v[24:27], v[156:159], a[164:167], v[24:27]
v_rcp_f32 v94, v94
v_mfma_f32_16x16x32_bf16 v[28:31], v[156:159], a[168:171], v[28:31]
buffer_load_dwordx4 v2, s[16:19], s69 offen  lds
v_mfma_f32_16x16x32_bf16 v[32:35], v[156:159], a[172:175], v[32:35]
s_waitcnt lgkmcnt(2)
ds_read_b64_tr_b16 v[152:153], v4 offset:18432
ds_read_b64_tr_b16 v[154:155], v4 offset:22528
v_mul_f32 v110, v110, v94
v_mfma_f32_16x16x32_bf16 v[36:39], v[160:163], a[160:163], v[36:39]
s_add_u32 m0, s72, 86016
v_exp_f32 v95, v95
v_mfma_f32_16x16x32_bf16 v[40:43], v[160:163], a[164:167], v[40:43]
s_add_u32 s69, s69, 294912
v_fma_f32 v95, v95, s90, s90
s_sub_u32 s0, s69, 5308416
v_mfma_f32_16x16x32_bf16 v[44:47], v[160:163], a[168:171], v[44:47]
s_min_u32 s69, s69, s0
v_rcp_f32 v95, v95
v_mfma_f32_16x16x32_bf16 v[48:51], v[160:163], a[172:175], v[48:51]
s_waitcnt lgkmcnt(2)
ds_read_b64_tr_b16 v[156:157], v5 offset:16384
ds_read_b64_tr_b16 v[158:159], v5 offset:20480
v_mfma_f32_16x16x32_bf16 v[116:119], v[148:151], a[176:179], v[116:119]
buffer_load_dwordx4 v2, s[16:19], s67 offen  lds
v_mul_f32 v111, v111, v95
v_mfma_f32_16x16x32_bf16 v[120:123], v[148:151], a[180:183], v[120:123]
s_add_u32 m0, s72, 90112
v_cvt_pk_bf16_f32 v63, v110, v111
s_add_u32 s67, s69, 36864
v_mfma_f32_16x16x32_bf16 v[124:127], v[148:151], a[184:187], v[124:127]
v_exp_f32 v96, v96
v_mfma_f32_16x16x32_bf16 v[128:131], v[148:151], a[188:191], v[128:131]
s_waitcnt lgkmcnt(2)
ds_read_b64_tr_b16 v[160:161], v5 offset:18432
ds_read_b64_tr_b16 v[162:163], v5 offset:22528
v_mfma_f32_16x16x32_bf16 v[132:135], v[152:155], a[176:179], v[132:135]
buffer_store_dwordx4 v[56:59], v1, s[32:35], s101 offen offset:1024 sc1
v_mfma_f32_16x16x32_bf16 v[136:139], v[152:155], a[180:183], v[136:139]
v_fma_f32 v96, v96, s90, s90
s_xor_b32 s101, s101, 2048
v_mfma_f32_16x16x32_bf16 v[140:143], v[152:155], a[184:187], v[140:143]
v_rcp_f32 v96, v96
v_mfma_f32_16x16x32_bf16 v[144:147], v[152:155], a[188:191], v[144:147]
s_waitcnt lgkmcnt(2)
ds_read_b64_tr_b16 v[148:149], v4 offset:24576
ds_read_b64_tr_b16 v[150:151], v4 offset:28672
v_mfma_f32_16x16x32_bf16 v[20:23], v[156:159], a[176:179], v[20:23]
v_mul_f32 v112, v112, v96
v_mfma_f32_16x16x32_bf16 v[24:27], v[156:159], a[180:183], v[24:27]
v_exp_f32 v97, v97
v_mfma_f32_16x16x32_bf16 v[28:31], v[156:159], a[184:187], v[28:31]
v_fma_f32 v97, v97, s90, s90
v_mfma_f32_16x16x32_bf16 v[32:35], v[156:159], a[188:191], v[32:35]
s_waitcnt lgkmcnt(2)
ds_read_b64_tr_b16 v[152:153], v4 offset:26624
ds_read_b64_tr_b16 v[154:155], v4 offset:30720
v_mfma_f32_16x16x32_bf16 v[36:39], v[160:163], a[176:179], v[36:39]
s_waitcnt vmcnt(14)
v_add_f32 v224, v224, v232
v_add_f32 v225, v225, v233
v_add_f32 v226, v226, v234
v_add_f32 v227, v227, v235
v_mfma_f32_16x16x32_bf16 v[40:43], v[160:163], a[180:183], v[40:43]
v_rcp_f32 v97, v97
v_mfma_f32_16x16x32_bf16 v[44:47], v[160:163], a[184:187], v[44:47]
v_mul_f32 v113, v113, v97
v_cvt_pk_bf16_f32 v66, v112, v113
v_mfma_f32_16x16x32_bf16 v[48:51], v[160:163], a[188:191], v[48:51]
s_waitcnt lgkmcnt(2)
ds_read_b64_tr_b16 v[156:157], v5 offset:24576
ds_read_b64_tr_b16 v[158:159], v5 offset:28672
v_mfma_f32_16x16x32_bf16 v[116:119], v[148:151], a[192:195], v[116:119]
buffer_load_dwordx4 v2, s[16:19], s69 offen  lds
v_exp_f32 v98, v98
v_mfma_f32_16x16x32_bf16 v[120:123], v[148:151], a[196:199], v[120:123]
s_add_u32 m0, s72, 94208
v_fma_f32 v98, v98, s90, s90
s_add_u32 s69, s69, 294912
v_mfma_f32_16x16x32_bf16 v[124:127], v[148:151], a[200:203], v[124:127]
s_sub_u32 s0, s69, 5308416
v_rcp_f32 v98, v98
s_waitcnt vmcnt(14)
v_add_f32 v228, v228, v236
v_add_f32 v229, v229, v237
v_mfma_f32_16x16x32_bf16 v[128:131], v[148:151], a[204:207], v[128:131]
s_waitcnt vmcnt(13) lgkmcnt(2)
ds_read_b64_tr_b16 v[160:161], v5 offset:26624
v_add_f32 v230, v230, v238
v_add_f32 v231, v231, v239
v_add_f32 v224, v224, v240
v_mfma_f32_16x16x32_bf16 v[132:135], v[152:155], a[192:195], v[132:135]
s_min_u32 s69, s69, s0
ds_read_b64_tr_b16 v[162:163], v5 offset:30720
v_add_f32 v225, v225, v241
v_add_f32 v226, v226, v242
v_add_f32 v227, v227, v243
v_mfma_f32_16x16x32_bf16 v[136:139], v[152:155], a[196:199], v[136:139]
s_waitcnt vmcnt(12)
v_add_f32 v228, v228, v244
v_add_f32 v229, v229, v245
v_add_f32 v230, v230, v246
v_add_f32 v231, v231, v247
v_mfma_f32_16x16x32_bf16 v[140:143], v[152:155], a[200:203], v[140:143]
s_waitcnt vmcnt(11)
v_add_f32 v224, v224, v248
v_add_f32 v225, v225, v249
v_add_f32 v226, v226, v250
v_add_f32 v227, v227, v251
v_mfma_f32_16x16x32_bf16 v[144:147], v[152:155], a[204:207], v[144:147]
s_waitcnt vmcnt(10) lgkmcnt(2)
ds_read_b64_tr_b16 v[148:149], v4 offset:32768
v_add_f32 v228, v228, v252
v_add_f32 v229, v229, v253
v_add_f32 v230, v230, v254
v_mfma_f32_16x16x32_bf16 v[20:23], v[156:159], a[192:195], v[20:23]
v_add_f32 v231, v231, v255
v_mul_f32 v114, v114, v98
v_exp_f32 v99, v99
v_mfma_f32_16x16x32_bf16 v[24:27], v[156:159], a[196:199], v[24:27]
ds_write_b128 v16, v[224:227] offset:0
v_fma_f32 v99, v99, s90, s90
v_rcp_f32 v99, v99
v_mfma_f32_16x16x32_bf16 v[28:31], v[156:159], a[200:203], v[28:31]
ds_write_b128 v16, v[228:231] offset:1024
s_waitcnt vmcnt(7) lgkmcnt(0)
s_barrier
v_mul_f32 v115, v115, v99
v_mfma_f32_16x16x32_bf16 v[32:35], v[156:159], a[204:207], v[32:35]
ds_read_b64_tr_b16 v[150:151], v4 offset:36864
ds_read_b64_tr_b16 v[152:153], v4 offset:34816
v_mfma_f32_16x16x32_bf16 v[36:39], v[160:163], a[192:195], v[36:39]
ds_read_b64_tr_b16 v[154:155], v4 offset:38912
v_cvt_pk_bf16_f32 v67, v114, v115
v_mfma_f32_16x16x32_bf16 v[40:43], v[160:163], a[196:199], v[40:43]
buffer_load_dwordx4 v2, s[16:19], s67 offen  lds
v_mfma_f32_16x16x32_bf16 v[44:47], v[160:163], a[200:203], v[44:47]
s_add_u32 m0, s72, 98304
ds_read_b128 v[232:235], v17 offset:0
s_add_u32 s67, s69, 36864
v_mfma_f32_16x16x32_bf16 v[48:51], v[160:163], a[204:207], v[48:51]
s_waitcnt lgkmcnt(3)
ds_read_b64_tr_b16 v[156:157], v5 offset:32768
ds_read_b64_tr_b16 v[158:159], v5 offset:36864
v_mfma_f32_16x16x32_bf16 v[116:119], v[148:151], a[208:211], v[116:119]
buffer_load_dwordx4 v2, s[16:19], s69 offen  lds
v_mfma_f32_16x16x32_bf16 v[120:123], v[148:151], a[212:215], v[120:123]
s_add_u32 m0, s72, 102400
ds_read_b128 v[236:239], v17 offset:1024
s_add_u32 s69, s69, 294912
v_mfma_f32_16x16x32_bf16 v[124:127], v[148:151], a[216:219], v[124:127]
s_sub_u32 s0, s69, 5308416
v_and_b32 v240, 15, v0
s_min_u32 s69, s69, s0
v_mfma_f32_16x16x32_bf16 v[128:131], v[148:151], a[220:223], v[128:131]
s_waitcnt lgkmcnt(4)
ds_read_b64_tr_b16 v[160:161], v5 offset:34816
ds_read_b64_tr_b16 v[162:163], v5 offset:38912
v_mfma_f32_16x16x32_bf16 v[132:135], v[152:155], a[208:211], v[132:135]
s_waitcnt lgkmcnt(5)
buffer_load_dwordx4 v2, s[16:19], s67 offen  lds
v_mfma_f32_16x16x32_bf16 v[136:139], v[152:155], a[212:215], v[136:139]
s_add_u32 m0, s72, 106496
v_add_f32 v224, v224, v232
s_add_u32 s67, s69, 36864
v_mfma_f32_16x16x32_bf16 v[140:143], v[152:155], a[216:219], v[140:143]
v_add_f32 v225, v225, v233
v_add_f32 v226, v226, v234
v_mfma_f32_16x16x32_bf16 v[144:147], v[152:155], a[220:223], v[144:147]
s_waitcnt lgkmcnt(3)
ds_read_b64_tr_b16 v[148:149], v4 offset:40960
ds_read_b64_tr_b16 v[150:151], v4 offset:45056
v_mfma_f32_16x16x32_bf16 v[20:23], v[156:159], a[208:211], v[20:23]
s_waitcnt lgkmcnt(4)
buffer_load_dwordx4 v2, s[16:19], s69 offen  lds
v_mfma_f32_16x16x32_bf16 v[24:27], v[156:159], a[212:215], v[24:27]
s_add_u32 m0, s72, 110592
v_add_f32 v227, v227, v235
s_add_u32 s69, s69, 294912
v_mfma_f32_16x16x32_bf16 v[28:31], v[156:159], a[216:219], v[28:31]
s_sub_u32 s0, s69, 5308416
v_add_f32 v228, v228, v236
s_min_u32 s69, s69, s0
v_mfma_f32_16x16x32_bf16 v[32:35], v[156:159], a[220:223], v[32:35]
s_waitcnt lgkmcnt(2)
ds_read_b64_tr_b16 v[152:153], v4 offset:43008
ds_read_b64_tr_b16 v[154:155], v4 offset:47104
v_mfma_f32_16x16x32_bf16 v[36:39], v[160:163], a[208:211], v[36:39]
buffer_store_dwordx4 v[60:63], v1, s[32:35], s101 offen offset:0 sc1
v_mfma_f32_16x16x32_bf16 v[40:43], v[160:163], a[212:215], v[40:43]
v_add_f32 v229, v229, v237
v_add_f32 v230, v230, v238
v_mfma_f32_16x16x32_bf16 v[44:47], v[160:163], a[216:219], v[44:47]
v_add_f32 v231, v231, v239
v_mul_u32_u24 v240, 40, v240
v_mfma_f32_16x16x32_bf16 v[48:51], v[160:163], a[220:223], v[48:51]
s_waitcnt lgkmcnt(2)
ds_read_b64_tr_b16 v[156:157], v5 offset:40960
ds_read_b64_tr_b16 v[158:159], v5 offset:45056
v_mfma_f32_16x16x32_bf16 v[116:119], v[148:151], a[224:227], v[116:119]
v_lshrrev_b32 v241, 4, v0
v_lshl_add_u32 v240, v241, 3, v240
v_mfma_f32_16x16x32_bf16 v[120:123], v[148:151], a[228:231], v[120:123]
v_add_u32 v240, s40, v240
v_cvt_pk_bf16_f32 v224, v224, v225
v_mfma_f32_16x16x32_bf16 v[124:127], v[148:151], a[232:235], v[124:127]
v_cvt_pk_bf16_f32 v225, v226, v227
v_cvt_pk_bf16_f32 v226, v228, v229
v_mfma_f32_16x16x32_bf16 v[128:131], v[148:151], a[236:239], v[128:131]
s_waitcnt lgkmcnt(2)
ds_read_b64_tr_b16 v[160:161], v5 offset:43008
v_cvt_pk_bf16_f32 v227, v230, v231
v_mfma_f32_16x16x32_bf16 v[132:135], v[152:155], a[224:227], v[132:135]
ds_write_b64 v240, v[226:227] offset:3072
v_mfma_f32_16x16x32_bf16 v[136:139], v[152:155], a[228:231], v[136:139]
ds_read_b64_tr_b16 v[162:163], v5 offset:47104
v_lshrrev_b32 v241, 2, v0
v_mfma_f32_16x16x32_bf16 v[140:143], v[152:155], a[232:235], v[140:143]
v_mul_u32_u24 v241, 40, v241
v_and_b32 v242, 12, v10
v_mfma_f32_16x16x32_bf16 v[144:147], v[152:155], a[236:239], v[144:147]
s_waitcnt lgkmcnt(3)
buffer_load_dwordx4 v2, s[16:19], s67 offen  lds
v_mfma_f32_16x16x32_bf16 v[20:23], v[156:159], a[224:227], v[20:23]
s_add_u32 m0, s72, 114688
v_lshl_add_u32 v241, v242, 1, v241
v_add_u32 v241, s40, v241
v_mfma_f32_16x16x32_bf16 v[24:27], v[156:159], a[228:231], v[24:27]
s_add_u32 s67, s69, 36864
v_permlane32_swap_b32 v226, v230
v_permlane32_swap_b32 v227, v231
v_mfma_f32_16x16x32_bf16 v[28:31], v[156:159], a[232:235], v[28:31]
s_waitcnt lgkmcnt(1)
ds_read_b64_tr_b16 v[228:229], v241 offset:3072
ds_read_b64_tr_b16 v[148:149], v6 offset:0
v_mfma_f32_16x16x32_bf16 v[32:35], v[156:159], a[236:239], v[32:35]
s_waitcnt lgkmcnt(2)
ds_read_b64_tr_b16 v[150:151], v6 offset:4096
v_cndmask_b32 v226, 0, v226, s[82:83]
v_mfma_f32_16x16x32_bf16 v[36:39], v[160:163], a[224:227], v[36:39]
v_cndmask_b32 v227, 0, v227, s[84:85]
v_cndmask_b32 v230, 0, v230, s[82:83]
v_mfma_f32_16x16x32_bf16 v[40:43], v[160:163], a[228:231], v[40:43]
v_cndmask_b32 v231, 0, v231, s[84:85]
v_mov_b32_dpp v238, v230 row_newbcast:12 row_mask:0xf bank_mask:0xf
v_mfma_f32_16x16x32_bf16 v[44:47], v[160:163], a[232:235], v[44:47]
ds_read_b64_tr_b16 v[152:153], v6 offset:2048
v_mov_b32_dpp v239, v231 row_newbcast:12 row_mask:0xf bank_mask:0xf
v_mfma_f32_16x16x32_bf16 v[48:51], v[160:163], a[236:239], v[48:51]
s_waitcnt lgkmcnt(3)
ds_read_b64_tr_b16 v[154:155], v6 offset:6144
v_mov_b32_dpp v236, v228 row_newbcast:12 row_mask:0xf bank_mask:0xf
v_mfma_f32_16x16x32_bf16 v[240:243], v[224:227], v[208:211], 0
v_mov_b32_dpp v237, v229 row_newbcast:12 row_mask:0xf bank_mask:0xf
v_add_u32 v16, s76, v1
v_mfma_f32_16x16x32_bf16 v[244:247], v[228:231], v[208:211], 0
buffer_store_dwordx4 v[64:67], v1, s[32:35], s101 offen offset:1024 sc1
v_mfma_f32_16x16x32_bf16 v[248:251], v[236:239], v[208:211], 0
s_waitcnt lgkmcnt(2)
ds_read_b64_tr_b16 v[156:157], v7 offset:0
ds_read_b64_tr_b16 v[158:159], v7 offset:4096
v_mfma_f32_16x16x32_bf16 v[116:119], v[148:151], a[240:243], v[116:119]
s_add_u32 s101, s2, 40960
v_mfma_f32_16x16x32_bf16 v[120:123], v[148:151], a[244:247], v[120:123]
v_mfma_f32_16x16x32_bf16 v[124:127], v[148:151], a[248:251], v[124:127]
v_mfma_f32_16x16x32_bf16 v[128:131], v[148:151], a[252:255], v[128:131]
s_waitcnt lgkmcnt(2)
ds_read_b64_tr_b16 v[160:161], v7 offset:2048
ds_read_b64_tr_b16 v[162:163], v7 offset:6144
v_mfma_f32_16x16x32_bf16 v[132:135], v[152:155], a[240:243], v[132:135]
v_fma_f32 v248, v248, s90, v15
v_mfma_f32_16x16x32_bf16 v[136:139], v[152:155], a[244:247], v[136:139]
v_rcp_f32 v248, v248
v_mfma_f32_16x16x32_bf16 v[140:143], v[152:155], a[248:251], v[140:143]
v_mul_f32 v240, v240, v248
v_mul_f32 v241, v241, v248
v_mfma_f32_16x16x32_bf16 v[144:147], v[152:155], a[252:255], v[144:147]
s_waitcnt lgkmcnt(2)
ds_read_b64_tr_b16 v[148:149], v6 offset:8192
ds_read_b64_tr_b16 v[150:151], v6 offset:12288
v_mfma_f32_16x16x32_bf16 v[20:23], v[156:159], a[240:243], v[20:23]
v_mul_f32 v242, v242, v248
v_mul_f32 v243, v243, v248
v_mfma_f32_16x16x32_bf16 v[24:27], v[156:159], a[244:247], v[24:27]
buffer_load_dwordx4 v2, s[16:19], s69 offen  lds
v_mfma_f32_16x16x32_bf16 v[28:31], v[156:159], a[248:251], v[28:31]
s_add_u32 m0, s72, 118784
v_mul_f32 v244, v244, v248
s_add_u32 s69, s69, 294912
v_mfma_f32_16x16x32_bf16 v[32:35], v[156:159], a[252:255], v[32:35]
s_waitcnt lgkmcnt(2)
ds_read_b64_tr_b16 v[152:153], v6 offset:10240
ds_read_b64_tr_b16 v[154:155], v6 offset:14336
v_mfma_f32_16x16x32_bf16 v[36:39], v[160:163], a[240:243], v[36:39]
s_sub_u32 s0, s69, 5308416
buffer_load_dwordx4 v2, s[16:19], s67 offen  lds
v_mfma_f32_16x16x32_bf16 v[40:43], v[160:163], a[244:247], v[40:43]
s_min_u32 s69, s69, s0
v_mul_f32 v245, v245, v248
s_add_u32 m0, s72, 122880
v_mfma_f32_16x16x32_bf16 v[44:47], v[160:163], a[248:251], v[44:47]
s_add_u32 s67, s69, 36864
v_mul_f32 v246, v246, v248
v_mul_f32 v247, v247, v248
v_mfma_f32_16x16x32_bf16 v[48:51], v[160:163], a[252:255], v[48:51]
s_waitcnt lgkmcnt(2)
ds_read_b64_tr_b16 v[156:157], v7 offset:8192
ds_read_b64_tr_b16 v[158:159], v7 offset:12288
v_mfma_f32_16x16x32_bf16 v[116:119], v[148:151], v[168:171], v[116:119]
buffer_load_dwordx4 v2, s[16:19], s69 offen  lds
v_mfma_f32_16x16x32_bf16 v[120:123], v[148:151], v[172:175], v[120:123]
s_add_u32 m0, s72, 126976
v_cvt_pk_bf16_f32 v252, v240, v241
s_add_u32 s69, s69, 294912
v_mfma_f32_16x16x32_bf16 v[124:127], v[148:151], v[176:179], v[124:127]
s_sub_u32 s0, s69, 5308416
v_cvt_pk_bf16_f32 v253, v242, v243
s_min_u32 s69, s69, s0
v_mfma_f32_16x16x32_bf16 v[128:131], v[148:151], v[180:183], v[128:131]
s_waitcnt lgkmcnt(2)
ds_read_b64_tr_b16 v[160:161], v7 offset:10240
ds_read_b64_tr_b16 v[162:163], v7 offset:14336
v_mfma_f32_16x16x32_bf16 v[132:135], v[152:155], v[168:171], v[132:135]
buffer_load_dwordx4 v2, s[16:19], s67 offen  lds
v_mfma_f32_16x16x32_bf16 v[136:139], v[152:155], v[172:175], v[136:139]
s_add_u32 m0, s72, 131072
v_cvt_pk_bf16_f32 v244, v244, v245
s_add_u32 s67, s69, 36864
v_mfma_f32_16x16x32_bf16 v[140:143], v[152:155], v[176:179], v[140:143]
v_cvt_pk_bf16_f32 v246, v246, v247
v_cndmask_b32 v232, v244, v246, s[88:89]
v_mfma_f32_16x16x32_bf16 v[144:147], v[152:155], v[180:183], v[144:147]
s_waitcnt lgkmcnt(2)
buffer_load_dwordx4 v2, s[16:19], s69 offen  lds
v_mfma_f32_16x16x32_bf16 v[20:23], v[156:159], v[168:171], v[20:23]
s_add_u32 m0, s72, 135168
v_mfma_f32_16x16x32_bf16 v[24:27], v[156:159], v[172:175], v[24:27]
s_add_u32 s69, s69, 294912
v_mfma_f32_16x16x32_bf16 v[28:31], v[156:159], v[176:179], v[28:31]
s_sub_u32 s0, s69, 5308416
ds_read_b64_tr_b16 v[148:149], v6 offset:16384
ds_read_b64_tr_b16 v[150:151], v6 offset:20480
v_mfma_f32_16x16x32_bf16 v[32:35], v[156:159], v[180:183], v[32:35]
s_waitcnt lgkmcnt(2)
buffer_load_dwordx4 v2, s[16:19], s67 offen  lds
v_mfma_f32_16x16x32_bf16 v[36:39], v[160:163], v[168:171], v[36:39]
s_min_u32 s69, s69, s0
v_mfma_f32_16x16x32_bf16 v[40:43], v[160:163], v[172:175], v[40:43]
s_add_u32 m0, s72, 139264
v_mfma_f32_16x16x32_bf16 v[44:47], v[160:163], v[176:179], v[44:47]
s_add_u32 s67, s69, 36864
ds_read_b64_tr_b16 v[152:153], v6 offset:18432
ds_read_b64_tr_b16 v[154:155], v6 offset:22528
v_mfma_f32_16x16x32_bf16 v[48:51], v[160:163], v[180:183], v[48:51]
buffer_load_dwordx4 v2, s[16:19], s69 offen  lds
v_mfma_f32_16x16x32_bf16 v[240:243], v[224:227], v[212:215], 0
s_add_u32 m0, s72, 143360
v_mfma_f32_16x16x32_bf16 v[244:247], v[228:231], v[212:215], 0
v_mfma_f32_16x16x32_bf16 v[248:251], v[236:239], v[212:215], 0
s_waitcnt lgkmcnt(2)
ds_read_b64_tr_b16 v[156:157], v7 offset:16384
ds_read_b64_tr_b16 v[158:159], v7 offset:20480
v_mfma_f32_16x16x32_bf16 v[116:119], v[148:151], v[184:187], v[116:119]
buffer_load_dwordx4 v2, s[16:19], s67 offen  lds
v_mfma_f32_16x16x32_bf16 v[120:123], v[148:151], v[188:191], v[120:123]
v_mfma_f32_16x16x32_bf16 v[124:127], v[148:151], v[192:195], v[124:127]
v_mfma_f32_16x16x32_bf16 v[128:131], v[148:151], v[196:199], v[128:131]
s_waitcnt lgkmcnt(2)
ds_read_b64_tr_b16 v[160:161], v7 offset:18432
ds_read_b64_tr_b16 v[162:163], v7 offset:22528
v_mfma_f32_16x16x32_bf16 v[132:135], v[152:155], v[184:187], v[132:135]
s_waitcnt vmcnt(11)
v_fma_f32 v248, v248, s90, v15
v_mfma_f32_16x16x32_bf16 v[136:139], v[152:155], v[188:191], v[136:139]
s_barrier
v_rcp_f32 v248, v248
v_mfma_f32_16x16x32_bf16 v[140:143], v[152:155], v[192:195], v[140:143]
s_add_u32 s69, s69, 294912
v_mul_f32 v240, v240, v248
s_sub_u32 s0, s69, 5308416
v_mfma_f32_16x16x32_bf16 v[144:147], v[152:155], v[196:199], v[144:147]
s_waitcnt lgkmcnt(2)
ds_read_b64_tr_b16 v[148:149], v6 offset:24576
ds_read_b64_tr_b16 v[150:151], v6 offset:28672
v_mfma_f32_16x16x32_bf16 v[20:23], v[156:159], v[184:187], v[20:23]
s_min_u32 s69, s69, s0
v_mul_f32 v241, v241, v248
s_add_u32 m0, s72, 0
v_mfma_f32_16x16x32_bf16 v[24:27], v[156:159], v[188:191], v[24:27]
s_add_u32 s67, s69, 36864
buffer_load_dwordx4 v2, s[16:19], s69 offen  lds
v_mfma_f32_16x16x32_bf16 v[28:31], v[156:159], v[192:195], v[28:31]
s_add_u32 m0, s72, 4096
v_mul_f32 v242, v242, v248
v_mul_f32 v243, v243, v248
v_mfma_f32_16x16x32_bf16 v[32:35], v[156:159], v[196:199], v[32:35]
s_waitcnt lgkmcnt(2)
ds_read_b64_tr_b16 v[152:153], v6 offset:26624
ds_read_b64_tr_b16 v[154:155], v6 offset:30720
v_mfma_f32_16x16x32_bf16 v[36:39], v[160:163], v[184:187], v[36:39]
v_mul_f32 v244, v244, v248
v_mul_f32 v245, v245, v248
v_mfma_f32_16x16x32_bf16 v[40:43], v[160:163], v[188:191], v[40:43]
v_mul_f32 v246, v246, v248
v_mul_f32 v247, v247, v248
v_mfma_f32_16x16x32_bf16 v[44:47], v[160:163], v[192:195], v[44:47]
s_add_u32 s69, s69, 294912
buffer_load_dwordx4 v2, s[16:19], s67 offen  lds
v_mfma_f32_16x16x32_bf16 v[48:51], v[160:163], v[196:199], v[48:51]
s_waitcnt lgkmcnt(2)
ds_read_b64_tr_b16 v[156:157], v7 offset:24576
ds_read_b64_tr_b16 v[158:159], v7 offset:28672
v_mfma_f32_16x16x32_bf16 v[52:55], v[148:151], a[0:3], 0
s_sub_u32 s0, s69, 5308416
v_exp_f32 v116, v116
v_mfma_f32_16x16x32_bf16 v[56:59], v[148:151], a[4:7], 0
s_min_u32 s69, s69, s0
v_cvt_pk_bf16_f32 v254, v240, v241
s_add_u32 m0, s72, 8192
v_mfma_f32_16x16x32_bf16 v[60:63], v[148:151], a[8:11], 0
v_fma_f32 v116, v116, s90, s90
v_cvt_pk_bf16_f32 v255, v242, v243
v_mfma_f32_16x16x32_bf16 v[64:67], v[148:151], a[12:15], 0
s_waitcnt lgkmcnt(2)
ds_read_b64_tr_b16 v[160:161], v7 offset:26624
ds_read_b64_tr_b16 v[162:163], v7 offset:30720
v_mfma_f32_16x16x32_bf16 v[68:71], v[152:155], a[0:3], 0
s_add_u32 s67, s69, 36864
buffer_load_dwordx4 v2, s[16:19], s69 offen  lds
v_mfma_f32_16x16x32_bf16 v[72:75], v[152:155], a[4:7], 0
s_add_u32 m0, s72, 12288
v_cvt_pk_bf16_f32 v244, v244, v245
v_mov_b32 v12, 2
v_mfma_f32_16x16x32_bf16 v[76:79], v[152:155], a[8:11], 0
v_rcp_f32 v116, v116
v_mfma_f32_16x16x32_bf16 v[80:83], v[152:155], a[12:15], 0
s_waitcnt lgkmcnt(2)
v_cvt_pk_bf16_f32 v246, v246, v247
v_mul_f32 v132, v132, v116
v_mfma_f32_16x16x32_bf16 v[84:87], v[156:159], a[0:3], 0
s_add_u32 s69, s69, 294912
v_cndmask_b32 v233, v244, v246, s[88:89]
v_mfma_f32_16x16x32_bf16 v[88:91], v[156:159], a[4:7], 0
s_sub_u32 s0, s69, 5308416
buffer_load_dwordx4 v2, s[16:19], s67 offen  lds
v_mfma_f32_16x16x32_bf16 v[92:95], v[156:159], a[8:11], 0
s_min_u32 s69, s69, s0
ds_read_b64_tr_b16 v[148:149], v6 offset:32768
ds_read_b64_tr_b16 v[150:151], v6 offset:36864
v_mfma_f32_16x16x32_bf16 v[96:99], v[156:159], a[12:15], 0
s_waitcnt lgkmcnt(2)
v_exp_f32 v117, v117
v_mfma_f32_16x16x32_bf16 v[100:103], v[160:163], a[0:3], 0
s_add_u32 m0, s72, 16384
v_fma_f32 v117, v117, s90, s90
v_mfma_f32_16x16x32_bf16 v[104:107], v[160:163], a[4:7], 0
s_add_u32 s67, s69, 36864
v_rcp_f32 v117, v117
v_mfma_f32_16x16x32_bf16 v[108:111], v[160:163], a[8:11], 0
ds_read_b64_tr_b16 v[152:153], v6 offset:34816
ds_read_b64_tr_b16 v[154:155], v6 offset:38912
v_mfma_f32_16x16x32_bf16 v[112:115], v[160:163], a[12:15], 0
buffer_store_dword v12, v13, s[32:35], s77 offen sc1
v_mfma_f32_16x16x32_bf16 v[240:243], v[224:227], v[216:219], 0
v_mul_f32 v133, v133, v117
v_cvt_pk_bf16_f32 v116, v132, v133
v_mfma_f32_16x16x32_bf16 v[244:247], v[228:231], v[216:219], 0
v_exp_f32 v118, v118
v_mfma_f32_16x16x32_bf16 v[248:251], v[236:239], v[216:219], 0
s_waitcnt lgkmcnt(2)
ds_read_b64_tr_b16 v[156:157], v7 offset:32768
ds_read_b64_tr_b16 v[158:159], v7 offset:36864
v_mfma_f32_16x16x32_bf16 v[52:55], v[148:151], a[16:19], v[52:55]
v_fma_f32 v118, v118, s90, s90
v_mfma_f32_16x16x32_bf16 v[56:59], v[148:151], a[20:23], v[56:59]
v_rcp_f32 v118, v118
v_mfma_f32_16x16x32_bf16 v[60:63], v[148:151], a[24:27], v[60:63]
v_mul_f32 v134, v134, v118
v_fma_f32 v248, v248, s90, v15
v_mfma_f32_16x16x32_bf16 v[64:67], v[148:151], a[28:31], v[64:67]
s_waitcnt lgkmcnt(2)
ds_read_b64_tr_b16 v[160:161], v7 offset:34816
ds_read_b64_tr_b16 v[162:163], v7 offset:38912
v_mfma_f32_16x16x32_bf16 v[68:71], v[152:155], a[16:19], v[68:71]
buffer_load_dwordx4 v2, s[16:19], s69 offen  lds
v_mfma_f32_16x16x32_bf16 v[72:75], v[152:155], a[20:23], v[72:75]
s_add_u32 m0, s72, 20480
v_exp_f32 v119, v119
v_mfma_f32_16x16x32_bf16 v[76:79], v[152:155], a[24:27], v[76:79]
s_add_u32 s69, s69, 294912
v_rcp_f32 v248, v248
v_mfma_f32_16x16x32_bf16 v[80:83], v[152:155], a[28:31], v[80:83]
s_waitcnt lgkmcnt(2)
ds_read_b64_tr_b16 v[148:149], v6 offset:40960
ds_read_b64_tr_b16 v[150:151], v6 offset:45056
v_mfma_f32_16x16x32_bf16 v[84:87], v[156:159], a[16:19], v[84:87]
s_sub_u32 s0, s69, 5308416
v_fma_f32 v119, v119, s90, s90
s_min_u32 s69, s69, s0
v_mfma_f32_16x16x32_bf16 v[88:91], v[156:159], a[20:23], v[88:91]
buffer_store_dwordx2 v[232:233], v18, s[32:35], s42 offen sc1
v_mfma_f32_16x16x32_bf16 v[92:95], v[156:159], a[24:27], v[92:95]
s_add_u32 s42, s42, s48
v_mul_f32 v240, v240, v248
v_mul_f32 v241, v241, v248
v_mfma_f32_16x16x32_bf16 v[96:99], v[156:159], a[28:31], v[96:99]
s_waitcnt lgkmcnt(2)
ds_read_b64_tr_b16 v[152:153], v6 offset:43008
ds_read_b64_tr_b16 v[154:155], v6 offset:47104
v_mfma_f32_16x16x32_bf16 v[100:103], v[160:163], a[16:19], v[100:103]
v_rcp_f32 v119, v119
v_mfma_f32_16x16x32_bf16 v[104:107], v[160:163], a[20:23], v[104:107]
v_mul_f32 v242, v242, v248
v_mul_f32 v135, v135, v119
v_mfma_f32_16x16x32_bf16 v[108:111], v[160:163], a[24:27], v[108:111]
v_mul_f32 v243, v243, v248
v_mul_f32 v244, v244, v248
v_mfma_f32_16x16x32_bf16 v[112:115], v[160:163], a[28:31], v[112:115]
s_waitcnt lgkmcnt(2)
ds_read_b64_tr_b16 v[156:157], v7 offset:40960
ds_read_b64_tr_b16 v[158:159], v7 offset:45056
v_mfma_f32_16x16x32_bf16 v[52:55], v[148:151], a[32:35], v[52:55]
buffer_store_dwordx4 v[252:255], v1, s[32:35], s41 offen sc1
v_mfma_f32_16x16x32_bf16 v[56:59], v[148:151], a[36:39], v[56:59]
v_mul_f32 v245, v245, v248
v_cvt_pk_bf16_f32 v117, v134, v135
v_mfma_f32_16x16x32_bf16 v[60:63], v[148:151], a[40:43], v[60:63]
s_add_u32 s41, s41, s48
v_mul_f32 v246, v246, v248
v_mul_f32 v247, v247, v248
v_mfma_f32_16x16x32_bf16 v[64:67], v[148:151], a[44:47], v[64:67]
s_waitcnt lgkmcnt(2)
ds_read_b64_tr_b16 v[160:161], v7 offset:43008
ds_read_b64_tr_b16 v[162:163], v7 offset:47104
v_mfma_f32_16x16x32_bf16 v[68:71], v[152:155], a[32:35], v[68:71]
v_exp_f32 v120, v120
v_mfma_f32_16x16x32_bf16 v[72:75], v[152:155], a[36:39], v[72:75]
v_cvt_pk_bf16_f32 v252, v240, v241
v_fma_f32 v120, v120, s90, s90
v_mfma_f32_16x16x32_bf16 v[76:79], v[152:155], a[40:43], v[76:79]
v_cvt_pk_bf16_f32 v253, v242, v243
v_cvt_pk_bf16_f32 v244, v244, v245
v_mfma_f32_16x16x32_bf16 v[80:83], v[152:155], a[44:47], v[80:83]
s_waitcnt lgkmcnt(2)
v_rcp_f32 v120, v120
v_mfma_f32_16x16x32_bf16 v[84:87], v[156:159], a[32:35], v[84:87]
v_cvt_pk_bf16_f32 v246, v246, v247
v_mul_f32 v136, v136, v120
v_mfma_f32_16x16x32_bf16 v[88:91], v[156:159], a[36:39], v[88:91]
v_cndmask_b32 v232, v244, v246, s[88:89]
v_mfma_f32_16x16x32_bf16 v[92:95], v[156:159], a[40:43], v[92:95]
ds_read_b64_tr_b16 v[148:149], v8 offset:0
ds_read_b64_tr_b16 v[150:151], v8 offset:4096
v_mfma_f32_16x16x32_bf16 v[96:99], v[156:159], a[44:47], v[96:99]
s_waitcnt lgkmcnt(2)
buffer_load_dwordx4 v2, s[16:19], s67 offen  lds
v_mfma_f32_16x16x32_bf16 v[100:103], v[160:163], a[32:35], v[100:103]
s_add_u32 m0, s72, 24576
v_exp_f32 v121, v121
v_mfma_f32_16x16x32_bf16 v[104:107], v[160:163], a[36:39], v[104:107]
s_add_u32 s67, s69, 36864
v_fma_f32 v121, v121, s90, s90
v_mfma_f32_16x16x32_bf16 v[108:111], v[160:163], a[40:43], v[108:111]
ds_read_b64_tr_b16 v[152:153], v8 offset:2048
ds_read_b64_tr_b16 v[154:155], v8 offset:6144
v_mfma_f32_16x16x32_bf16 v[112:115], v[160:163], a[44:47], v[112:115]
buffer_load_dwordx4 v2, s[16:19], s69 offen  lds
v_mfma_f32_16x16x32_bf16 v[240:243], v[224:227], v[220:223], 0
s_add_u32 m0, s72, 28672
v_rcp_f32 v121, v121
v_mfma_f32_16x16x32_bf16 v[244:247], v[228:231], v[220:223], 0
s_add_u32 s69, s69, 294912
v_mul_f32 v137, v137, v121
s_sub_u32 s0, s69, 5308416
v_mfma_f32_16x16x32_bf16 v[248:251], v[236:239], v[220:223], 0
s_waitcnt lgkmcnt(2)
ds_read_b64_tr_b16 v[156:157], v9 offset:0
ds_read_b64_tr_b16 v[158:159], v9 offset:4096
v_mfma_f32_16x16x32_bf16 v[52:55], v[148:151], a[48:51], v[52:55]
s_min_u32 s69, s69, s0
buffer_load_dwordx4 v2, s[16:19], s67 offen  lds
v_mfma_f32_16x16x32_bf16 v[56:59], v[148:151], a[52:55], v[56:59]
s_add_u32 m0, s72, 32768
v_exp_f32 v122, v122
v_mfma_f32_16x16x32_bf16 v[60:63], v[148:151], a[56:59], v[60:63]
v_fma_f32 v122, v122, s90, s90
v_fma_f32 v248, v248, s90, v15
v_mfma_f32_16x16x32_bf16 v[64:67], v[148:151], a[60:63], v[64:67]
s_waitcnt lgkmcnt(2)
ds_read_b64_tr_b16 v[160:161], v9 offset:2048
ds_read_b64_tr_b16 v[162:163], v9 offset:6144
v_mfma_f32_16x16x32_bf16 v[68:71], v[152:155], a[48:51], v[68:71]
s_waitcnt vmcnt(11)
buffer_load_dwordx4 v2, s[16:19], s69 offen  lds
v_mfma_f32_16x16x32_bf16 v[72:75], v[152:155], a[52:55], v[72:75]
s_barrier
v_rcp_f32 v122, v122
v_mfma_f32_16x16x32_bf16 v[76:79], v[152:155], a[56:59], v[76:79]
s_add_u32 s67, s69, 36864
v_mul_f32 v138, v138, v122
s_add_u32 m0, s72, 36864
v_mfma_f32_16x16x32_bf16 v[80:83], v[152:155], a[60:63], v[80:83]
s_waitcnt lgkmcnt(2)
ds_read_b64_tr_b16 v[148:149], v8 offset:8192
ds_read_b64_tr_b16 v[150:151], v8 offset:12288
v_mfma_f32_16x16x32_bf16 v[84:87], v[156:159], a[48:51], v[84:87]
v_exp_f32 v123, v123
v_mfma_f32_16x16x32_bf16 v[88:91], v[156:159], a[52:55], v[88:91]
s_add_u32 s69, s69, 294912
buffer_load_dwordx4 v2, s[16:19], s67 offen  lds
v_mfma_f32_16x16x32_bf16 v[92:95], v[156:159], a[56:59], v[92:95]
s_sub_u32 s0, s69, 5308416
v_fma_f32 v123, v123, s90, s90
v_cvt_pk_bf16_f32 v120, v136, v137
v_mfma_f32_16x16x32_bf16 v[96:99], v[156:159], a[60:63], v[96:99]
s_waitcnt lgkmcnt(2)
ds_read_b64_tr_b16 v[152:153], v8 offset:10240
ds_read_b64_tr_b16 v[154:155], v8 offset:14336
v_rcp_f32 v248, v248
v_mfma_f32_16x16x32_bf16 v[100:103], v[160:163], a[48:51], v[100:103]
s_min_u32 s69, s69, s0
v_mul_f32 v240, v240, v248
s_add_u32 m0, s72, 40960
v_mfma_f32_16x16x32_bf16 v[104:107], v[160:163], a[52:55], v[104:107]
v_rcp_f32 v123, v123
v_mfma_f32_16x16x32_bf16 v[108:111], v[160:163], a[56:59], v[108:111]
s_add_u32 s67, s69, 36864
v_mul_f32 v139, v139, v123
v_mul_f32 v241, v241, v248
v_mfma_f32_16x16x32_bf16 v[112:115], v[160:163], a[60:63], v[112:115]
s_waitcnt lgkmcnt(2)
ds_read_b64_tr_b16 v[156:157], v9 offset:8192
ds_read_b64_tr_b16 v[158:159], v9 offset:12288
v_mul_f32 v242, v242, v248
v_mfma_f32_16x16x32_bf16 v[52:55], v[148:151], a[64:67], v[52:55]
buffer_load_dwordx4 v2, s[16:19], s69 offen  lds
v_mfma_f32_16x16x32_bf16 v[56:59], v[148:151], a[68:71], v[56:59]
s_add_u32 m0, s72, 45056
v_mul_f32 v243, v243, v248
v_cvt_pk_bf16_f32 v121, v138, v139
v_mfma_f32_16x16x32_bf16 v[60:63], v[148:151], a[72:75], v[60:63]
v_mul_f32 v244, v244, v248
v_mul_f32 v245, v245, v248
v_mfma_f32_16x16x32_bf16 v[64:67], v[148:151], a[76:79], v[64:67]
s_waitcnt lgkmcnt(2)
ds_read_b64_tr_b16 v[160:161], v9 offset:10240
ds_read_b64_tr_b16 v[162:163], v9 offset:14336
v_mfma_f32_16x16x32_bf16 v[68:71], v[152:155], a[64:67], v[68:71]
s_add_u32 s69, s69, 294912
v_exp_f32 v124, v124
v_mfma_f32_16x16x32_bf16 v[72:75], v[152:155], a[68:71], v[72:75]
s_sub_u32 s0, s69, 5308416
buffer_load_dwordx4 v2, s[16:19], s67 offen  lds
v_mul_f32 v246, v246, v248
v_mfma_f32_16x16x32_bf16 v[76:79], v[152:155], a[72:75], v[76:79]
s_min_u32 s69, s69, s0
v_fma_f32 v124, v124, s90, s90
v_mul_f32 v247, v247, v248
v_mfma_f32_16x16x32_bf16 v[80:83], v[152:155], a[76:79], v[80:83]
s_waitcnt lgkmcnt(2)
ds_read_b64_tr_b16 v[148:149], v8 offset:16384
ds_read_b64_tr_b16 v[150:151], v8 offset:20480
v_mfma_f32_16x16x32_bf16 v[84:87], v[156:159], a[64:67], v[84:87]
s_add_u32 m0, s72, 49152
v_rcp_f32 v124, v124
v_cvt_pk_bf16_f32 v254, v240, v241
v_mfma_f32_16x16x32_bf16 v[88:91], v[156:159], a[68:71], v[88:91]
s_add_u32 s67, s69, 36864
v_cvt_pk_bf16_f32 v255, v242, v243
v_mul_f32 v140, v140, v124
v_mfma_f32_16x16x32_bf16 v[92:95], v[156:159], a[72:75], v[92:95]
buffer_load_dwordx4 v2, s[16:19], s69 offen  lds
v_cvt_pk_bf16_f32 v244, v244, v245
v_mfma_f32_16x16x32_bf16 v[96:99], v[156:159], a[76:79], v[96:99]
s_waitcnt lgkmcnt(2)
ds_read_b64_tr_b16 v[152:153], v8 offset:18432
ds_read_b64_tr_b16 v[154:155], v8 offset:22528
v_mfma_f32_16x16x32_bf16 v[100:103], v[160:163], a[64:67], v[100:103]
s_add_u32 m0, s72, 53248
v_exp_f32 v125, v125
v_cvt_pk_bf16_f32 v246, v246, v247
v_mfma_f32_16x16x32_bf16 v[104:107], v[160:163], a[68:71], v[104:107]
s_add_u32 s69, s69, 294912
v_fma_f32 v125, v125, s90, s90
v_cndmask_b32 v233, v244, v246, s[88:89]
v_mfma_f32_16x16x32_bf16 v[108:111], v[160:163], a[72:75], v[108:111]
s_sub_u32 s0, s69, 5308416
v_rcp_f32 v125, v125
v_mfma_f32_16x16x32_bf16 v[112:115], v[160:163], a[76:79], v[112:115]
s_waitcnt lgkmcnt(2)
ds_read_b64_tr_b16 v[156:157], v9 offset:16384
ds_read_b64_tr_b16 v[158:159], v9 offset:20480
v_mfma_f32_16x16x32_bf16 v[52:55], v[148:151], a[80:83], v[52:55]
s_min_u32 s69, s69, s0
buffer_load_dwordx4 v2, s[16:19], s67 offen  lds
v_mfma_f32_16x16x32_bf16 v[56:59], v[148:151], a[84:87], v[56:59]
s_add_u32 m0, s72, 57344
v_mul_f32 v141, v141, v125
v_cvt_pk_bf16_f32 v124, v140, v141
v_mfma_f32_16x16x32_bf16 v[60:63], v[148:151], a[88:91], v[60:63]
s_add_u32 s67, s69, 36864
v_exp_f32 v126, v126
v_mfma_f32_16x16x32_bf16 v[64:67], v[148:151], a[92:95], v[64:67]
s_waitcnt lgkmcnt(2)
ds_read_b64_tr_b16 v[160:161], v9 offset:18432
ds_read_b64_tr_b16 v[162:163], v9 offset:22528
v_mfma_f32_16x16x32_bf16 v[68:71], v[152:155], a[80:83], v[68:71]
v_fma_f32 v126, v126, s90, s90
v_mfma_f32_16x16x32_bf16 v[72:75], v[152:155], a[84:87], v[72:75]
buffer_store_dwordx2 v[232:233], v18, s[32:35], s42 offen sc1
v_mfma_f32_16x16x32_bf16 v[76:79], v[152:155], a[88:91], v[76:79]
v_rcp_f32 v126, v126
v_mfma_f32_16x16x32_bf16 v[80:83], v[152:155], a[92:95], v[80:83]
s_waitcnt lgkmcnt(2)
ds_read_b64_tr_b16 v[148:149], v8 offset:24576
ds_read_b64_tr_b16 v[150:151], v8 offset:28672
v_mfma_f32_16x16x32_bf16 v[84:87], v[156:159], a[80:83], v[84:87]
v_mul_f32 v142, v142, v126
v_mov_b32 v18, 6
v_mfma_f32_16x16x32_bf16 v[88:91], v[156:159], a[84:87], v[88:91]
v_exp_f32 v127, v127
v_mfma_f32_16x16x32_bf16 v[92:95], v[156:159], a[88:91], v[92:95]
v_fma_f32 v127, v127, s90, s90
v_mfma_f32_16x16x32_bf16 v[96:99], v[156:159], a[92:95], v[96:99]
s_waitcnt lgkmcnt(2)
ds_read_b64_tr_b16 v[152:153], v8 offset:26624
ds_read_b64_tr_b16 v[154:155], v8 offset:30720
v_mfma_f32_16x16x32_bf16 v[100:103], v[160:163], a[80:83], v[100:103]
buffer_store_dwordx4 v[252:255], v1, s[32:35], s41 offen sc1
v_mfma_f32_16x16x32_bf16 v[104:107], v[160:163], a[84:87], v[104:107]
v_rcp_f32 v127, v127
v_mfma_f32_16x16x32_bf16 v[108:111], v[160:163], a[88:91], v[108:111]
v_mul_f32 v143, v143, v127
v_cvt_pk_bf16_f32 v125, v142, v143
v_mfma_f32_16x16x32_bf16 v[112:115], v[160:163], a[92:95], v[112:115]
s_waitcnt lgkmcnt(2)
ds_read_b64_tr_b16 v[156:157], v9 offset:24576
ds_read_b64_tr_b16 v[158:159], v9 offset:28672
v_mfma_f32_16x16x32_bf16 v[52:55], v[148:151], a[96:99], v[52:55]
v_exp_f32 v128, v128
v_mfma_f32_16x16x32_bf16 v[56:59], v[148:151], a[100:103], v[56:59]
v_fma_f32 v128, v128, s90, s90
v_mfma_f32_16x16x32_bf16 v[60:63], v[148:151], a[104:107], v[60:63]
v_rcp_f32 v128, v128
v_mfma_f32_16x16x32_bf16 v[64:67], v[148:151], a[108:111], v[64:67]
s_waitcnt lgkmcnt(2)
ds_read_b64_tr_b16 v[160:161], v9 offset:26624
ds_read_b64_tr_b16 v[162:163], v9 offset:30720
v_mfma_f32_16x16x32_bf16 v[68:71], v[152:155], a[96:99], v[68:71]
v_mul_f32 v144, v144, v128
v_mfma_f32_16x16x32_bf16 v[72:75], v[152:155], a[100:103], v[72:75]
v_exp_f32 v129, v129
v_mfma_f32_16x16x32_bf16 v[76:79], v[152:155], a[104:107], v[76:79]
v_fma_f32 v129, v129, s90, s90
v_mfma_f32_16x16x32_bf16 v[80:83], v[152:155], a[108:111], v[80:83]
s_waitcnt lgkmcnt(2)
ds_read_b64_tr_b16 v[148:149], v8 offset:32768
ds_read_b64_tr_b16 v[150:151], v8 offset:36864
v_mfma_f32_16x16x32_bf16 v[84:87], v[156:159], a[96:99], v[84:87]
v_rcp_f32 v129, v129
v_mfma_f32_16x16x32_bf16 v[88:91], v[156:159], a[100:103], v[88:91]
v_mul_f32 v145, v145, v129
v_cvt_pk_bf16_f32 v128, v144, v145
v_mfma_f32_16x16x32_bf16 v[92:95], v[156:159], a[104:107], v[92:95]
buffer_load_dwordx4 v2, s[16:19], s69 offen  lds
v_mfma_f32_16x16x32_bf16 v[96:99], v[156:159], a[108:111], v[96:99]
s_waitcnt lgkmcnt(2)
ds_read_b64_tr_b16 v[152:153], v8 offset:34816
ds_read_b64_tr_b16 v[154:155], v8 offset:38912
v_mfma_f32_16x16x32_bf16 v[100:103], v[160:163], a[96:99], v[100:103]
s_add_u32 m0, s72, 61440
v_exp_f32 v130, v130
v_mfma_f32_16x16x32_bf16 v[104:107], v[160:163], a[100:103], v[104:107]
s_add_u32 s69, s69, 294912
v_fma_f32 v130, v130, s90, s90
s_sub_u32 s0, s69, 5308416
v_mfma_f32_16x16x32_bf16 v[108:111], v[160:163], a[104:107], v[108:111]
s_min_u32 s69, s69, s0
v_rcp_f32 v130, v130
v_mfma_f32_16x16x32_bf16 v[112:115], v[160:163], a[108:111], v[112:115]
s_waitcnt lgkmcnt(2)
ds_read_b64_tr_b16 v[156:157], v9 offset:32768
ds_read_b64_tr_b16 v[158:159], v9 offset:36864
v_mfma_f32_16x16x32_bf16 v[52:55], v[148:151], a[112:115], v[52:55]
buffer_load_dwordx4 v2, s[16:19], s67 offen  lds
v_mfma_f32_16x16x32_bf16 v[56:59], v[148:151], a[116:119], v[56:59]
s_add_u32 m0, s72, 65536
v_mul_f32 v146, v146, v130
s_add_u32 s67, s69, 36864
v_mfma_f32_16x16x32_bf16 v[60:63], v[148:151], a[120:123], v[60:63]
v_exp_f32 v131, v131
v_mfma_f32_16x16x32_bf16 v[64:67], v[148:151], a[124:127], v[64:67]
s_waitcnt lgkmcnt(2)
ds_read_b64_tr_b16 v[160:161], v9 offset:34816
ds_read_b64_tr_b16 v[162:163], v9 offset:38912
v_mfma_f32_16x16x32_bf16 v[68:71], v[152:155], a[112:115], v[68:71]
buffer_load_dwordx4 v2, s[16:19], s69 offen  lds
v_mfma_f32_16x16x32_bf16 v[72:75], v[152:155], a[116:119], v[72:75]
s_add_u32 m0, s72, 69632
v_fma_f32 v131, v131, s90, s90
v_mfma_f32_16x16x32_bf16 v[76:79], v[152:155], a[120:123], v[76:79]
v_rcp_f32 v131, v131
v_mfma_f32_16x16x32_bf16 v[80:83], v[152:155], a[124:127], v[80:83]
s_waitcnt lgkmcnt(2)
ds_read_b64_tr_b16 v[148:149], v8 offset:40960
ds_read_b64_tr_b16 v[150:151], v8 offset:45056
v_mfma_f32_16x16x32_bf16 v[84:87], v[156:159], a[112:115], v[84:87]
v_mul_f32 v147, v147, v131
v_cvt_pk_bf16_f32 v129, v146, v147
v_mfma_f32_16x16x32_bf16 v[88:91], v[156:159], a[116:119], v[88:91]
buffer_load_dwordx4 v2, s[16:19], s67 offen  lds
v_mfma_f32_16x16x32_bf16 v[92:95], v[156:159], a[120:123], v[92:95]
v_exp_f32 v20, v20
v_mfma_f32_16x16x32_bf16 v[96:99], v[156:159], a[124:127], v[96:99]
s_waitcnt lgkmcnt(2)
ds_read_b64_tr_b16 v[152:153], v8 offset:43008
ds_read_b64_tr_b16 v[154:155], v8 offset:47104
v_mfma_f32_16x16x32_bf16 v[100:103], v[160:163], a[112:115], v[100:103]
v_fma_f32 v20, v20, s90, s90
v_add_u32 v8, 73728, v1
v_mfma_f32_16x16x32_bf16 v[104:107], v[160:163], a[116:119], v[104:107]
v_rcp_f32 v20, v20
v_mfma_f32_16x16x32_bf16 v[108:111], v[160:163], a[120:123], v[108:111]
buffer_load_dword v12, v3, s[32:35], s74 offen sc1
v_mfma_f32_16x16x32_bf16 v[112:115], v[160:163], a[124:127], v[112:115]
s_waitcnt lgkmcnt(2)
ds_read_b64_tr_b16 v[156:157], v9 offset:40960
ds_read_b64_tr_b16 v[158:159], v9 offset:45056
v_mfma_f32_16x16x32_bf16 v[52:55], v[148:151], a[128:131], v[52:55]
v_mul_f32 v36, v36, v20
v_mfma_f32_16x16x32_bf16 v[56:59], v[148:151], a[132:135], v[56:59]
v_exp_f32 v21, v21
v_mfma_f32_16x16x32_bf16 v[60:63], v[148:151], a[136:139], v[60:63]
v_fma_f32 v21, v21, s90, s90
v_mfma_f32_16x16x32_bf16 v[64:67], v[148:151], a[140:143], v[64:67]
s_waitcnt lgkmcnt(2)
ds_read_b64_tr_b16 v[160:161], v9 offset:43008
ds_read_b64_tr_b16 v[162:163], v9 offset:47104
v_mfma_f32_16x16x32_bf16 v[68:71], v[152:155], a[128:131], v[68:71]
s_waitcnt vmcnt(12)
v_rcp_f32 v21, v21
v_mfma_f32_16x16x32_bf16 v[72:75], v[152:155], a[132:135], v[72:75]
s_barrier
v_mul_f32 v37, v37, v21
v_cvt_pk_bf16_f32 v118, v36, v37
v_mfma_f32_16x16x32_bf16 v[76:79], v[152:155], a[136:139], v[76:79]
s_add_u32 m0, s76, 73728
v_exp_f32 v22, v22
v_mfma_f32_16x16x32_bf16 v[80:83], v[152:155], a[140:143], v[80:83]
s_waitcnt lgkmcnt(2)
ds_read_b64_tr_b16 v[148:149], v4 offset:0
ds_read_b64_tr_b16 v[150:151], v4 offset:4096
v_mfma_f32_16x16x32_bf16 v[84:87], v[156:159], a[128:131], v[84:87]
s_add_u32 s67, s75, 0
buffer_load_dwordx4 v1, s[32:35], s67 offen offset:0 sc1 lds
v_mfma_f32_16x16x32_bf16 v[88:91], v[156:159], a[132:135], v[88:91]
v_fma_f32 v22, v22, s90, s90
v_add_u32 v9, 110592, v1
v_mfma_f32_16x16x32_bf16 v[92:95], v[156:159], a[136:139], v[92:95]
v_rcp_f32 v22, v22
v_mfma_f32_16x16x32_bf16 v[96:99], v[156:159], a[140:143], v[96:99]
s_waitcnt lgkmcnt(2)
ds_read_b64_tr_b16 v[152:153], v4 offset:2048
ds_read_b64_tr_b16 v[154:155], v4 offset:6144
v_mfma_f32_16x16x32_bf16 v[100:103], v[160:163], a[128:131], v[100:103]
buffer_load_dwordx4 v1, s[32:35], s67 offen offset:1024 sc1 lds
v_mfma_f32_16x16x32_bf16 v[104:107], v[160:163], a[132:135], v[104:107]
v_mul_f32 v38, v38, v22
v_mfma_f32_16x16x32_bf16 v[108:111], v[160:163], a[136:139], v[108:111]
v_exp_f32 v23, v23
v_mfma_f32_16x16x32_bf16 v[112:115], v[160:163], a[140:143], v[112:115]
s_waitcnt lgkmcnt(2)
ds_read_b64_tr_b16 v[156:157], v5 offset:0
ds_read_b64_tr_b16 v[158:159], v5 offset:4096
v_mfma_f32_16x16x32_bf16 v[52:55], v[148:151], a[144:147], v[52:55]
buffer_load_dwordx4 v1, s[32:35], s67 offen offset:2048 sc1 lds
v_mfma_f32_16x16x32_bf16 v[56:59], v[148:151], a[148:151], v[56:59]
v_fma_f32 v23, v23, s90, s90
v_mfma_f32_16x16x32_bf16 v[60:63], v[148:151], a[152:155], v[60:63]
v_rcp_f32 v23, v23
v_mfma_f32_16x16x32_bf16 v[64:67], v[148:151], a[156:159], v[64:67]
s_waitcnt lgkmcnt(2)
ds_read_b64_tr_b16 v[160:161], v5 offset:2048
ds_read_b64_tr_b16 v[162:163], v5 offset:6144
v_mfma_f32_16x16x32_bf16 v[68:71], v[152:155], a[144:147], v[68:71]
buffer_load_dwordx4 v1, s[32:35], s67 offen offset:3072 sc1 lds
v_mfma_f32_16x16x32_bf16 v[72:75], v[152:155], a[148:151], v[72:75]
v_mul_f32 v39, v39, v23
v_cvt_pk_bf16_f32 v119, v38, v39
v_mfma_f32_16x16x32_bf16 v[76:79], v[152:155], a[152:155], v[76:79]
v_exp_f32 v24, v24
v_mfma_f32_16x16x32_bf16 v[80:83], v[152:155], a[156:159], v[80:83]
s_waitcnt lgkmcnt(2)
ds_read_b64_tr_b16 v[148:149], v4 offset:8192
ds_read_b64_tr_b16 v[150:151], v4 offset:12288
v_mfma_f32_16x16x32_bf16 v[84:87], v[156:159], a[144:147], v[84:87]
s_add_u32 m0, s76, 77824
buffer_store_dwordx4 v[116:119], v1, s[32:35], s101 offen offset:0 sc1
v_mfma_f32_16x16x32_bf16 v[88:91], v[156:159], a[148:151], v[88:91]
s_add_u32 s68, s75, 4096
v_fma_f32 v24, v24, s90, s90
v_mfma_f32_16x16x32_bf16 v[92:95], v[156:159], a[152:155], v[92:95]
v_rcp_f32 v24, v24
v_mfma_f32_16x16x32_bf16 v[96:99], v[156:159], a[156:159], v[96:99]
s_waitcnt lgkmcnt(2)
ds_read_b64_tr_b16 v[152:153], v4 offset:10240
ds_read_b64_tr_b16 v[154:155], v4 offset:14336
v_mfma_f32_16x16x32_bf16 v[100:103], v[160:163], a[144:147], v[100:103]
v_mul_f32 v40, v40, v24
v_mfma_f32_16x16x32_bf16 v[104:107], v[160:163], a[148:151], v[104:107]
v_exp_f32 v25, v25
v_mfma_f32_16x16x32_bf16 v[108:111], v[160:163], a[152:155], v[108:111]
v_fma_f32 v25, v25, s90, s90
v_mfma_f32_16x16x32_bf16 v[112:115], v[160:163], a[156:159], v[112:115]
s_waitcnt lgkmcnt(2)
ds_read_b64_tr_b16 v[156:157], v5 offset:8192
ds_read_b64_tr_b16 v[158:159], v5 offset:12288
v_mfma_f32_16x16x32_bf16 v[52:55], v[148:151], a[160:163], v[52:55]
v_rcp_f32 v25, v25
v_mfma_f32_16x16x32_bf16 v[56:59], v[148:151], a[164:167], v[56:59]
v_mul_f32 v41, v41, v25
v_cvt_pk_bf16_f32 v122, v40, v41
v_mfma_f32_16x16x32_bf16 v[60:63], v[148:151], a[168:171], v[60:63]
v_exp_f32 v26, v26
v_mfma_f32_16x16x32_bf16 v[64:67], v[148:151], a[172:175], v[64:67]
s_waitcnt lgkmcnt(2)
ds_read_b64_tr_b16 v[160:161], v5 offset:10240
ds_read_b64_tr_b16 v[162:163], v5 offset:14336
v_mfma_f32_16x16x32_bf16 v[68:71], v[152:155], a[160:163], v[68:71]
buffer_load_dwordx4 v1, s[32:35], s68 offen offset:0 sc1 lds
v_mfma_f32_16x16x32_bf16 v[72:75], v[152:155], a[164:167], v[72:75]
v_fma_f32 v26, v26, s90, s90
v_mfma_f32_16x16x32_bf16 v[76:79], v[152:155], a[168:171], v[76:79]
v_rcp_f32 v26, v26
v_mfma_f32_16x16x32_bf16 v[80:83], v[152:155], a[172:175], v[80:83]
s_waitcnt lgkmcnt(2)
ds_read_b64_tr_b16 v[148:149], v4 offset:16384
ds_read_b64_tr_b16 v[150:151], v4 offset:20480
v_mfma_f32_16x16x32_bf16 v[84:87], v[156:159], a[160:163], v[84:87]
buffer_load_dwordx4 v1, s[32:35], s68 offen offset:1024 sc1 lds
v_mfma_f32_16x16x32_bf16 v[88:91], v[156:159], a[164:167], v[88:91]
v_mul_f32 v42, v42, v26
v_mfma_f32_16x16x32_bf16 v[92:95], v[156:159], a[168:171], v[92:95]
v_exp_f32 v27, v27
v_mfma_f32_16x16x32_bf16 v[96:99], v[156:159], a[172:175], v[96:99]
s_waitcnt lgkmcnt(2)
ds_read_b64_tr_b16 v[152:153], v4 offset:18432
ds_read_b64_tr_b16 v[154:155], v4 offset:22528
v_mfma_f32_16x16x32_bf16 v[100:103], v[160:163], a[160:163], v[100:103]
s_add_u32 s67, s75, 8192
buffer_load_dwordx4 v1, s[32:35], s68 offen offset:2048 sc1 lds
v_mfma_f32_16x16x32_bf16 v[104:107], v[160:163], a[164:167], v[104:107]
v_fma_f32 v27, v27, s90, s90
v_mfma_f32_16x16x32_bf16 v[108:111], v[160:163], a[168:171], v[108:111]
v_rcp_f32 v27, v27
v_mfma_f32_16x16x32_bf16 v[112:115], v[160:163], a[172:175], v[112:115]
s_waitcnt lgkmcnt(2)
ds_read_b64_tr_b16 v[156:157], v5 offset:16384
ds_read_b64_tr_b16 v[158:159], v5 offset:20480
v_mfma_f32_16x16x32_bf16 v[52:55], v[148:151], a[176:179], v[52:55]
buffer_load_dwordx4 v1, s[32:35], s68 offen offset:3072 sc1 lds
v_mfma_f32_16x16x32_bf16 v[56:59], v[148:151], a[180:183], v[56:59]
s_add_u32 m0, s76, 81920
v_mul_f32 v43, v43, v27
v_cvt_pk_bf16_f32 v123, v42, v43
v_mfma_f32_16x16x32_bf16 v[60:63], v[148:151], a[184:187], v[60:63]
v_exp_f32 v28, v28
v_mfma_f32_16x16x32_bf16 v[64:67], v[148:151], a[188:191], v[64:67]
s_waitcnt lgkmcnt(2)
ds_read_b64_tr_b16 v[160:161], v5 offset:18432
ds_read_b64_tr_b16 v[162:163], v5 offset:22528
v_mfma_f32_16x16x32_bf16 v[68:71], v[152:155], a[176:179], v[68:71]
buffer_load_dwordx4 v1, s[32:35], s67 offen offset:0 sc1 lds
v_mfma_f32_16x16x32_bf16 v[72:75], v[152:155], a[180:183], v[72:75]
v_fma_f32 v28, v28, s90, s90
v_mfma_f32_16x16x32_bf16 v[76:79], v[152:155], a[184:187], v[76:79]
v_rcp_f32 v28, v28
v_mfma_f32_16x16x32_bf16 v[80:83], v[152:155], a[188:191], v[80:83]
s_waitcnt lgkmcnt(2)
ds_read_b64_tr_b16 v[148:149], v4 offset:24576
ds_read_b64_tr_b16 v[150:151], v4 offset:28672
v_mfma_f32_16x16x32_bf16 v[84:87], v[156:159], a[176:179], v[84:87]
buffer_store_dwordx4 v[120:123], v1, s[32:35], s101 offen offset:1024 sc1
v_mfma_f32_16x16x32_bf16 v[88:91], v[156:159], a[180:183], v[88:91]
v_mul_f32 v44, v44, v28
v_mfma_f32_16x16x32_bf16 v[92:95], v[156:159], a[184:187], v[92:95]
s_xor_b32 s101, s101, 2048
v_exp_f32 v29, v29
v_mfma_f32_16x16x32_bf16 v[96:99], v[156:159], a[188:191], v[96:99]
s_waitcnt lgkmcnt(2)
ds_read_b64_tr_b16 v[152:153], v4 offset:26624
ds_read_b64_tr_b16 v[154:155], v4 offset:30720
v_mfma_f32_16x16x32_bf16 v[100:103], v[160:163], a[176:179], v[100:103]
v_fma_f32 v29, v29, s90, s90
v_mfma_f32_16x16x32_bf16 v[104:107], v[160:163], a[180:183], v[104:107]
v_rcp_f32 v29, v29
v_mfma_f32_16x16x32_bf16 v[108:111], v[160:163], a[184:187], v[108:111]
v_mul_f32 v45, v45, v29
v_cvt_pk_bf16_f32 v126, v44, v45
v_mfma_f32_16x16x32_bf16 v[112:115], v[160:163], a[188:191], v[112:115]
s_waitcnt lgkmcnt(2)
ds_read_b64_tr_b16 v[156:157], v5 offset:24576
ds_read_b64_tr_b16 v[158:159], v5 offset:28672
v_mfma_f32_16x16x32_bf16 v[52:55], v[148:151], a[192:195], v[52:55]
v_exp_f32 v30, v30
v_mfma_f32_16x16x32_bf16 v[56:59], v[148:151], a[196:199], v[56:59]
v_fma_f32 v30, v30, s90, s90
v_mfma_f32_16x16x32_bf16 v[60:63], v[148:151], a[200:203], v[60:63]
v_rcp_f32 v30, v30
v_mfma_f32_16x16x32_bf16 v[64:67], v[148:151], a[204:207], v[64:67]
s_waitcnt lgkmcnt(2)
ds_read_b64_tr_b16 v[160:161], v5 offset:26624
ds_read_b64_tr_b16 v[162:163], v5 offset:30720
v_mfma_f32_16x16x32_bf16 v[68:71], v[152:155], a[192:195], v[68:71]
s_waitcnt vmcnt(12)
v_mul_f32 v46, v46, v30
s_waitcnt vmcnt(11)
v_cmp_ge_u32 s[86:87], v12, 2
v_mfma_f32_16x16x32_bf16 v[72:75], v[152:155], a[196:199], v[72:75]
s_barrier
v_exp_f32 v31, v31
s_cmp_eq_u64 s[86:87], -1
s_cbranch_scc0 L_slow3
L_back3:
v_mfma_f32_16x16x32_bf16 v[76:79], v[152:155], a[200:203], v[76:79]
s_add_u32 s46, s54, 8192
buffer_load_dwordx4 a[0:3], v1, s[32:35], s46 offen offset:0 sc1
v_mfma_f32_16x16x32_bf16 v[80:83], v[152:155], a[204:207], v[80:83]
s_waitcnt lgkmcnt(2)
ds_read_b64_tr_b16 v[148:149], v4 offset:32768
ds_read_b64_tr_b16 v[150:151], v4 offset:36864
v_mfma_f32_16x16x32_bf16 v[84:87], v[156:159], a[192:195], v[84:87]
s_add_u32 s75, s75, 36864
v_mov_b32 v12, 3
s_add_u32 m0, s76, 110592
v_mfma_f32_16x16x32_bf16 v[88:91], v[156:159], a[196:199], v[88:91]
s_add_u32 s68, s75, 0
buffer_load_dwordx4 a[4:7], v1, s[32:35], s46 offen offset:1024 sc1
v_mfma_f32_16x16x32_bf16 v[92:95], v[156:159], a[200:203], v[92:95]
s_add_u32 s46, s55, 8192
v_fma_f32 v31, v31, s90, s90
v_mfma_f32_16x16x32_bf16 v[96:99], v[156:159], a[204:207], v[96:99]
s_waitcnt lgkmcnt(2)
ds_read_b64_tr_b16 v[152:153], v4 offset:34816
ds_read_b64_tr_b16 v[154:155], v4 offset:38912
v_mfma_f32_16x16x32_bf16 v[100:103], v[160:163], a[192:195], v[100:103]
buffer_load_dwordx4 a[8:11], v1, s[32:35], s46 offen offset:0 sc1
v_mfma_f32_16x16x32_bf16 v[104:107], v[160:163], a[196:199], v[104:107]
v_rcp_f32 v31, v31
v_mfma_f32_16x16x32_bf16 v[108:111], v[160:163], a[200:203], v[108:111]
v_mul_f32 v47, v47, v31
v_cvt_pk_bf16_f32 v127, v46, v47
v_mfma_f32_16x16x32_bf16 v[112:115], v[160:163], a[204:207], v[112:115]
s_waitcnt lgkmcnt(2)
ds_read_b64_tr_b16 v[156:157], v5 offset:32768
ds_read_b64_tr_b16 v[158:159], v5 offset:36864
v_mfma_f32_16x16x32_bf16 v[52:55], v[148:151], a[208:211], v[52:55]
buffer_load_dwordx4 a[12:15], v1, s[32:35], s46 offen offset:1024 sc1
v_mfma_f32_16x16x32_bf16 v[56:59], v[148:151], a[212:215], v[56:59]
s_add_u32 s46, s59, 8192
v_exp_f32 v32, v32
v_mfma_f32_16x16x32_bf16 v[60:63], v[148:151], a[216:219], v[60:63]
v_fma_f32 v32, v32, s90, s90
v_mfma_f32_16x16x32_bf16 v[64:67], v[148:151], a[220:223], v[64:67]
s_waitcnt lgkmcnt(2)
ds_read_b64_tr_b16 v[160:161], v5 offset:34816
ds_read_b64_tr_b16 v[162:163], v5 offset:38912
v_mfma_f32_16x16x32_bf16 v[68:71], v[152:155], a[208:211], v[68:71]
buffer_load_dwordx4 v1, s[32:35], s68 offen offset:0 sc1 lds
v_mfma_f32_16x16x32_bf16 v[72:75], v[152:155], a[212:215], v[72:75]
v_rcp_f32 v32, v32
v_mfma_f32_16x16x32_bf16 v[76:79], v[152:155], a[216:219], v[76:79]
v_exp_f32 v33, v33
v_mfma_f32_16x16x32_bf16 v[80:83], v[152:155], a[220:223], v[80:83]
s_waitcnt lgkmcnt(2)
ds_read_b64_tr_b16 v[148:149], v4 offset:40960
ds_read_b64_tr_b16 v[150:151], v4 offset:45056
v_mfma_f32_16x16x32_bf16 v[84:87], v[156:159], a[208:211], v[84:87]
s_add_u32 s67, s75, 4096
buffer_store_dword v12, v13, s[32:35], s77 offen sc1
v_mfma_f32_16x16x32_bf16 v[88:91], v[156:159], a[212:215], v[88:91]
v_exp_f32 v34, v34
v_mfma_f32_16x16x32_bf16 v[92:95], v[156:159], a[216:219], v[92:95]
v_exp_f32 v35, v35
v_mfma_f32_16x16x32_bf16 v[96:99], v[156:159], a[220:223], v[96:99]
s_waitcnt lgkmcnt(2)
ds_read_b64_tr_b16 v[152:153], v4 offset:43008
ds_read_b64_tr_b16 v[154:155], v4 offset:47104
v_mfma_f32_16x16x32_bf16 v[100:103], v[160:163], a[208:211], v[100:103]
buffer_load_dwordx4 a[16:19], v1, s[32:35], s46 offen offset:0 sc1
v_mfma_f32_16x16x32_bf16 v[104:107], v[160:163], a[212:215], v[104:107]
v_fma_f32 v33, v33, s90, s90
v_fma_f32 v34, v34, s90, s90
v_mfma_f32_16x16x32_bf16 v[108:111], v[160:163], a[216:219], v[108:111]
v_rcp_f32 v33, v33
v_mfma_f32_16x16x32_bf16 v[112:115], v[160:163], a[220:223], v[112:115]
s_waitcnt lgkmcnt(2)
ds_read_b64_tr_b16 v[156:157], v5 offset:40960
ds_read_b64_tr_b16 v[158:159], v5 offset:45056
v_mfma_f32_16x16x32_bf16 v[52:55], v[148:151], a[224:227], v[52:55]
buffer_load_dwordx4 a[20:23], v1, s[32:35], s46 offen offset:1024 sc1
v_mfma_f32_16x16x32_bf16 v[56:59], v[148:151], a[228:231], v[56:59]
s_add_u32 s46, s3, 8192
v_rcp_f32 v34, v34
v_mfma_f32_16x16x32_bf16 v[60:63], v[148:151], a[232:235], v[60:63]
v_fma_f32 v35, v35, s90, s90
v_mul_f32 v48, v48, v32
v_mfma_f32_16x16x32_bf16 v[64:67], v[148:151], a[236:239], v[64:67]
s_waitcnt lgkmcnt(2)
ds_read_b64_tr_b16 v[160:161], v5 offset:43008
ds_read_b64_tr_b16 v[162:163], v5 offset:47104
v_mfma_f32_16x16x32_bf16 v[68:71], v[152:155], a[224:227], v[68:71]
buffer_load_dwordx4 v1, s[32:35], s68 offen offset:1024 sc1 lds
v_mfma_f32_16x16x32_bf16 v[72:75], v[152:155], a[228:231], v[72:75]
v_rcp_f32 v35, v35
v_mfma_f32_16x16x32_bf16 v[76:79], v[152:155], a[232:235], v[76:79]
v_mul_f32 v49, v49, v33
v_mul_f32 v50, v50, v34
v_mfma_f32_16x16x32_bf16 v[80:83], v[152:155], a[236:239], v[80:83]
s_waitcnt lgkmcnt(2)
ds_read_b64_tr_b16 v[148:149], v6 offset:0
ds_read_b64_tr_b16 v[150:151], v6 offset:4096
v_mfma_f32_16x16x32_bf16 v[84:87], v[156:159], a[224:227], v[84:87]
buffer_load_dwordx4 v1, s[32:35], s68 offen offset:2048 sc1 lds
v_mfma_f32_16x16x32_bf16 v[88:91], v[156:159], a[228:231], v[88:91]
v_mul_f32 v51, v51, v35
v_cvt_pk_bf16_f32 v130, v48, v49
v_mfma_f32_16x16x32_bf16 v[92:95], v[156:159], a[232:235], v[92:95]
v_cvt_pk_bf16_f32 v131, v50, v51
v_mfma_f32_16x16x32_bf16 v[96:99], v[156:159], a[236:239], v[96:99]
s_waitcnt lgkmcnt(2)
ds_read_b64_tr_b16 v[152:153], v6 offset:2048
ds_read_b64_tr_b16 v[154:155], v6 offset:6144
v_mfma_f32_16x16x32_bf16 v[100:103], v[160:163], a[224:227], v[100:103]
buffer_load_dwordx4 a[24:27], v1, s[32:35], s46 offen offset:0 sc1
v_mfma_f32_16x16x32_bf16 v[104:107], v[160:163], a[228:231], v[104:107]
v_mfma_f32_16x16x32_bf16 v[108:111], v[160:163], a[232:235], v[108:111]
v_mfma_f32_16x16x32_bf16 v[112:115], v[160:163], a[236:239], v[112:115]
s_waitcnt lgkmcnt(2)
ds_read_b64_tr_b16 v[156:157], v7 offset:0
ds_read_b64_tr_b16 v[158:159], v7 offset:4096
v_mfma_f32_16x16x32_bf16 v[52:55], v[148:151], a[240:243], v[52:55]
buffer_load_dwordx4 a[28:31], v1, s[32:35], s46 offen offset:1024 sc1
v_mfma_f32_16x16x32_bf16 v[56:59], v[148:151], a[244:247], v[56:59]
s_add_u32 s46, s54, 16384
v_mfma_f32_16x16x32_bf16 v[60:63], v[148:151], a[248:251], v[60:63]
buffer_load_dwordx4 v1, s[32:35], s68 offen offset:3072 sc1 lds
v_mfma_f32_16x16x32_bf16 v[64:67], v[148:151], a[252:255], v[64:67]
s_waitcnt lgkmcnt(2)
ds_read_b64_tr_b16 v[160:161], v7 offset:2048
ds_read_b64_tr_b16 v[162:163], v7 offset:6144
v_mfma_f32_16x16x32_bf16 v[68:71], v[152:155], a[240:243], v[68:71]
s_add_u32 m0, s76, 114688
v_mfma_f32_16x16x32_bf16 v[72:75], v[152:155], a[244:247], v[72:75]
s_add_u32 s68, s75, 8192
buffer_load_dwordx4 v1, s[32:35], s67 offen offset:0 sc1 lds
v_mfma_f32_16x16x32_bf16 v[76:79], v[152:155], a[248:251], v[76:79]
v_mfma_f32_16x16x32_bf16 v[80:83], v[152:155], a[252:255], v[80:83]
s_waitcnt lgkmcnt(2)
ds_read_b64_tr_b16 v[148:149], v6 offset:8192
ds_read_b64_tr_b16 v[150:151], v6 offset:12288
v_mfma_f32_16x16x32_bf16 v[84:87], v[156:159], a[240:243], v[84:87]
buffer_load_dwordx4 v1, s[32:35], s67 offen offset:1024 sc1 lds
v_mfma_f32_16x16x32_bf16 v[88:91], v[156:159], a[244:247], v[88:91]
v_mfma_f32_16x16x32_bf16 v[92:95], v[156:159], a[248:251], v[92:95]
v_mfma_f32_16x16x32_bf16 v[96:99], v[156:159], a[252:255], v[96:99]
s_waitcnt lgkmcnt(2)
ds_read_b64_tr_b16 v[152:153], v6 offset:10240
ds_read_b64_tr_b16 v[154:155], v6 offset:14336
v_mfma_f32_16x16x32_bf16 v[100:103], v[160:163], a[240:243], v[100:103]
buffer_load_dwordx4 a[32:35], v1, s[32:35], s46 offen offset:0 sc1
v_mfma_f32_16x16x32_bf16 v[104:107], v[160:163], a[244:247], v[104:107]
v_mfma_f32_16x16x32_bf16 v[108:111], v[160:163], a[248:251], v[108:111]
buffer_load_dwordx4 a[36:39], v1, s[32:35], s46 offen offset:1024 sc1
v_mfma_f32_16x16x32_bf16 v[112:115], v[160:163], a[252:255], v[112:115]
s_waitcnt lgkmcnt(2)
ds_read_b64_tr_b16 v[156:157], v7 offset:8192
ds_read_b64_tr_b16 v[158:159], v7 offset:12288
v_mfma_f32_16x16x32_bf16 v[52:55], v[148:151], v[168:171], v[52:55]
s_add_u32 s46, s55, 16384
buffer_load_dwordx4 v1, s[32:35], s67 offen offset:2048 sc1 lds
v_mfma_f32_16x16x32_bf16 v[56:59], v[148:151], v[172:175], v[56:59]
v_mfma_f32_16x16x32_bf16 v[60:63], v[148:151], v[176:179], v[60:63]
v_mfma_f32_16x16x32_bf16 v[64:67], v[148:151], v[180:183], v[64:67]
s_waitcnt lgkmcnt(2)
ds_read_b64_tr_b16 v[160:161], v7 offset:10240
ds_read_b64_tr_b16 v[162:163], v7 offset:14336
v_mfma_f32_16x16x32_bf16 v[68:71], v[152:155], v[168:171], v[68:71]
buffer_store_dwordx4 v[124:127], v1, s[32:35], s101 offen offset:0 sc1
v_mfma_f32_16x16x32_bf16 v[72:75], v[152:155], v[172:175], v[72:75]
v_mfma_f32_16x16x32_bf16 v[76:79], v[152:155], v[176:179], v[76:79]
v_mfma_f32_16x16x32_bf16 v[80:83], v[152:155], v[180:183], v[80:83]
s_waitcnt lgkmcnt(2)
ds_read_b64_tr_b16 v[148:149], v6 offset:16384
ds_read_b64_tr_b16 v[150:151], v6 offset:20480
v_mfma_f32_16x16x32_bf16 v[84:87], v[156:159], v[168:171], v[84:87]
v_mfma_f32_16x16x32_bf16 v[88:91], v[156:159], v[172:175], v[88:91]
v_mfma_f32_16x16x32_bf16 v[92:95], v[156:159], v[176:179], v[92:95]
v_mfma_f32_16x16x32_bf16 v[96:99], v[156:159], v[180:183], v[96:99]
s_waitcnt lgkmcnt(2)
ds_read_b64_tr_b16 v[152:153], v6 offset:18432
ds_read_b64_tr_b16 v[154:155], v6 offset:22528
v_mfma_f32_16x16x32_bf16 v[100:103], v[160:163], v[168:171], v[100:103]
buffer_load_dwordx4 v1, s[32:35], s67 offen offset:3072 sc1 lds
v_mfma_f32_16x16x32_bf16 v[104:107], v[160:163], v[172:175], v[104:107]
s_add_u32 m0, s76, 118784
v_add_u32 v6, 0, v1
v_mfma_f32_16x16x32_bf16 v[108:111], v[160:163], v[176:179], v[108:111]
buffer_load_dwordx4 a[40:43], v1, s[32:35], s46 offen offset:0 sc1
v_mfma_f32_16x16x32_bf16 v[112:115], v[160:163], v[180:183], v[112:115]
s_waitcnt lgkmcnt(2)
ds_read_b64_tr_b16 v[156:157], v7 offset:16384
ds_read_b64_tr_b16 v[158:159], v7 offset:20480
v_mfma_f32_16x16x32_bf16 v[52:55], v[148:151], v[184:187], v[52:55]
buffer_load_dwordx4 a[44:47], v1, s[32:35], s46 offen offset:1024 sc1
v_mfma_f32_16x16x32_bf16 v[56:59], v[148:151], v[188:191], v[56:59]
s_add_u32 s46, s59, 16384
v_mfma_f32_16x16x32_bf16 v[60:63], v[148:151], v[192:195], v[60:63]
buffer_load_dwordx4 v1, s[32:35], s68 offen offset:0 sc1 lds
v_mfma_f32_16x16x32_bf16 v[64:67], v[148:151], v[196:199], v[64:67]
s_waitcnt lgkmcnt(2)
ds_read_b64_tr_b16 v[160:161], v7 offset:18432
ds_read_b64_tr_b16 v[162:163], v7 offset:22528
v_mfma_f32_16x16x32_bf16 v[68:71], v[152:155], v[184:187], v[68:71]
buffer_store_dwordx4 v[128:131], v1, s[32:35], s101 offen offset:1024 sc1
v_mfma_f32_16x16x32_bf16 v[72:75], v[152:155], v[188:191], v[72:75]
s_waitcnt vmcnt(25)
v_exp_f32 v52, v52
v_mfma_f32_16x16x32_bf16 v[76:79], v[152:155], v[192:195], v[76:79]
s_barrier
v_fma_f32 v52, v52, s90, s90
v_add_u32 v7, 36864, v1
v_mfma_f32_16x16x32_bf16 v[80:83], v[152:155], v[196:199], v[80:83]
s_waitcnt lgkmcnt(2)
v_rcp_f32 v52, v52
v_mfma_f32_16x16x32_bf16 v[84:87], v[156:159], v[184:187], v[84:87]
s_add_u32 s75, s75, 36864
ds_read_b128 v[148:151], v8 offset:0
s_add_u32 m0, s76, 0
v_mfma_f32_16x16x32_bf16 v[88:91], v[156:159], v[188:191], v[88:91]
s_add_u32 s67, s75, 0
v_mul_f32 v68, v68, v52
v_mfma_f32_16x16x32_bf16 v[92:95], v[156:159], v[192:195], v[92:95]
s_add_u32 s101, s2, 57344
ds_read_b128 v[152:155], v8 offset:1024
v_mfma_f32_16x16x32_bf16 v[96:99], v[156:159], v[196:199], v[96:99]
s_waitcnt lgkmcnt(2)
buffer_load_dwordx4 a[48:51], v1, s[32:35], s46 offen offset:0 sc1
v_mfma_f32_16x16x32_bf16 v[100:103], v[160:163], v[184:187], v[100:103]
ds_read_b128 v[156:159], v8 offset:2048
v_mfma_f32_16x16x32_bf16 v[104:107], v[160:163], v[188:191], v[104:107]
buffer_load_dwordx4 a[52:55], v1, s[32:35], s46 offen offset:1024 sc1
v_mfma_f32_16x16x32_bf16 v[108:111], v[160:163], v[192:195], v[108:111]
s_add_u32 s46, s3, 16384
v_exp_f32 v53, v53
v_mfma_f32_16x16x32_bf16 v[112:115], v[160:163], v[196:199], v[112:115]
s_waitcnt vmcnt(25) lgkmcnt(2)
ds_read_b128 v[160:163], v8 offset:3072
v_fma_f32 v53, v53, s90, s90
v_mfma_f32_16x16x32_bf16 v[116:119], v[148:151], a[0:3], 0
s_waitcnt vmcnt(24)
ds_read_b128 v[164:167], v8 offset:4096
v_mfma_f32_16x16x32_bf16 v[120:123], v[148:151], a[4:7], 0
s_waitcnt lgkmcnt(3)
buffer_load_dwordx4 a[56:59], v1, s[32:35], s46 offen offset:0 sc1
v_mfma_f32_16x16x32_bf16 v[124:127], v[152:155], a[0:3], 0
ds_read_b128 v[148:151], v8 offset:5120
v_mfma_f32_16x16x32_bf16 v[128:131], v[152:155], a[4:7], 0
s_waitcnt lgkmcnt(3)
buffer_load_dwordx4 a[60:63], v1, s[32:35], s46 offen offset:1024 sc1
v_mfma_f32_16x16x32_bf16 v[132:135], v[156:159], a[0:3], 0
s_add_u32 s46, s54, 0
ds_read_b128 v[152:155], v8 offset:6144
v_mfma_f32_16x16x32_bf16 v[136:139], v[156:159], a[4:7], 0
s_waitcnt lgkmcnt(3)
v_rcp_f32 v53, v53
v_mfma_f32_16x16x32_bf16 v[140:143], v[160:163], a[0:3], 0
ds_read_b128 v[156:159], v8 offset:7168
v_mul_f32 v69, v69, v53
v_mfma_f32_16x16x32_bf16 v[144:147], v[160:163], a[4:7], 0
s_waitcnt lgkmcnt(3)
buffer_load_dword v12, v3, s[32:35], s74 offen sc1
v_mfma_f32_16x16x32_bf16 v[168:171], v[164:167], a[0:3], 0
ds_read_b128 v[160:163], v8 offset:8192
v_cvt_pk_bf16_f32 v52, v68, v69
v_mfma_f32_16x16x32_bf16 v[172:175], v[164:167], a[4:7], 0
s_waitcnt lgkmcnt(3)
buffer_load_dwordx4 v[20:23], v1, s[32:35], s46 offen offset:0 sc1
v_mfma_f32_16x16x32_bf16 v[176:179], v[148:151], a[0:3], 0
ds_read_b128 v[164:167], v8 offset:9216
v_exp_f32 v54, v54
v_mfma_f32_16x16x32_bf16 v[180:183], v[148:151], a[4:7], 0
s_waitcnt lgkmcnt(3)
buffer_load_dwordx4 v[24:27], v1, s[32:35], s46 offen offset:1024 sc1
v_fma_f32 v54, v54, s90, s90
v_rcp_f32 v54, v54
v_mfma_f32_16x16x32_bf16 v[184:187], v[152:155], a[0:3], 0
s_add_u32 s46, s55, 0
ds_read_b128 v[148:151], v8 offset:10240
v_mul_f32 v70, v70, v54
v_mfma_f32_16x16x32_bf16 v[188:191], v[152:155], a[4:7], 0
s_waitcnt lgkmcnt(3)
v_exp_f32 v55, v55
v_mfma_f32_16x16x32_bf16 v[192:195], v[156:159], a[0:3], 0
ds_read_b128 v[152:155], v8 offset:11264
v_fma_f32 v55, v55, s90, s90
v_rcp_f32 v55, v55
v_mfma_f32_16x16x32_bf16 v[196:199], v[156:159], a[4:7], 0
s_waitcnt lgkmcnt(3)
buffer_load_dwordx4 v1, s[32:35], s67 offen offset:0 sc1 lds
v_mul_f32 v71, v71, v55
v_mfma_f32_16x16x32_bf16 v[200:203], v[160:163], a[0:3], 0
ds_read_b128 v[156:159], v8 offset:12288
v_cvt_pk_bf16_f32 v53, v70, v71
v_mfma_f32_16x16x32_bf16 v[204:207], v[160:163], a[4:7], 0
s_waitcnt vmcnt(29) lgkmcnt(3)
v_exp_f32 v56, v56
v_mfma_f32_16x16x32_bf16 v[116:119], v[164:167], a[8:11], v[116:119]
s_waitcnt vmcnt(28)
ds_read_b128 v[160:163], v8 offset:13312
v_fma_f32 v56, v56, s90, s90
v_rcp_f32 v56, v56
v_mfma_f32_16x16x32_bf16 v[120:123], v[164:167], a[12:15], v[120:123]
s_waitcnt lgkmcnt(3)
buffer_load_dwordx4 v[28:31], v1, s[32:35], s46 offen offset:0 sc1
v_mul_f32 v72, v72, v56
v_exp_f32 v57, v57
v_mfma_f32_16x16x32_bf16 v[124:127], v[148:151], a[8:11], v[124:127]
ds_read_b128 v[164:167], v8 offset:14336
v_fma_f32 v57, v57, s90, s90
v_mfma_f32_16x16x32_bf16 v[128:131], v[148:151], a[12:15], v[128:131]
s_waitcnt lgkmcnt(3)
buffer_load_dwordx4 v[32:35], v1, s[32:35], s46 offen offset:1024 sc1
v_rcp_f32 v57, v57
v_mfma_f32_16x16x32_bf16 v[132:135], v[152:155], a[8:11], v[132:135]
s_add_u32 s46, s59, 0
ds_read_b128 v[148:151], v8 offset:15360
v_mul_f32 v73, v73, v57
v_exp_f32 v58, v58
v_mfma_f32_16x16x32_bf16 v[136:139], v[152:155], a[12:15], v[136:139]
s_waitcnt lgkmcnt(3)
v_fma_f32 v58, v58, s90, s90
v_cvt_pk_bf16_f32 v56, v72, v73
v_mfma_f32_16x16x32_bf16 v[140:143], v[156:159], a[8:11], v[140:143]
s_add_u32 s68, s75, 4096
ds_read_b128 v[152:155], v8 offset:16384
v_rcp_f32 v58, v58
v_mfma_f32_16x16x32_bf16 v[144:147], v[156:159], a[12:15], v[144:147]
s_waitcnt lgkmcnt(3)
buffer_load_dwordx4 v1, s[32:35], s67 offen offset:1024 sc1 lds
v_mul_f32 v74, v74, v58
v_exp_f32 v59, v59
v_mfma_f32_16x16x32_bf16 v[168:171], v[160:163], a[8:11], v[168:171]
ds_read_b128 v[156:159], v8 offset:17408
v_fma_f32 v59, v59, s90, s90
v_rcp_f32 v59, v59
v_mfma_f32_16x16x32_bf16 v[172:175], v[160:163], a[12:15], v[172:175]
s_waitcnt lgkmcnt(3)
v_mul_f32 v75, v75, v59
v_cvt_pk_bf16_f32 v57, v74, v75
v_mfma_f32_16x16x32_bf16 v[176:179], v[164:167], a[8:11], v[176:179]
ds_read_b128 v[160:163], v8 offset:18432
v_mfma_f32_16x16x32_bf16 v[180:183], v[164:167], a[12:15], v[180:183]
s_waitcnt lgkmcnt(3)
buffer_load_dwordx4 v[36:39], v1, s[32:35], s46 offen offset:0 sc1
v_exp_f32 v60, v60
v_mfma_f32_16x16x32_bf16 v[184:187], v[148:151], a[8:11], v[184:187]
ds_read_b128 v[164:167], v8 offset:19456
v_fma_f32 v60, v60, s90, s90
v_mfma_f32_16x16x32_bf16 v[188:191], v[148:151], a[12:15], v[188:191]
s_waitcnt lgkmcnt(3)
v_rcp_f32 v60, v60
v_mfma_f32_16x16x32_bf16 v[192:195], v[152:155], a[8:11], v[192:195]
ds_read_b128 v[148:151], v8 offset:20480
v_mul_f32 v76, v76, v60
v_exp_f32 v61, v61
v_mfma_f32_16x16x32_bf16 v[196:199], v[152:155], a[12:15], v[196:199]
s_waitcnt lgkmcnt(3)
buffer_load_dwordx4 v[40:43], v1, s[32:35], s46 offen offset:1024 sc1
v_fma_f32 v61, v61, s90, s90
v_rcp_f32 v61, v61
v_mfma_f32_16x16x32_bf16 v[200:203], v[156:159], a[8:11], v[200:203]
s_add_u32 s46, s3, 0
ds_read_b128 v[152:155], v8 offset:21504
v_mul_f32 v77, v77, v61
v_mfma_f32_16x16x32_bf16 v[204:207], v[156:159], a[12:15], v[204:207]
s_waitcnt vmcnt(30) lgkmcnt(3)
buffer_load_dwordx4 v1, s[32:35], s67 offen offset:2048 sc1 lds
v_exp_f32 v62, v62
v_mfma_f32_16x16x32_bf16 v[116:119], v[160:163], a[16:19], v[116:119]
s_waitcnt vmcnt(30)
ds_read_b128 v[156:159], v8 offset:22528
v_fma_f32 v62, v62, s90, s90
v_rcp_f32 v62, v62
v_mfma_f32_16x16x32_bf16 v[120:123], v[160:163], a[20:23], v[120:123]
s_waitcnt lgkmcnt(3)
v_mul_f32 v78, v78, v62
v_cvt_pk_bf16_f32 v60, v76, v77
v_mfma_f32_16x16x32_bf16 v[124:127], v[164:167], a[16:19], v[124:127]
ds_read_b128 v[160:163], v8 offset:23552
v_exp_f32 v63, v63
v_mfma_f32_16x16x32_bf16 v[128:131], v[164:167], a[20:23], v[128:131]
s_waitcnt lgkmcnt(3)
buffer_load_dwordx4 v1, s[32:35], s67 offen offset:3072 sc1 lds
v_fma_f32 v63, v63, s90, s90
v_rcp_f32 v63, v63
v_mfma_f32_16x16x32_bf16 v[132:135], v[148:151], a[16:19], v[132:135]
s_add_u32 m0, s76, 4096
ds_read_b128 v[164:167], v8 offset:24576
v_mul_f32 v79, v79, v63
v_mfma_f32_16x16x32_bf16 v[136:139], v[148:151], a[20:23], v[136:139]
s_waitcnt lgkmcnt(3)
v_cvt_pk_bf16_f32 v61, v78, v79
v_mfma_f32_16x16x32_bf16 v[140:143], v[152:155], a[16:19], v[140:143]
ds_read_b128 v[148:151], v8 offset:25600
v_exp_f32 v64, v64
v_mfma_f32_16x16x32_bf16 v[144:147], v[152:155], a[20:23], v[144:147]
s_waitcnt lgkmcnt(3)
buffer_load_dwordx4 v[44:47], v1, s[32:35], s46 offen offset:0 sc1
v_fma_f32 v64, v64, s90, s90
v_rcp_f32 v64, v64
v_mfma_f32_16x16x32_bf16 v[168:171], v[156:159], a[16:19], v[168:171]
ds_read_b128 v[152:155], v8 offset:26624
v_mul_f32 v80, v80, v64
v_exp_f32 v65, v65
v_mfma_f32_16x16x32_bf16 v[172:175], v[156:159], a[20:23], v[172:175]
s_waitcnt lgkmcnt(3)
buffer_load_dwordx4 v[48:51], v1, s[32:35], s46 offen offset:1024 sc1
v_fma_f32 v65, v65, s90, s90
v_mfma_f32_16x16x32_bf16 v[176:179], v[160:163], a[16:19], v[176:179]
ds_read_b128 v[156:159], v8 offset:27648
v_rcp_f32 v65, v65
v_mfma_f32_16x16x32_bf16 v[180:183], v[160:163], a[20:23], v[180:183]
s_waitcnt lgkmcnt(3)
v_mul_f32 v81, v81, v65
v_cvt_pk_bf16_f32 v64, v80, v81
v_exp_f32 v66, v66
v_mfma_f32_16x16x32_bf16 v[184:187], v[164:167], a[16:19], v[184:187]
ds_read_b128 v[160:163], v8 offset:28672
v_fma_f32 v66, v66, s90, s90
v_mfma_f32_16x16x32_bf16 v[188:191], v[164:167], a[20:23], v[188:191]
s_waitcnt lgkmcnt(3)
buffer_load_dwordx4 v1, s[32:35], s68 offen offset:0 sc1 lds
v_rcp_f32 v66, v66
v_mfma_f32_16x16x32_bf16 v[192:195], v[148:151], a[16:19], v[192:195]
ds_read_b128 v[164:167], v8 offset:29696
v_mul_f32 v82, v82, v66
v_exp_f32 v67, v67
v_mfma_f32_16x16x32_bf16 v[196:199], v[148:151], a[20:23], v[196:199]
s_waitcnt lgkmcnt(3)
v_fma_f32 v67, v67, s90, s90
v_rcp_f32 v67, v67
v_mfma_f32_16x16x32_bf16 v[200:203], v[152:155], a[16:19], v[200:203]
ds_read_b128 v[148:151], v8 offset:30720
v_mul_f32 v83, v83, v67
v_mfma_f32_16x16x32_bf16 v[204:207], v[152:155], a[20:23], v[204:207]
s_waitcnt vmcnt(31) lgkmcnt(3)
buffer_load_dwordx4 v1, s[32:35], s68 offen offset:1024 sc1 lds
v_mfma_f32_16x16x32_bf16 v[116:119], v[156:159], a[24:27], v[116:119]
s_waitcnt vmcnt(31)
ds_read_b128 v[152:155], v8 offset:31744
v_cvt_pk_bf16_f32 v65, v82, v83
v_exp_f32 v84, v84
v_mfma_f32_16x16x32_bf16 v[120:123], v[156:159], a[28:31], v[120:123]
s_waitcnt lgkmcnt(3)
v_fma_f32 v84, v84, s90, s90
v_rcp_f32 v84, v84
v_mfma_f32_16x16x32_bf16 v[124:127], v[160:163], a[24:27], v[124:127]
s_add_u32 s67, s75, 8192
ds_read_b128 v[156:159], v8 offset:32768
v_mul_f32 v100, v100, v84
v_mfma_f32_16x16x32_bf16 v[128:131], v[160:163], a[28:31], v[128:131]
s_waitcnt lgkmcnt(3)
buffer_load_dwordx4 v1, s[32:35], s68 offen offset:2048 sc1 lds
v_exp_f32 v85, v85
v_mfma_f32_16x16x32_bf16 v[132:135], v[164:167], a[24:27], v[132:135]
ds_read_b128 v[160:163], v8 offset:33792
v_fma_f32 v85, v85, s90, s90
v_rcp_f32 v85, v85
v_mfma_f32_16x16x32_bf16 v[136:139], v[164:167], a[28:31], v[136:139]
s_waitcnt lgkmcnt(3)
v_mul_f32 v101, v101, v85
v_cvt_pk_bf16_f32 v54, v100, v101
v_exp_f32 v86, v86
v_mfma_f32_16x16x32_bf16 v[140:143], v[148:151], a[24:27], v[140:143]
ds_read_b128 v[164:167], v8 offset:34816
v_fma_f32 v86, v86, s90, s90
v_mfma_f32_16x16x32_bf16 v[144:147], v[148:151], a[28:31], v[144:147]
s_waitcnt vmcnt(21) lgkmcnt(3)
buffer_load_dwordx4 v1, s[32:35], s68 offen offset:3072 sc1 lds
v_rcp_f32 v86, v86
v_mfma_f32_16x16x32_bf16 v[168:171], v[152:155], a[24:27], v[168:171]
s_add_u32 m0, s76, 8192
ds_read_b128 v[148:151], v8 offset:35840
v_mul_f32 v102, v102, v86
v_exp_f32 v87, v87
v_mfma_f32_16x16x32_bf16 v[172:175], v[152:155], a[28:31], v[172:175]
s_waitcnt lgkmcnt(3)
v_fma_f32 v87, v87, s90, s90
s_barrier
v_rcp_f32 v87, v87
v_mfma_f32_16x16x32_bf16 v[176:179], v[156:159], a[24:27], v[176:179]
s_add_u32 s75, s75, 36864
ds_read_b128 v[152:155], v9 offset:0
v_mul_f32 v103, v103, v87
v_mfma_f32_16x16x32_bf16 v[180:183], v[156:159], a[28:31], v[180:183]
s_waitcnt lgkmcnt(3)
buffer_load_dwordx4 v1, s[32:35], s67 offen offset:0 sc1 lds
v_cvt_pk_bf16_f32 v55, v102, v103
v_mfma_f32_16x16x32_bf16 v[184:187], v[160:163], a[24:27], v[184:187]
s_add_u32 m0, s76, 36864
ds_read_b128 v[156:159], v9 offset:1024
s_add_u32 s68, s75, 0
v_mfma_f32_16x16x32_bf16 v[188:191], v[160:163], a[28:31], v[188:191]
s_waitcnt lgkmcnt(3)
v_exp_f32 v88, v88
v_mfma_f32_16x16x32_bf16 v[192:195], v[164:167], a[24:27], v[192:195]
ds_read_b128 v[160:163], v9 offset:2048
v_fma_f32 v88, v88, s90, s90
v_rcp_f32 v88, v88
v_mfma_f32_16x16x32_bf16 v[196:199], v[164:167], a[28:31], v[196:199]
s_waitcnt lgkmcnt(3)
buffer_store_dwordx4 v[52:55], v1, s[32:35], s101 offen offset:0 sc1
v_mul_f32 v104, v104, v88
v_mfma_f32_16x16x32_bf16 v[200:203], v[148:151], a[24:27], v[200:203]
ds_read_b128 v[164:167], v9 offset:3072
v_exp_f32 v89, v89
v_mfma_f32_16x16x32_bf16 v[204:207], v[148:151], a[28:31], v[204:207]
s_waitcnt lgkmcnt(3)
v_fma_f32 v89, v89, s90, s90
v_rcp_f32 v89, v89
v_mfma_f32_16x16x32_bf16 v[116:119], v[152:155], a[32:35], v[116:119]
ds_read_b128 v[148:151], v9 offset:4096
v_mul_f32 v105, v105, v89
v_exp_f32 v90, v90
v_mfma_f32_16x16x32_bf16 v[120:123], v[152:155], a[36:39], v[120:123]
s_waitcnt lgkmcnt(3)
v_fma_f32 v90, v90, s90, s90
v_cvt_pk_bf16_f32 v58, v104, v105
v_rcp_f32 v90, v90
v_mfma_f32_16x16x32_bf16 v[124:127], v[156:159], a[32:35], v[124:127]
ds_read_b128 v[152:155], v9 offset:5120
v_mul_f32 v106, v106, v90
v_mfma_f32_16x16x32_bf16 v[128:131], v[156:159], a[36:39], v[128:131]
s_waitcnt lgkmcnt(3)
v_exp_f32 v91, v91
v_mfma_f32_16x16x32_bf16 v[132:135], v[160:163], a[32:35], v[132:135]
ds_read_b128 v[156:159], v9 offset:6144
v_fma_f32 v91, v91, s90, s90
v_rcp_f32 v91, v91
v_mfma_f32_16x16x32_bf16 v[136:139], v[160:163], a[36:39], v[136:139]
s_waitcnt lgkmcnt(3)
v_mul_f32 v107, v107, v91
v_cvt_pk_bf16_f32 v59, v106, v107
v_mfma_f32_16x16x32_bf16 v[140:143], v[164:167], a[32:35], v[140:143]
ds_read_b128 v[160:163], v9 offset:7168
v_mfma_f32_16x16x32_bf16 v[144:147], v[164:167], a[36:39], v[144:147]
s_waitcnt lgkmcnt(3)
v_exp_f32 v92, v92
v_mfma_f32_16x16x32_bf16 v[168:171], v[148:151], a[32:35], v[168:171]
ds_read_b128 v[164:167], v9 offset:8192
v_fma_f32 v92, v92, s90, s90
v_rcp_f32 v92, v92
v_mfma_f32_16x16x32_bf16 v[172:175], v[148:151], a[36:39], v[172:175]
s_waitcnt lgkmcnt(3)
buffer_load_dwordx4 v1, s[32:35], s68 offen offset:0 sc1 lds
v_mul_f32 v108, v108, v92
v_mfma_f32_16x16x32_bf16 v[176:179], v[152:155], a[32:35], v[176:179]
ds_read_b128 v[148:151], v9 offset:9216
v_exp_f32 v93, v93
v_mfma_f32_16x16x32_bf16 v[180:183], v[152:155], a[36:39], v[180:183]
s_waitcnt lgkmcnt(3)
v_fma_f32 v93, v93, s90, s90
v_rcp_f32 v93, v93
v_mfma_f32_16x16x32_bf16 v[184:187], v[156:159], a[32:35], v[184:187]
ds_read_b128 v[152:155], v9 offset:10240
v_mul_f32 v109, v109, v93
v_exp_f32 v94, v94
v_mfma_f32_16x16x32_bf16 v[188:191], v[156:159], a[36:39], v[188:191]
s_waitcnt lgkmcnt(3)
buffer_load_dwordx4 v1, s[32:35], s68 offen offset:1024 sc1 lds
v_fma_f32 v94, v94, s90, s90
v_mfma_f32_16x16x32_bf16 v[192:195], v[160:163], a[32:35], v[192:195]
ds_read_b128 v[156:159], v9 offset:11264
v_cvt_pk_bf16_f32 v62, v108, v109
v_rcp_f32 v94, v94
v_mfma_f32_16x16x32_bf16 v[196:199], v[160:163], a[36:39], v[196:199]
s_waitcnt lgkmcnt(3)
v_mul_f32 v110, v110, v94
v_exp_f32 v95, v95
v_mfma_f32_16x16x32_bf16 v[200:203], v[164:167], a[32:35], v[200:203]
ds_read_b128 v[160:163], v9 offset:12288
v_fma_f32 v95, v95, s90, s90
v_rcp_f32 v95, v95
v_mfma_f32_16x16x32_bf16 v[204:207], v[164:167], a[36:39], v[204:207]
s_waitcnt lgkmcnt(3)
buffer_store_dwordx4 v[56:59], v1, s[32:35], s101 offen offset:1024 sc1
v_mul_f32 v111, v111, v95
v_mfma_f32_16x16x32_bf16 v[116:119], v[148:151], a[40:43], v[116:119]
s_xor_b32 s101, s101, 2048
ds_read_b128 v[164:167], v9 offset:13312
v_cvt_pk_bf16_f32 v63, v110, v111
v_mfma_f32_16x16x32_bf16 v[120:123], v[148:151], a[44:47], v[120:123]
s_waitcnt lgkmcnt(3)
v_exp_f32 v96, v96
v_mfma_f32_16x16x32_bf16 v[124:127], v[152:155], a[40:43], v[124:127]
ds_read_b128 v[148:151], v9 offset:14336
v_fma_f32 v96, v96, s90, s90
v_mfma_f32_16x16x32_bf16 v[128:131], v[152:155], a[44:47], v[128:131]
s_waitcnt lgkmcnt(3)
v_rcp_f32 v96, v96
v_mfma_f32_16x16x32_bf16 v[132:135], v[156:159], a[40:43], v[132:135]
s_add_u32 s67, s75, 4096
ds_read_b128 v[152:155], v9 offset:15360
v_mul_f32 v112, v112, v96
v_mfma_f32_16x16x32_bf16 v[136:139], v[156:159], a[44:47], v[136:139]
s_waitcnt lgkmcnt(3)
v_exp_f32 v97, v97
v_mfma_f32_16x16x32_bf16 v[140:143], v[160:163], a[40:43], v[140:143]
ds_read_b128 v[156:159], v9 offset:16384
v_fma_f32 v97, v97, s90, s90
v_rcp_f32 v97, v97
v_mfma_f32_16x16x32_bf16 v[144:147], v[160:163], a[44:47], v[144:147]
s_waitcnt lgkmcnt(3)
v_mul_f32 v113, v113, v97
v_cvt_pk_bf16_f32 v66, v112, v113
v_exp_f32 v98, v98
v_mfma_f32_16x16x32_bf16 v[168:171], v[164:167], a[40:43], v[168:171]
s_waitcnt vmcnt(21)
ds_read_b128 v[160:163], v9 offset:17408
v_cmp_ge_u32 s[86:87], v12, 3
v_fma_f32 v98, v98, s90, s90
v_rcp_f32 v98, v98
v_mfma_f32_16x16x32_bf16 v[172:175], v[164:167], a[44:47], v[172:175]
s_waitcnt lgkmcnt(3)
v_mul_f32 v114, v114, v98
s_cmp_eq_u64 s[86:87], -1
s_cbranch_scc0 L_slow4
L_back4:
v_mov_b32 v12, 4
v_mfma_f32_16x16x32_bf16 v[176:179], v[148:151], a[40:43], v[176:179]
s_add_u32 s46, s54, 24576
ds_read_b128 v[164:167], v9 offset:18432
v_exp_f32 v99, v99
v_mfma_f32_16x16x32_bf16 v[180:183], v[148:151], a[44:47], v[180:183]
s_waitcnt lgkmcnt(3)
buffer_load_dwordx4 a[64:67], v1, s[32:35], s46 offen offset:0 sc1
v_fma_f32 v99, v99, s90, s90
v_rcp_f32 v99, v99
v_mfma_f32_16x16x32_bf16 v[184:187], v[152:155], a[40:43], v[184:187]
ds_read_b128 v[148:151], v9 offset:19456
v_mul_f32 v115, v115, v99
v_mfma_f32_16x16x32_bf16 v[188:191], v[152:155], a[44:47], v[188:191]
s_waitcnt lgkmcnt(3)
buffer_load_dwordx4 a[68:71], v1, s[32:35], s46 offen offset:1024 sc1
v_cvt_pk_bf16_f32 v67, v114, v115
v_mfma_f32_16x16x32_bf16 v[192:195], v[156:159], a[40:43], v[192:195]
s_add_u32 s46, s55, 24576
ds_read_b128 v[152:155], v9 offset:20480
v_mfma_f32_16x16x32_bf16 v[196:199], v[156:159], a[44:47], v[196:199]
s_waitcnt lgkmcnt(3)
buffer_load_dwordx4 a[72:75], v1, s[32:35], s46 offen offset:0 sc1
v_mfma_f32_16x16x32_bf16 v[200:203], v[160:163], a[40:43], v[200:203]
ds_read_b128 v[156:159], v9 offset:21504
v_mfma_f32_16x16x32_bf16 v[204:207], v[160:163], a[44:47], v[204:207]
s_waitcnt lgkmcnt(3)
buffer_load_dwordx4 a[76:79], v1, s[32:35], s46 offen offset:1024 sc1
v_mfma_f32_16x16x32_bf16 v[116:119], v[164:167], a[48:51], v[116:119]
s_add_u32 s46, s59, 24576
ds_read_b128 v[160:163], v9 offset:22528
v_mfma_f32_16x16x32_bf16 v[120:123], v[164:167], a[52:55], v[120:123]
s_waitcnt lgkmcnt(3)
buffer_store_dword v12, v13, s[32:35], s77 offen sc1
v_mfma_f32_16x16x32_bf16 v[124:127], v[148:151], a[48:51], v[124:127]
ds_read_b128 v[164:167], v9 offset:23552
v_mfma_f32_16x16x32_bf16 v[128:131], v[148:151], a[52:55], v[128:131]
s_waitcnt lgkmcnt(3)
v_mfma_f32_16x16x32_bf16 v[132:135], v[152:155], a[48:51], v[132:135]
ds_read_b128 v[148:151], v9 offset:24576
v_mfma_f32_16x16x32_bf16 v[136:139], v[152:155], a[52:55], v[136:139]
s_waitcnt lgkmcnt(3)
buffer_load_dwordx4 a[80:83], v1, s[32:35], s46 offen offset:0 sc1
v_mfma_f32_16x16x32_bf16 v[140:143], v[156:159], a[48:51], v[140:143]
ds_read_b128 v[152:155], v9 offset:25600
v_mfma_f32_16x16x32_bf16 v[144:147], v[156:159], a[52:55], v[144:147]
s_waitcnt lgkmcnt(3)
buffer_load_dwordx4 a[84:87], v1, s[32:35], s46 offen offset:1024 sc1
v_mfma_f32_16x16x32_bf16 v[168:171], v[160:163], a[48:51], v[168:171]
s_add_u32 s46, s3, 24576
ds_read_b128 v[156:159], v9 offset:26624
v_mfma_f32_16x16x32_bf16 v[172:175], v[160:163], a[52:55], v[172:175]
s_waitcnt lgkmcnt(3)
buffer_load_dwordx4 v1, s[32:35], s68 offen offset:2048 sc1 lds
v_mfma_f32_16x16x32_bf16 v[176:179], v[164:167], a[48:51], v[176:179]
ds_read_b128 v[160:163], v9 offset:27648
v_mfma_f32_16x16x32_bf16 v[180:183], v[164:167], a[52:55], v[180:183]
s_waitcnt lgkmcnt(3)
buffer_load_dwordx4 v1, s[32:35], s68 offen offset:3072 sc1 lds
v_mfma_f32_16x16x32_bf16 v[184:187], v[148:151], a[48:51], v[184:187]
s_add_u32 m0, s76, 40960
ds_read_b128 v[164:167], v9 offset:28672
v_mfma_f32_16x16x32_bf16 v[188:191], v[148:151], a[52:55], v[188:191]
s_waitcnt lgkmcnt(3)
buffer_store_dwordx4 v[60:63], v1, s[32:35], s101 offen offset:0 sc1
v_mfma_f32_16x16x32_bf16 v[192:195], v[152:155], a[48:51], v[192:195]
ds_read_b128 v[148:151], v9 offset:29696
v_mfma_f32_16x16x32_bf16 v[196:199], v[152:155], a[52:55], v[196:199]
s_waitcnt lgkmcnt(3)
v_mfma_f32_16x16x32_bf16 v[200:203], v[156:159], a[48:51], v[200:203]
ds_read_b128 v[152:155], v9 offset:30720
v_mfma_f32_16x16x32_bf16 v[204:207], v[156:159], a[52:55], v[204:207]
s_waitcnt lgkmcnt(3)
v_mfma_f32_16x16x32_bf16 v[116:119], v[160:163], a[56:59], v[116:119]
s_add_u32 s68, s75, 8192
ds_read_b128 v[156:159], v9 offset:31744
v_mfma_f32_16x16x32_bf16 v[120:123], v[160:163], a[60:63], v[120:123]
s_waitcnt lgkmcnt(3)
v_mfma_f32_16x16x32_bf16 v[124:127], v[164:167], a[56:59], v[124:127]
ds_read_b128 v[160:163], v9 offset:32768
v_mfma_f32_16x16x32_bf16 v[128:131], v[164:167], a[60:63], v[128:131]
s_waitcnt lgkmcnt(3)
buffer_load_dwordx4 a[88:91], v1, s[32:35], s46 offen offset:0 sc1
v_mfma_f32_16x16x32_bf16 v[132:135], v[148:151], a[56:59], v[132:135]
ds_read_b128 v[164:167], v9 offset:33792
v_mfma_f32_16x16x32_bf16 v[136:139], v[148:151], a[60:63], v[136:139]
s_waitcnt lgkmcnt(3)
buffer_load_dwordx4 a[92:95], v1, s[32:35], s46 offen offset:1024 sc1
v_mfma_f32_16x16x32_bf16 v[140:143], v[152:155], a[56:59], v[140:143]
s_add_u32 s46, s54, 32768
ds_read_b128 v[148:151], v9 offset:34816
v_mfma_f32_16x16x32_bf16 v[144:147], v[152:155], a[60:63], v[144:147]
s_waitcnt vmcnt(16) lgkmcnt(3)
buffer_load_dwordx4 v1, s[32:35], s67 offen offset:0 sc1 lds
v_mfma_f32_16x16x32_bf16 v[168:171], v[156:159], a[56:59], v[168:171]
s_barrier
ds_read_b128 v[152:155], v9 offset:35840
v_swap_b32 v22, v24
v_mfma_f32_16x16x32_bf16 v[172:175], v[156:159], a[60:63], v[172:175]
s_waitcnt lgkmcnt(3)
buffer_store_dwordx4 v[64:67], v1, s[32:35], s101 offen offset:1024 sc1
v_mfma_f32_16x16x32_bf16 v[176:179], v[160:163], a[56:59], v[176:179]
s_add_u32 s75, s75, 36864
ds_read_b128 v[156:159], v6 offset:0
v_swap_b32 v23, v25
v_mfma_f32_16x16x32_bf16 v[180:183], v[160:163], a[60:63], v[180:183]
s_waitcnt lgkmcnt(3)
v_mfma_f32_16x16x32_bf16 v[184:187], v[164:167], a[56:59], v[184:187]
s_add_u32 s101, s43, 0
ds_read_b128 v[160:163], v6 offset:1024
v_mfma_f32_16x16x32_bf16 v[188:191], v[164:167], a[60:63], v[188:191]
s_waitcnt lgkmcnt(3)
v_mfma_f32_16x16x32_bf16 v[192:195], v[148:151], a[56:59], v[192:195]
ds_read_b128 v[164:167], v6 offset:2048
v_mfma_f32_16x16x32_bf16 v[196:199], v[148:151], a[60:63], v[196:199]
s_waitcnt lgkmcnt(3)
v_mfma_f32_16x16x32_bf16 v[200:203], v[152:155], a[56:59], v[200:203]
ds_read_b128 v[148:151], v6 offset:3072
v_mfma_f32_16x16x32_bf16 v[204:207], v[152:155], a[60:63], v[204:207]
s_waitcnt lgkmcnt(3)
buffer_load_dwordx4 v1, s[32:35], s67 offen offset:1024 sc1 lds
v_mfma_f32_16x16x32_bf16 v[116:119], v[156:159], v[20:23], v[116:119]
ds_read_b128 v[152:155], v6 offset:4096
v_mfma_f32_16x16x32_bf16 v[120:123], v[156:159], v[24:27], v[120:123]
s_waitcnt lgkmcnt(3)
buffer_load_dwordx4 v1, s[32:35], s67 offen offset:2048 sc1 lds
v_mfma_f32_16x16x32_bf16 v[124:127], v[160:163], v[20:23], v[124:127]
ds_read_b128 v[156:159], v6 offset:5120
v_mfma_f32_16x16x32_bf16 v[128:131], v[160:163], v[24:27], v[128:131]
s_waitcnt lgkmcnt(3)
buffer_load_dwordx4 a[96:99], v1, s[32:35], s46 offen offset:0 sc1
v_mfma_f32_16x16x32_bf16 v[132:135], v[164:167], v[20:23], v[132:135]
ds_read_b128 v[160:163], v6 offset:6144
v_mfma_f32_16x16x32_bf16 v[136:139], v[164:167], v[24:27], v[136:139]
s_waitcnt lgkmcnt(3)
buffer_load_dwordx4 a[100:103], v1, s[32:35], s46 offen offset:1024 sc1
v_mfma_f32_16x16x32_bf16 v[140:143], v[148:151], v[20:23], v[140:143]
s_add_u32 s46, s55, 32768
ds_read_b128 v[164:167], v6 offset:7168
v_swap_b32 v30, v32
v_mfma_f32_16x16x32_bf16 v[144:147], v[148:151], v[24:27], v[144:147]
s_waitcnt lgkmcnt(3)
buffer_load_dwordx4 v1, s[32:35], s67 offen offset:3072 sc1 lds
v_mfma_f32_16x16x32_bf16 v[168:171], v[152:155], v[20:23], v[168:171]
s_add_u32 m0, s76, 45056
ds_read_b128 v[148:151], v6 offset:8192
s_add_u32 s67, s75, 0
v_mfma_f32_16x16x32_bf16 v[172:175], v[152:155], v[24:27], v[172:175]
s_waitcnt lgkmcnt(3)
v_swap_b32 v31, v33
v_mfma_f32_16x16x32_bf16 v[176:179], v[156:159], v[20:23], v[176:179]
ds_read_b128 v[152:155], v6 offset:9216
v_mfma_f32_16x16x32_bf16 v[180:183], v[156:159], v[24:27], v[180:183]
s_waitcnt lgkmcnt(3)
buffer_load_dwordx4 v1, s[32:35], s68 offen offset:0 sc1 lds
v_mfma_f32_16x16x32_bf16 v[184:187], v[160:163], v[20:23], v[184:187]
s_add_u32 m0, s76, 73728
ds_read_b128 v[156:159], v6 offset:10240
v_mfma_f32_16x16x32_bf16 v[188:191], v[160:163], v[24:27], v[188:191]
s_waitcnt lgkmcnt(3)
buffer_load_dwordx4 a[104:107], v1, s[32:35], s46 offen offset:0 sc1
v_mfma_f32_16x16x32_bf16 v[192:195], v[164:167], v[20:23], v[192:195]
ds_read_b128 v[160:163], v6 offset:11264
v_mfma_f32_16x16x32_bf16 v[196:199], v[164:167], v[24:27], v[196:199]
s_waitcnt lgkmcnt(3)
buffer_load_dwordx4 a[108:111], v1, s[32:35], s46 offen offset:1024 sc1
v_mfma_f32_16x16x32_bf16 v[200:203], v[148:151], v[20:23], v[200:203]
s_add_u32 s46, s59, 32768
ds_read_b128 v[164:167], v6 offset:12288
v_mfma_f32_16x16x32_bf16 v[204:207], v[148:151], v[24:27], v[204:207]
s_waitcnt lgkmcnt(3)
v_mfma_f32_16x16x32_bf16 v[116:119], v[152:155], v[28:31], v[116:119]
ds_read_b128 v[148:151], v6 offset:13312
v_mfma_f32_16x16x32_bf16 v[120:123], v[152:155], v[32:35], v[120:123]
s_waitcnt lgkmcnt(3)
buffer_load_dwordx4 v1, s[32:35], s67 offen offset:0 sc1 lds
v_mfma_f32_16x16x32_bf16 v[124:127], v[156:159], v[28:31], v[124:127]
ds_read_b128 v[152:155], v6 offset:14336
v_mfma_f32_16x16x32_bf16 v[128:131], v[156:159], v[32:35], v[128:131]
s_waitcnt lgkmcnt(3)
v_mfma_f32_16x16x32_bf16 v[132:135], v[160:163], v[28:31], v[132:135]
s_add_u32 s68, s75, 4096
ds_read_b128 v[156:159], v6 offset:15360
v_mfma_f32_16x16x32_bf16 v[136:139], v[160:163], v[32:35], v[136:139]
s_waitcnt lgkmcnt(3)
buffer_load_dwordx4 v1, s[32:35], s67 offen offset:1024 sc1 lds
v_mfma_f32_16x16x32_bf16 v[140:143], v[164:167], v[28:31], v[140:143]
ds_read_b128 v[160:163], v6 offset:16384
v_swap_b32 v38, v40
v_mfma_f32_16x16x32_bf16 v[144:147], v[164:167], v[32:35], v[144:147]
s_waitcnt lgkmcnt(3)
v_swap_b32 v39, v41
v_mfma_f32_16x16x32_bf16 v[168:171], v[148:151], v[28:31], v[168:171]
ds_read_b128 v[164:167], v6 offset:17408
v_mfma_f32_16x16x32_bf16 v[172:175], v[148:151], v[32:35], v[172:175]
s_waitcnt lgkmcnt(3)
buffer_load_dwordx4 a[0:3], v1, s[32:35], s46 offen offset:0 sc1
v_mfma_f32_16x16x32_bf16 v[176:179], v[152:155], v[28:31], v[176:179]
ds_read_b128 v[148:151], v6 offset:18432
v_mfma_f32_16x16x32_bf16 v[180:183], v[152:155], v[32:35], v[180:183]
s_waitcnt lgkmcnt(3)
v_mfma_f32_16x16x32_bf16 v[184:187], v[156:159], v[28:31], v[184:187]
ds_read_b128 v[152:155], v6 offset:19456
v_mfma_f32_16x16x32_bf16 v[188:191], v[156:159], v[32:35], v[188:191]
s_waitcnt lgkmcnt(3)
buffer_load_dwordx4 a[4:7], v1, s[32:35], s46 offen offset:1024 sc1
v_mfma_f32_16x16x32_bf16 v[192:195], v[160:163], v[28:31], v[192:195]
s_add_u32 s46, s3, 32768
ds_read_b128 v[156:159], v6 offset:20480
v_mfma_f32_16x16x32_bf16 v[196:199], v[160:163], v[32:35], v[196:199]
s_waitcnt lgkmcnt(3)
v_mfma_f32_16x16x32_bf16 v[200:203], v[164:167], v[28:31], v[200:203]
ds_read_b128 v[160:163], v6 offset:21504
v_mfma_f32_16x16x32_bf16 v[204:207], v[164:167], v[32:35], v[204:207]
s_waitcnt lgkmcnt(3)
buffer_load_dword v12, v3, s[32:35], s74 offen sc1
v_mfma_f32_16x16x32_bf16 v[116:119], v[148:151], v[36:39], v[116:119]
ds_read_b128 v[164:167], v6 offset:22528
v_mfma_f32_16x16x32_bf16 v[120:123], v[148:151], v[40:43], v[120:123]
s_waitcnt lgkmcnt(3)
buffer_load_dwordx4 v1, s[32:35], s67 offen offset:2048 sc1 lds
v_mfma_f32_16x16x32_bf16 v[124:127], v[152:155], v[36:39], v[124:127]
ds_read_b128 v[148:151], v6 offset:23552
v_mfma_f32_16x16x32_bf16 v[128:131], v[152:155], v[40:43], v[128:131]
s_waitcnt lgkmcnt(3)
v_mfma_f32_16x16x32_bf16 v[132:135], v[156:159], v[36:39], v[132:135]
ds_read_b128 v[152:155], v6 offset:24576
v_mfma_f32_16x16x32_bf16 v[136:139], v[156:159], v[40:43], v[136:139]
s_waitcnt lgkmcnt(3)
buffer_load_dwordx4 v1, s[32:35], s67 offen offset:3072 sc1 lds
v_mfma_f32_16x16x32_bf16 v[140:143], v[160:163], v[36:39], v[140:143]
s_add_u32 m0, s76, 77824
ds_read_b128 v[156:159], v6 offset:25600
v_swap_b32 v46, v48
v_mfma_f32_16x16x32_bf16 v[144:147], v[160:163], v[40:43], v[144:147]
s_waitcnt lgkmcnt(3)
v_swap_b32 v47, v49
v_mfma_f32_16x16x32_bf16 v[168:171], v[164:167], v[36:39], v[168:171]
ds_read_b128 v[160:163], v6 offset:26624
v_mfma_f32_16x16x32_bf16 v[172:175], v[164:167], v[40:43], v[172:175]
s_waitcnt lgkmcnt(3)
buffer_load_dwordx4 a[8:11], v1, s[32:35], s46 offen offset:0 sc1
v_mfma_f32_16x16x32_bf16 v[176:179], v[148:151], v[36:39], v[176:179]
ds_read_b128 v[164:167], v6 offset:27648
v_mfma_f32_16x16x32_bf16 v[180:183], v[148:151], v[40:43], v[180:183]
s_waitcnt lgkmcnt(3)
v_mfma_f32_16x16x32_bf16 v[184:187], v[152:155], v[36:39], v[184:187]
ds_read_b128 v[148:151], v6 offset:28672
v_mfma_f32_16x16x32_bf16 v[188:191], v[152:155], v[40:43], v[188:191]
s_waitcnt lgkmcnt(3)
buffer_load_dwordx4 a[12:15], v1, s[32:35], s46 offen offset:1024 sc1
v_mfma_f32_16x16x32_bf16 v[192:195], v[156:159], v[36:39], v[192:195]
ds_read_b128 v[152:155], v6 offset:29696
v_mfma_f32_16x16x32_bf16 v[196:199], v[156:159], v[40:43], v[196:199]
s_waitcnt lgkmcnt(3)
buffer_load_dwordx4 v1, s[32:35], s68 offen offset:0 sc1 lds
v_mfma_f32_16x16x32_bf16 v[200:203], v[160:163], v[36:39], v[200:203]
ds_read_b128 v[156:159], v6 offset:30720
v_mfma_f32_16x16x32_bf16 v[204:207], v[160:163], v[40:43], v[204:207]
s_waitcnt lgkmcnt(3)
v_mfma_f32_16x16x32_bf16 v[116:119], v[164:167], v[44:47], v[116:119]
s_add_u32 s67, s75, 8192
ds_read_b128 v[160:163], v6 offset:31744
v_mfma_f32_16x16x32_bf16 v[120:123], v[164:167], v[48:51], v[120:123]
s_waitcnt lgkmcnt(3)
buffer_load_dwordx4 v1, s[32:35], s68 offen offset:1024 sc1 lds
v_mfma_f32_16x16x32_bf16 v[124:127], v[148:151], v[44:47], v[124:127]
ds_read_b128 v[164:167], v6 offset:32768
v_mfma_f32_16x16x32_bf16 v[128:131], v[148:151], v[48:51], v[128:131]
s_waitcnt lgkmcnt(3)
v_mfma_f32_16x16x32_bf16 v[132:135], v[152:155], v[44:47], v[132:135]
ds_read_b128 v[148:151], v6 offset:33792
v_mfma_f32_16x16x32_bf16 v[136:139], v[152:155], v[48:51], v[136:139]
s_waitcnt lgkmcnt(3)
buffer_load_dwordx4 v1, s[32:35], s68 offen offset:2048 sc1 lds
v_mfma_f32_16x16x32_bf16 v[140:143], v[156:159], v[44:47], v[140:143]
ds_read_b128 v[152:155], v6 offset:34816
v_mfma_f32_16x16x32_bf16 v[144:147], v[156:159], v[48:51], v[144:147]
s_waitcnt vmcnt(14) lgkmcnt(3)
v_mfma_f32_16x16x32_bf16 v[168:171], v[160:163], v[44:47], v[168:171]
s_barrier
ds_read_b128 v[156:159], v6 offset:35840
v_mfma_f32_16x16x32_bf16 v[172:175], v[160:163], v[48:51], v[172:175]
s_waitcnt lgkmcnt(3)
buffer_load_dwordx4 v1, s[32:35], s68 offen offset:3072 sc1 lds
v_mfma_f32_16x16x32_bf16 v[176:179], v[164:167], v[44:47], v[176:179]
s_add_u32 m0, s76, 81920
ds_read_b128 v[160:163], v7 offset:0
s_add_u32 s75, s75, 36864
v_mfma_f32_16x16x32_bf16 v[180:183], v[164:167], v[48:51], v[180:183]
s_waitcnt lgkmcnt(3)
v_mfma_f32_16x16x32_bf16 v[184:187], v[148:151], v[44:47], v[184:187]
s_add_u32 s68, s75, 0
ds_read_b128 v[164:167], v7 offset:1024
v_mfma_f32_16x16x32_bf16 v[188:191], v[148:151], v[48:51], v[188:191]
s_waitcnt lgkmcnt(3)
buffer_load_dwordx4 v1, s[32:35], s67 offen offset:0 sc1 lds
v_mfma_f32_16x16x32_bf16 v[192:195], v[152:155], v[44:47], v[192:195]
s_add_u32 m0, s76, 110592
ds_read_b128 v[148:151], v7 offset:2048
v_mfma_f32_16x16x32_bf16 v[196:199], v[152:155], v[48:51], v[196:199]
s_waitcnt lgkmcnt(3)
v_mfma_f32_16x16x32_bf16 v[200:203], v[156:159], v[44:47], v[200:203]
ds_read_b128 v[152:155], v7 offset:3072
v_mfma_f32_16x16x32_bf16 v[204:207], v[156:159], v[48:51], v[204:207]
s_waitcnt lgkmcnt(3)
buffer_load_dwordx4 v1, s[32:35], s68 offen offset:0 sc1 lds
v_mfma_f32_16x16x32_bf16 v[116:119], v[160:163], a[64:67], v[116:119]
ds_read_b128 v[156:159], v7 offset:4096
v_mfma_f32_16x16x32_bf16 v[120:123], v[160:163], a[68:71], v[120:123]
s_waitcnt lgkmcnt(3)
v_mfma_f32_16x16x32_bf16 v[124:127], v[164:167], a[64:67], v[124:127]
ds_read_b128 v[160:163], v7 offset:5120
v_mfma_f32_16x16x32_bf16 v[128:131], v[164:167], a[68:71], v[128:131]
s_waitcnt lgkmcnt(3)
buffer_load_dwordx4 v1, s[32:35], s68 offen offset:1024 sc1 lds
v_mfma_f32_16x16x32_bf16 v[132:135], v[148:151], a[64:67], v[132:135]
ds_read_b128 v[164:167], v7 offset:6144
v_mfma_f32_16x16x32_bf16 v[136:139], v[148:151], a[68:71], v[136:139]
s_waitcnt lgkmcnt(3)
v_mfma_f32_16x16x32_bf16 v[140:143], v[152:155], a[64:67], v[140:143]
ds_read_b128 v[148:151], v7 offset:7168
v_mfma_f32_16x16x32_bf16 v[144:147], v[152:155], a[68:71], v[144:147]
s_waitcnt lgkmcnt(3)
buffer_load_dwordx4 v1, s[32:35], s68 offen offset:2048 sc1 lds
v_mfma_f32_16x16x32_bf16 v[168:171], v[156:159], a[64:67], v[168:171]
ds_read_b128 v[152:155], v7 offset:8192
v_mfma_f32_16x16x32_bf16 v[172:175], v[156:159], a[68:71], v[172:175]
s_waitcnt lgkmcnt(3)
v_mfma_f32_16x16x32_bf16 v[176:179], v[160:163], a[64:67], v[176:179]
ds_read_b128 v[156:159], v7 offset:9216
v_mfma_f32_16x16x32_bf16 v[180:183], v[160:163], a[68:71], v[180:183]
s_waitcnt lgkmcnt(3)
v_mfma_f32_16x16x32_bf16 v[184:187], v[164:167], a[64:67], v[184:187]
ds_read_b128 v[160:163], v7 offset:10240
v_mfma_f32_16x16x32_bf16 v[188:191], v[164:167], a[68:71], v[188:191]
s_waitcnt lgkmcnt(3)
v_mfma_f32_16x16x32_bf16 v[192:195], v[148:151], a[64:67], v[192:195]
ds_read_b128 v[164:167], v7 offset:11264
v_mfma_f32_16x16x32_bf16 v[196:199], v[148:151], a[68:71], v[196:199]
s_waitcnt lgkmcnt(3)
buffer_load_dwordx4 v1, s[32:35], s68 offen offset:3072 sc1 lds
v_mfma_f32_16x16x32_bf16 v[200:203], v[152:155], a[64:67], v[200:203]
ds_read_b128 v[148:151], v7 offset:12288
v_mfma_f32_16x16x32_bf16 v[204:207], v[152:155], a[68:71], v[204:207]
s_waitcnt lgkmcnt(3)
v_mfma_f32_16x16x32_bf16 v[116:119], v[156:159], a[72:75], v[116:119]
ds_read_b128 v[152:155], v7 offset:13312
v_mfma_f32_16x16x32_bf16 v[120:123], v[156:159], a[76:79], v[120:123]
s_waitcnt lgkmcnt(3)
v_mfma_f32_16x16x32_bf16 v[124:127], v[160:163], a[72:75], v[124:127]
ds_read_b128 v[156:159], v7 offset:14336
v_mfma_f32_16x16x32_bf16 v[128:131], v[160:163], a[76:79], v[128:131]
s_waitcnt lgkmcnt(3)
v_mfma_f32_16x16x32_bf16 v[132:135], v[164:167], a[72:75], v[132:135]
s_add_u32 m0, s76, 114688
ds_read_b128 v[160:163], v7 offset:15360
v_mfma_f32_16x16x32_bf16 v[136:139], v[164:167], a[76:79], v[136:139]
s_waitcnt vmcnt(13) lgkmcnt(3)
v_cmp_ge_u32 s[86:87], v12, 4
v_mfma_f32_16x16x32_bf16 v[140:143], v[148:151], a[72:75], v[140:143]
s_add_u32 s67, s75, 4096
ds_read_b128 v[164:167], v7 offset:16384
s_cmp_eq_u64 s[86:87], -1
s_cbranch_scc0 L_slow5
L_back5:
v_mfma_f32_16x16x32_bf16 v[144:147], v[148:151], a[76:79], v[144:147]
s_waitcnt lgkmcnt(3)
buffer_load_dwordx4 v1, s[32:35], s67 offen offset:0 sc1 lds
v_mfma_f32_16x16x32_bf16 v[168:171], v[152:155], a[72:75], v[168:171]
s_add_u32 s46, s54, 40960
ds_read_b128 v[148:151], v7 offset:17408
v_mov_b32 v12, 5
v_mfma_f32_16x16x32_bf16 v[172:175], v[152:155], a[76:79], v[172:175]
s_waitcnt lgkmcnt(3)
buffer_load_dwordx4 a[16:19], v1, s[32:35], s46 offen offset:0 sc1
v_mfma_f32_16x16x32_bf16 v[176:179], v[156:159], a[72:75], v[176:179]
ds_read_b128 v[152:155], v7 offset:18432
v_mfma_f32_16x16x32_bf16 v[180:183], v[156:159], a[76:79], v[180:183]
s_waitcnt lgkmcnt(3)
buffer_load_dwordx4 a[20:23], v1, s[32:35], s46 offen offset:1024 sc1
v_mfma_f32_16x16x32_bf16 v[184:187], v[160:163], a[72:75], v[184:187]
s_add_u32 s46, s55, 40960
ds_read_b128 v[156:159], v7 offset:19456
v_mfma_f32_16x16x32_bf16 v[188:191], v[160:163], a[76:79], v[188:191]
s_waitcnt lgkmcnt(3)
buffer_load_dwordx4 a[24:27], v1, s[32:35], s46 offen offset:0 sc1
v_mfma_f32_16x16x32_bf16 v[192:195], v[164:167], a[72:75], v[192:195]
ds_read_b128 v[160:163], v7 offset:20480
v_mfma_f32_16x16x32_bf16 v[196:199], v[164:167], a[76:79], v[196:199]
s_waitcnt lgkmcnt(3)
buffer_load_dwordx4 a[28:31], v1, s[32:35], s46 offen offset:1024 sc1
v_mfma_f32_16x16x32_bf16 v[200:203], v[148:151], a[72:75], v[200:203]
s_add_u32 s46, s59, 40960
ds_read_b128 v[164:167], v7 offset:21504
v_mfma_f32_16x16x32_bf16 v[204:207], v[148:151], a[76:79], v[204:207]
s_waitcnt lgkmcnt(3)
buffer_load_dwordx4 a[32:35], v1, s[32:35], s46 offen offset:0 sc1
v_mfma_f32_16x16x32_bf16 v[116:119], v[152:155], a[80:83], v[116:119]
ds_read_b128 v[148:151], v7 offset:22528
v_mfma_f32_16x16x32_bf16 v[120:123], v[152:155], a[84:87], v[120:123]
s_waitcnt lgkmcnt(3)
buffer_load_dwordx4 a[36:39], v1, s[32:35], s46 offen offset:1024 sc1
v_mfma_f32_16x16x32_bf16 v[124:127], v[156:159], a[80:83], v[124:127]
s_add_u32 s46, s3, 40960
ds_read_b128 v[152:155], v7 offset:23552
v_mfma_f32_16x16x32_bf16 v[128:131], v[156:159], a[84:87], v[128:131]
s_waitcnt lgkmcnt(3)
v_mfma_f32_16x16x32_bf16 v[132:135], v[160:163], a[80:83], v[132:135]
ds_read_b128 v[156:159], v7 offset:24576
v_mfma_f32_16x16x32_bf16 v[136:139], v[160:163], a[84:87], v[136:139]
s_waitcnt lgkmcnt(3)
buffer_load_dwordx4 a[40:43], v1, s[32:35], s46 offen offset:0 sc1
v_mfma_f32_16x16x32_bf16 v[140:143], v[164:167], a[80:83], v[140:143]
ds_read_b128 v[160:163], v7 offset:25600
v_mfma_f32_16x16x32_bf16 v[144:147], v[164:167], a[84:87], v[144:147]
s_waitcnt lgkmcnt(3)
v_mfma_f32_16x16x32_bf16 v[168:171], v[148:151], a[80:83], v[168:171]
ds_read_b128 v[164:167], v7 offset:26624
v_mfma_f32_16x16x32_bf16 v[172:175], v[148:151], a[84:87], v[172:175]
s_waitcnt lgkmcnt(3)
buffer_load_dwordx4 a[44:47], v1, s[32:35], s46 offen offset:1024 sc1
v_mfma_f32_16x16x32_bf16 v[176:179], v[152:155], a[80:83], v[176:179]
s_add_u32 s46, s54, 49152
ds_read_b128 v[148:151], v7 offset:27648
v_mfma_f32_16x16x32_bf16 v[180:183], v[152:155], a[84:87], v[180:183]
s_waitcnt lgkmcnt(3)
v_mfma_f32_16x16x32_bf16 v[184:187], v[156:159], a[80:83], v[184:187]
ds_read_b128 v[152:155], v7 offset:28672
v_and_b32 v2, 15, v0
v_mfma_f32_16x16x32_bf16 v[188:191], v[156:159], a[84:87], v[188:191]
s_waitcnt lgkmcnt(3)
buffer_store_dword v12, v13, s[32:35], s77 offen sc1
v_mfma_f32_16x16x32_bf16 v[192:195], v[160:163], a[80:83], v[192:195]
ds_read_b128 v[156:159], v7 offset:29696
v_mul_u32_u24 v2, 1152, v2
v_mfma_f32_16x16x32_bf16 v[196:199], v[160:163], a[84:87], v[196:199]
s_waitcnt lgkmcnt(3)
v_lshrrev_b32 v4, 4, v0
v_lshl_add_u32 v2, v4, 3, v2
v_mfma_f32_16x16x32_bf16 v[200:203], v[164:167], a[80:83], v[200:203]
ds_read_b128 v[160:163], v7 offset:30720
v_add_u32 v5, 18432, v2
v_mfma_f32_16x16x32_bf16 v[204:207], v[164:167], a[84:87], v[204:207]
s_waitcnt lgkmcnt(3)
buffer_load_dwordx4 v1, s[32:35], s67 offen offset:1024 sc1 lds
v_mfma_f32_16x16x32_bf16 v[116:119], v[148:151], a[88:91], v[116:119]
s_add_u32 s68, s75, 8192
ds_read_b128 v[164:167], v7 offset:31744
v_mov_b32 v77, 2147483648
v_mfma_f32_16x16x32_bf16 v[120:123], v[148:151], a[92:95], v[120:123]
s_waitcnt lgkmcnt(3)
v_cndmask_b32 v76, v77, v2, s[52:53]
v_cndmask_b32 v77, v77, v5, s[52:53]
v_mfma_f32_16x16x32_bf16 v[124:127], v[152:155], a[88:91], v[124:127]
ds_read_b128 v[148:151], v7 offset:32768
v_and_b32 v4, 3, v0
v_mfma_f32_16x16x32_bf16 v[128:131], v[152:155], a[92:95], v[128:131]
s_waitcnt lgkmcnt(3)
buffer_load_dwordx4 v1, s[32:35], s67 offen offset:2048 sc1 lds
v_mfma_f32_16x16x32_bf16 v[132:135], v[156:159], a[88:91], v[132:135]
ds_read_b128 v[152:155], v7 offset:33792
v_max_u32 v4, 1, v4
v_mfma_f32_16x16x32_bf16 v[136:139], v[156:159], a[92:95], v[136:139]
s_waitcnt lgkmcnt(3)
v_add_u32 v4, s63, v4
v_and_b32 v4, 3, v4
v_mfma_f32_16x16x32_bf16 v[140:143], v[160:163], a[88:91], v[140:143]
ds_read_b128 v[156:159], v7 offset:34816
v_lshlrev_b32 v4, 9, v4
v_mfma_f32_16x16x32_bf16 v[144:147], v[160:163], a[92:95], v[144:147]
s_waitcnt vmcnt(16) lgkmcnt(3)
buffer_load_dwordx4 a[48:51], v1, s[32:35], s46 offen offset:0 sc1
v_mfma_f32_16x16x32_bf16 v[168:171], v[164:167], a[88:91], v[168:171]
s_barrier
ds_read_b128 v[160:163], v7 offset:35840
v_mfma_f32_16x16x32_bf16 v[172:175], v[164:167], a[92:95], v[172:175]
s_waitcnt lgkmcnt(3)
v_mfma_f32_16x16x32_bf16 v[176:179], v[148:151], a[88:91], v[176:179]
s_add_u32 s75, s75, 36864
ds_read_b128 v[164:167], v8 offset:0
v_mfma_f32_16x16x32_bf16 v[180:183], v[148:151], a[92:95], v[180:183]
s_waitcnt lgkmcnt(3)
buffer_load_dwordx4 a[52:55], v1, s[32:35], s46 offen offset:1024 sc1
v_mfma_f32_16x16x32_bf16 v[184:187], v[152:155], a[88:91], v[184:187]
s_add_u32 s46, s55, 49152
ds_read_b128 v[148:151], v8 offset:1024
v_mfma_f32_16x16x32_bf16 v[188:191], v[152:155], a[92:95], v[188:191]
s_waitcnt lgkmcnt(3)
v_mfma_f32_16x16x32_bf16 v[192:195], v[156:159], a[88:91], v[192:195]
s_lshl_b32 s47, s60, 6
ds_read_b128 v[152:155], v8 offset:2048
v_mfma_f32_16x16x32_bf16 v[196:199], v[156:159], a[92:95], v[196:199]
s_waitcnt lgkmcnt(3)
buffer_load_dwordx4 v1, s[32:35], s67 offen offset:3072 sc1 lds
v_mfma_f32_16x16x32_bf16 v[200:203], v[160:163], a[88:91], v[200:203]
s_add_u32 m0, s76, 118784
ds_read_b128 v[156:159], v8 offset:3072
s_add_u32 s67, s75, 0
v_mfma_f32_16x16x32_bf16 v[204:207], v[160:163], a[92:95], v[204:207]
s_waitcnt lgkmcnt(3)
v_mfma_f32_16x16x32_bf16 v[116:119], v[164:167], a[96:99], v[116:119]
s_mul_i32 s49, s64, 288
ds_read_b128 v[160:163], v8 offset:4096
v_mfma_f32_16x16x32_bf16 v[120:123], v[164:167], a[100:103], v[120:123]
s_waitcnt lgkmcnt(3)
buffer_load_dwordx4 v1, s[32:35], s68 offen offset:0 sc1 lds
v_mfma_f32_16x16x32_bf16 v[124:127], v[148:151], a[96:99], v[124:127]
s_add_u32 m0, s76, 0
ds_read_b128 v[164:167], v8 offset:5120
v_add_u32 v220, s47, v0
v_mfma_f32_16x16x32_bf16 v[128:131], v[148:151], a[100:103], v[128:131]
s_waitcnt lgkmcnt(3)
v_add_u32 v220, 0, v220
v_mul_u32_u24 v221, 3641, v220
v_mfma_f32_16x16x32_bf16 v[132:135], v[152:155], a[96:99], v[132:135]
ds_read_b128 v[148:151], v8 offset:6144
v_lshrrev_b32 v221, 16, v221
v_mfma_f32_16x16x32_bf16 v[136:139], v[152:155], a[100:103], v[136:139]
s_waitcnt lgkmcnt(3)
buffer_load_dwordx4 a[56:59], v1, s[32:35], s46 offen offset:0 sc1
v_mfma_f32_16x16x32_bf16 v[140:143], v[156:159], a[96:99], v[140:143]
ds_read_b128 v[152:155], v8 offset:7168
v_mul_u32_u24 v221, 864, v221
v_mfma_f32_16x16x32_bf16 v[144:147], v[156:159], a[100:103], v[144:147]
s_waitcnt lgkmcnt(3)
v_lshl_add_u32 v208, v220, 4, v221
v_mfma_f32_16x16x32_bf16 v[168:171], v[160:163], a[96:99], v[168:171]
ds_read_b128 v[156:159], v8 offset:8192
v_mfma_f32_16x16x32_bf16 v[172:175], v[160:163], a[100:103], v[172:175]
s_waitcnt lgkmcnt(3)
buffer_load_dwordx4 a[60:63], v1, s[32:35], s46 offen offset:1024 sc1
v_mfma_f32_16x16x32_bf16 v[176:179], v[164:167], a[96:99], v[176:179]
s_add_u32 s46, s59, 49152
ds_read_b128 v[160:163], v8 offset:9216
v_add_u32 v220, s47, v0
v_mfma_f32_16x16x32_bf16 v[180:183], v[164:167], a[100:103], v[180:183]
s_waitcnt lgkmcnt(3)
v_add_u32 v220, 256, v220
v_mul_u32_u24 v221, 3641, v220
v_mfma_f32_16x16x32_bf16 v[184:187], v[148:151], a[96:99], v[184:187]
ds_read_b128 v[164:167], v8 offset:10240
v_lshrrev_b32 v221, 16, v221
v_mfma_f32_16x16x32_bf16 v[188:191], v[148:151], a[100:103], v[188:191]
s_waitcnt lgkmcnt(3)
buffer_load_dwordx4 v1, s[32:35], s67 offen offset:0 sc1 lds
v_mfma_f32_16x16x32_bf16 v[192:195], v[152:155], a[96:99], v[192:195]
ds_read_b128 v[148:151], v8 offset:11264
v_mul_u32_u24 v221, 864, v221
v_mfma_f32_16x16x32_bf16 v[196:199], v[152:155], a[100:103], v[196:199]
s_waitcnt lgkmcnt(3)
v_lshl_add_u32 v209, v220, 4, v221
v_mfma_f32_16x16x32_bf16 v[200:203], v[156:159], a[96:99], v[200:203]
ds_read_b128 v[152:155], v8 offset:12288
v_mfma_f32_16x16x32_bf16 v[204:207], v[156:159], a[100:103], v[204:207]
s_waitcnt lgkmcnt(3)
buffer_load_dwordx4 v1, s[32:35], s67 offen offset:1024 sc1 lds
v_mfma_f32_16x16x32_bf16 v[116:119], v[160:163], a[104:107], v[116:119]
ds_read_b128 v[156:159], v8 offset:13312
v_add_u32 v220, s47, v0
v_mfma_f32_16x16x32_bf16 v[120:123], v[160:163], a[108:111], v[120:123]
s_waitcnt lgkmcnt(3)
v_add_u32 v220, 512, v220
v_mul_u32_u24 v221, 3641, v220
v_mfma_f32_16x16x32_bf16 v[124:127], v[164:167], a[104:107], v[124:127]
ds_read_b128 v[160:163], v8 offset:14336
v_lshrrev_b32 v221, 16, v221
v_mfma_f32_16x16x32_bf16 v[128:131], v[164:167], a[108:111], v[128:131]
s_waitcnt lgkmcnt(3)
buffer_load_dwordx4 a[64:67], v1, s[32:35], s46 offen offset:0 sc1
v_mfma_f32_16x16x32_bf16 v[132:135], v[148:151], a[104:107], v[132:135]
s_add_u32 s68, s75, 4096
ds_read_b128 v[164:167], v8 offset:15360
v_mul_u32_u24 v221, 864, v221
v_mfma_f32_16x16x32_bf16 v[136:139], v[148:151], a[108:111], v[136:139]
s_waitcnt lgkmcnt(3)
v_lshl_add_u32 v210, v220, 4, v221
v_mov_b32 v220, 2147483648
v_mfma_f32_16x16x32_bf16 v[140:143], v[152:155], a[104:107], v[140:143]
ds_read_b128 v[148:151], v8 offset:16384
v_cndmask_b32 v210, v220, v210, s[52:53]
v_mfma_f32_16x16x32_bf16 v[144:147], v[152:155], a[108:111], v[144:147]
s_waitcnt lgkmcnt(3)
buffer_load_dwordx4 a[68:71], v1, s[32:35], s46 offen offset:1024 sc1
v_mfma_f32_16x16x32_bf16 v[168:171], v[156:159], a[104:107], v[168:171]
s_add_u32 s46, s3, 49152
ds_read_b128 v[152:155], v8 offset:17408
v_mfma_f32_16x16x32_bf16 v[172:175], v[156:159], a[108:111], v[172:175]
s_waitcnt lgkmcnt(3)
v_and_b32 v220, 15, v0
v_mfma_f32_16x16x32_bf16 v[176:179], v[160:163], a[104:107], v[176:179]
ds_read_b128 v[156:159], v8 offset:18432
v_mul_u32_u24 v220, 288, v220
v_mfma_f32_16x16x32_bf16 v[180:183], v[160:163], a[108:111], v[180:183]
s_waitcnt lgkmcnt(3)
buffer_load_dwordx4 v1, s[32:35], s67 offen offset:2048 sc1 lds
v_mfma_f32_16x16x32_bf16 v[184:187], v[164:167], a[104:107], v[184:187]
ds_read_b128 v[160:163], v8 offset:19456
v_lshrrev_b32 v221, 4, v0
v_mfma_f32_16x16x32_bf16 v[188:191], v[164:167], a[108:111], v[188:191]
s_waitcnt lgkmcnt(3)
v_lshl_add_u32 v220, v221, 3, v220
v_mfma_f32_16x16x32_bf16 v[192:195], v[148:151], a[104:107], v[192:195]
ds_read_b128 v[164:167], v8 offset:20480
v_mfma_f32_16x16x32_bf16 v[196:199], v[148:151], a[108:111], v[196:199]
s_waitcnt lgkmcnt(3)
buffer_load_dwordx4 v1, s[32:35], s67 offen offset:3072 sc1 lds
v_mfma_f32_16x16x32_bf16 v[200:203], v[152:155], a[104:107], v[200:203]
s_add_u32 m0, s76, 4096
ds_read_b128 v[148:151], v8 offset:21504
v_mfma_f32_16x16x32_bf16 v[204:207], v[152:155], a[108:111], v[204:207]
s_waitcnt lgkmcnt(3)
v_mfma_f32_16x16x32_bf16 v[116:119], v[156:159], a[0:3], v[116:119]
ds_read_b128 v[152:155], v8 offset:22528
v_mfma_f32_16x16x32_bf16 v[120:123], v[156:159], a[4:7], v[120:123]
s_waitcnt lgkmcnt(3)
buffer_load_dwordx4 a[72:75], v1, s[32:35], s46 offen offset:0 sc1
v_mfma_f32_16x16x32_bf16 v[124:127], v[160:163], a[0:3], v[124:127]
ds_read_b128 v[156:159], v8 offset:23552
v_mfma_f32_16x16x32_bf16 v[128:131], v[160:163], a[4:7], v[128:131]
s_waitcnt lgkmcnt(3)
v_mfma_f32_16x16x32_bf16 v[132:135], v[164:167], a[0:3], v[132:135]
ds_read_b128 v[160:163], v8 offset:24576
v_mfma_f32_16x16x32_bf16 v[136:139], v[164:167], a[4:7], v[136:139]
s_waitcnt lgkmcnt(3)
buffer_load_dwordx4 a[76:79], v1, s[32:35], s46 offen offset:1024 sc1
v_mfma_f32_16x16x32_bf16 v[140:143], v[148:151], a[0:3], v[140:143]
ds_read_b128 v[164:167], v8 offset:25600
v_mfma_f32_16x16x32_bf16 v[144:147], v[148:151], a[4:7], v[144:147]
s_waitcnt lgkmcnt(3)
v_mfma_f32_16x16x32_bf16 v[168:171], v[152:155], a[0:3], v[168:171]
ds_read_b128 v[148:151], v8 offset:26624
v_mfma_f32_16x16x32_bf16 v[172:175], v[152:155], a[4:7], v[172:175]
s_waitcnt lgkmcnt(3)
buffer_load_dwordx4 v1, s[32:35], s68 offen offset:0 sc1 lds
v_mfma_f32_16x16x32_bf16 v[176:179], v[156:159], a[0:3], v[176:179]
ds_read_b128 v[152:155], v8 offset:27648
v_mfma_f32_16x16x32_bf16 v[180:183], v[156:159], a[4:7], v[180:183]
s_waitcnt lgkmcnt(3)
v_mfma_f32_16x16x32_bf16 v[184:187], v[160:163], a[0:3], v[184:187]
ds_read_b128 v[156:159], v8 offset:28672
v_mfma_f32_16x16x32_bf16 v[188:191], v[160:163], a[4:7], v[188:191]
s_waitcnt lgkmcnt(3)
buffer_load_dwordx4 v1, s[32:35], s68 offen offset:1024 sc1 lds
v_mfma_f32_16x16x32_bf16 v[192:195], v[164:167], a[0:3], v[192:195]
ds_read_b128 v[160:163], v8 offset:29696
v_mfma_f32_16x16x32_bf16 v[196:199], v[164:167], a[4:7], v[196:199]
s_waitcnt lgkmcnt(3)
v_mfma_f32_16x16x32_bf16 v[200:203], v[148:151], a[0:3], v[200:203]
ds_read_b128 v[164:167], v8 offset:30720
v_mfma_f32_16x16x32_bf16 v[204:207], v[148:151], a[4:7], v[204:207]
s_waitcnt lgkmcnt(3)
buffer_load_dword v12, v3, s[32:35], s74 offen sc1
v_mfma_f32_16x16x32_bf16 v[116:119], v[152:155], a[8:11], v[116:119]
s_add_u32 s67, s75, 8192
ds_read_b128 v[148:151], v8 offset:31744
v_mfma_f32_16x16x32_bf16 v[120:123], v[152:155], a[12:15], v[120:123]
s_waitcnt lgkmcnt(3)
buffer_load_dwordx4 v1, s[32:35], s68 offen offset:2048 sc1 lds
v_mfma_f32_16x16x32_bf16 v[124:127], v[156:159], a[8:11], v[124:127]
ds_read_b128 v[152:155], v8 offset:32768
v_mfma_f32_16x16x32_bf16 v[128:131], v[156:159], a[12:15], v[128:131]
s_waitcnt lgkmcnt(3)
v_mfma_f32_16x16x32_bf16 v[132:135], v[160:163], a[8:11], v[132:135]
ds_read_b128 v[156:159], v8 offset:33792
v_mfma_f32_16x16x32_bf16 v[136:139], v[160:163], a[12:15], v[136:139]
s_waitcnt lgkmcnt(3)
buffer_load_dwordx4 v1, s[32:35], s68 offen offset:3072 sc1 lds
v_mfma_f32_16x16x32_bf16 v[140:143], v[164:167], a[8:11], v[140:143]
s_add_u32 m0, s76, 8192
ds_read_b128 v[160:163], v8 offset:34816
v_mfma_f32_16x16x32_bf16 v[144:147], v[164:167], a[12:15], v[144:147]
s_waitcnt vmcnt(15) lgkmcnt(3)
v_mfma_f32_16x16x32_bf16 v[168:171], v[148:151], a[8:11], v[168:171]
s_barrier
ds_read_b128 v[164:167], v8 offset:35840
s_add_u32 s75, s75, 36864
v_mfma_f32_16x16x32_bf16 v[172:175], v[148:151], a[12:15], v[172:175]
s_waitcnt lgkmcnt(3)
buffer_load_dwordx4 v1, s[32:35], s67 offen offset:0 sc1 lds
v_mfma_f32_16x16x32_bf16 v[176:179], v[152:155], a[8:11], v[176:179]
s_add_u32 m0, s76, 36864
ds_read_b128 v[148:151], v9 offset:0
s_add_u32 s68, s75, 0
v_mfma_f32_16x16x32_bf16 v[180:183], v[152:155], a[12:15], v[180:183]
s_waitcnt lgkmcnt(3)
v_mfma_f32_16x16x32_bf16 v[184:187], v[156:159], a[8:11], v[184:187]
ds_read_b128 v[152:155], v9 offset:1024
v_mfma_f32_16x16x32_bf16 v[188:191], v[156:159], a[12:15], v[188:191]
s_waitcnt lgkmcnt(3)
buffer_load_dwordx4 v1, s[32:35], s68 offen offset:0 sc1 lds
v_mfma_f32_16x16x32_bf16 v[192:195], v[160:163], a[8:11], v[192:195]
ds_read_b128 v[156:159], v9 offset:2048
v_mfma_f32_16x16x32_bf16 v[196:199], v[160:163], a[12:15], v[196:199]
s_waitcnt lgkmcnt(3)
v_mfma_f32_16x16x32_bf16 v[200:203], v[164:167], a[8:11], v[200:203]
ds_read_b128 v[160:163], v9 offset:3072
v_mfma_f32_16x16x32_bf16 v[204:207], v[164:167], a[12:15], v[204:207]
s_waitcnt lgkmcnt(3)
buffer_load_dwordx4 v1, s[32:35], s68 offen offset:1024 sc1 lds
v_mfma_f32_16x16x32_bf16 v[116:119], v[148:151], a[16:19], v[116:119]
ds_read_b128 v[164:167], v9 offset:4096
v_mfma_f32_16x16x32_bf16 v[120:123], v[148:151], a[20:23], v[120:123]
s_waitcnt lgkmcnt(3)
v_mfma_f32_16x16x32_bf16 v[124:127], v[152:155], a[16:19], v[124:127]
ds_read_b128 v[148:151], v9 offset:5120
v_mfma_f32_16x16x32_bf16 v[128:131], v[152:155], a[20:23], v[128:131]
s_waitcnt lgkmcnt(3)
buffer_load_dwordx4 v1, s[32:35], s68 offen offset:2048 sc1 lds
v_mfma_f32_16x16x32_bf16 v[132:135], v[156:159], a[16:19], v[132:135]
ds_read_b128 v[152:155], v9 offset:6144
v_mfma_f32_16x16x32_bf16 v[136:139], v[156:159], a[20:23], v[136:139]
s_waitcnt lgkmcnt(3)
v_mfma_f32_16x16x32_bf16 v[140:143], v[160:163], a[16:19], v[140:143]
ds_read_b128 v[156:159], v9 offset:7168
v_mfma_f32_16x16x32_bf16 v[144:147], v[160:163], a[20:23], v[144:147]
s_waitcnt lgkmcnt(3)
buffer_load_dwordx4 v1, s[32:35], s68 offen offset:3072 sc1 lds
v_mfma_f32_16x16x32_bf16 v[168:171], v[164:167], a[16:19], v[168:171]
s_add_u32 m0, s76, 40960
ds_read_b128 v[160:163], v9 offset:8192
v_mfma_f32_16x16x32_bf16 v[172:175], v[164:167], a[20:23], v[172:175]
s_waitcnt lgkmcnt(3)
v_mfma_f32_16x16x32_bf16 v[176:179], v[148:151], a[16:19], v[176:179]
s_add_u32 s67, s75, 4096
ds_read_b128 v[164:167], v9 offset:9216
v_mfma_f32_16x16x32_bf16 v[180:183], v[148:151], a[20:23], v[180:183]
s_waitcnt lgkmcnt(3)
buffer_load_dwordx4 v1, s[32:35], s67 offen offset:0 sc1 lds
v_mfma_f32_16x16x32_bf16 v[184:187], v[152:155], a[16:19], v[184:187]
ds_read_b128 v[148:151], v9 offset:10240
v_mfma_f32_16x16x32_bf16 v[188:191], v[152:155], a[20:23], v[188:191]
s_waitcnt lgkmcnt(3)
v_mfma_f32_16x16x32_bf16 v[192:195], v[156:159], a[16:19], v[192:195]
ds_read_b128 v[152:155], v9 offset:11264
v_mfma_f32_16x16x32_bf16 v[196:199], v[156:159], a[20:23], v[196:199]
s_waitcnt lgkmcnt(3)
buffer_load_dwordx4 v1, s[32:35], s67 offen offset:1024 sc1 lds
v_mfma_f32_16x16x32_bf16 v[200:203], v[160:163], a[16:19], v[200:203]
ds_read_b128 v[156:159], v9 offset:12288
v_mfma_f32_16x16x32_bf16 v[204:207], v[160:163], a[20:23], v[204:207]
s_waitcnt lgkmcnt(3)
v_mfma_f32_16x16x32_bf16 v[116:119], v[164:167], a[24:27], v[116:119]
ds_read_b128 v[160:163], v9 offset:13312
v_mfma_f32_16x16x32_bf16 v[120:123], v[164:167], a[28:31], v[120:123]
s_waitcnt lgkmcnt(3)
buffer_load_dwordx4 v1, s[32:35], s67 offen offset:2048 sc1 lds
v_mfma_f32_16x16x32_bf16 v[124:127], v[148:151], a[24:27], v[124:127]
ds_read_b128 v[164:167], v9 offset:14336
v_mfma_f32_16x16x32_bf16 v[128:131], v[148:151], a[28:31], v[128:131]
s_waitcnt lgkmcnt(3)
v_mfma_f32_16x16x32_bf16 v[132:135], v[152:155], a[24:27], v[132:135]
ds_read_b128 v[148:151], v9 offset:15360
v_mfma_f32_16x16x32_bf16 v[136:139], v[152:155], a[28:31], v[136:139]
s_waitcnt lgkmcnt(3)
buffer_load_dwordx4 v1, s[32:35], s67 offen offset:3072 sc1 lds
v_mfma_f32_16x16x32_bf16 v[140:143], v[156:159], a[24:27], v[140:143]
ds_read_b128 v[152:155], v9 offset:16384
v_mfma_f32_16x16x32_bf16 v[144:147], v[156:159], a[28:31], v[144:147]
s_waitcnt lgkmcnt(3)
v_mfma_f32_16x16x32_bf16 v[168:171], v[160:163], a[24:27], v[168:171]
ds_read_b128 v[156:159], v9 offset:17408
v_mfma_f32_16x16x32_bf16 v[172:175], v[160:163], a[28:31], v[172:175]
s_waitcnt lgkmcnt(3)
v_mfma_f32_16x16x32_bf16 v[176:179], v[164:167], a[24:27], v[176:179]
s_add_u32 m0, s76, 45056
ds_read_b128 v[160:163], v9 offset:18432
v_mfma_f32_16x16x32_bf16 v[180:183], v[164:167], a[28:31], v[180:183]
s_waitcnt lgkmcnt(3)
v_mfma_f32_16x16x32_bf16 v[184:187], v[148:151], a[24:27], v[184:187]
s_add_u32 s68, s75, 8192
ds_read_b128 v[164:167], v9 offset:19456
v_mfma_f32_16x16x32_bf16 v[188:191], v[148:151], a[28:31], v[188:191]
s_waitcnt lgkmcnt(3)
buffer_load_dwordx4 v1, s[32:35], s68 offen offset:0 sc1 lds
v_mfma_f32_16x16x32_bf16 v[192:195], v[152:155], a[24:27], v[192:195]
ds_read_b128 v[148:151], v9 offset:20480
v_mfma_f32_16x16x32_bf16 v[196:199], v[152:155], a[28:31], v[196:199]
s_waitcnt lgkmcnt(3)
v_mfma_f32_16x16x32_bf16 v[200:203], v[156:159], a[24:27], v[200:203]
ds_read_b128 v[152:155], v9 offset:21504
v_mfma_f32_16x16x32_bf16 v[204:207], v[156:159], a[28:31], v[204:207]
s_waitcnt lgkmcnt(3)
v_mfma_f32_16x16x32_bf16 v[116:119], v[160:163], a[32:35], v[116:119]
ds_read_b128 v[156:159], v9 offset:22528
v_mfma_f32_16x16x32_bf16 v[120:123], v[160:163], a[36:39], v[120:123]
s_waitcnt lgkmcnt(3)
v_mfma_f32_16x16x32_bf16 v[124:127], v[164:167], a[32:35], v[124:127]
ds_read_b128 v[160:163], v9 offset:23552
v_mfma_f32_16x16x32_bf16 v[128:131], v[164:167], a[36:39], v[128:131]
s_waitcnt lgkmcnt(3)
v_mfma_f32_16x16x32_bf16 v[132:135], v[148:151], a[32:35], v[132:135]
ds_read_b128 v[164:167], v9 offset:24576
v_mfma_f32_16x16x32_bf16 v[136:139], v[148:151], a[36:39], v[136:139]
s_waitcnt vmcnt(12) lgkmcnt(3)
v_cmp_ge_u32 s[86:87], v12, 5
v_mfma_f32_16x16x32_bf16 v[140:143], v[152:155], a[32:35], v[140:143]
ds_read_b128 v[148:151], v9 offset:25600
s_cmp_eq_u64 s[86:87], -1
s_cbranch_scc0 L_slow6
L_back6:
v_mfma_f32_16x16x32_bf16 v[144:147], v[152:155], a[36:39], v[144:147]
s_waitcnt lgkmcnt(3)
buffer_load_dword v12, v14, s[32:35], s56 offen sc1
v_mfma_f32_16x16x32_bf16 v[168:171], v[156:159], a[32:35], v[168:171]
s_add_u32 s46, s54, 57344
ds_read_b128 v[152:155], v9 offset:26624
v_mfma_f32_16x16x32_bf16 v[172:175], v[156:159], a[36:39], v[172:175]
s_waitcnt lgkmcnt(3)
buffer_load_dwordx4 a[80:83], v1, s[32:35], s46 offen offset:0 sc1
v_mfma_f32_16x16x32_bf16 v[176:179], v[160:163], a[32:35], v[176:179]
ds_read_b128 v[156:159], v9 offset:27648
v_mfma_f32_16x16x32_bf16 v[180:183], v[160:163], a[36:39], v[180:183]
s_waitcnt lgkmcnt(3)
buffer_load_dwordx4 a[84:87], v1, s[32:35], s46 offen offset:1024 sc1
v_mfma_f32_16x16x32_bf16 v[184:187], v[164:167], a[32:35], v[184:187]
s_add_u32 s46, s55, 57344
ds_read_b128 v[160:163], v9 offset:28672
v_mfma_f32_16x16x32_bf16 v[188:191], v[164:167], a[36:39], v[188:191]
s_waitcnt lgkmcnt(3)
buffer_load_dwordx4 a[88:91], v1, s[32:35], s46 offen offset:0 sc1
v_mfma_f32_16x16x32_bf16 v[192:195], v[148:151], a[32:35], v[192:195]
ds_read_b128 v[164:167], v9 offset:29696
v_mfma_f32_16x16x32_bf16 v[196:199], v[148:151], a[36:39], v[196:199]
s_waitcnt lgkmcnt(3)
buffer_load_dwordx4 a[92:95], v1, s[32:35], s46 offen offset:1024 sc1
v_mfma_f32_16x16x32_bf16 v[200:203], v[152:155], a[32:35], v[200:203]
s_add_u32 s46, s59, 57344
ds_read_b128 v[148:151], v9 offset:30720
v_mfma_f32_16x16x32_bf16 v[204:207], v[152:155], a[36:39], v[204:207]
s_waitcnt lgkmcnt(3)
buffer_load_dwordx4 a[96:99], v1, s[32:35], s46 offen offset:0 sc1
v_mfma_f32_16x16x32_bf16 v[116:119], v[156:159], a[40:43], v[116:119]
ds_read_b128 v[152:155], v9 offset:31744
v_mfma_f32_16x16x32_bf16 v[120:123], v[156:159], a[44:47], v[120:123]
s_waitcnt lgkmcnt(3)
buffer_load_dwordx4 a[100:103], v1, s[32:35], s46 offen offset:1024 sc1
v_mfma_f32_16x16x32_bf16 v[124:127], v[160:163], a[40:43], v[124:127]
s_add_u32 s46, s3, 57344
ds_read_b128 v[156:159], v9 offset:32768
v_mfma_f32_16x16x32_bf16 v[128:131], v[160:163], a[44:47], v[128:131]
s_waitcnt lgkmcnt(3)
buffer_load_dwordx4 a[104:107], v1, s[32:35], s46 offen offset:0 sc1
v_mfma_f32_16x16x32_bf16 v[132:135], v[164:167], a[40:43], v[132:135]
ds_read_b128 v[160:163], v9 offset:33792
v_mfma_f32_16x16x32_bf16 v[136:139], v[164:167], a[44:47], v[136:139]
s_waitcnt lgkmcnt(3)
buffer_load_dwordx4 a[108:111], v1, s[32:35], s46 offen offset:1024 sc1
v_mfma_f32_16x16x32_bf16 v[140:143], v[148:151], a[40:43], v[140:143]
s_add_u32 s46, s54, 65536
ds_read_b128 v[164:167], v9 offset:34816
v_mfma_f32_16x16x32_bf16 v[144:147], v[148:151], a[44:47], v[144:147]
s_waitcnt vmcnt(18) lgkmcnt(3)
v_mfma_f32_16x16x32_bf16 v[168:171], v[152:155], a[40:43], v[168:171]
s_barrier
ds_read_b128 v[148:151], v9 offset:35840
s_add_u32 s75, s75, 36864
v_mfma_f32_16x16x32_bf16 v[172:175], v[152:155], a[44:47], v[172:175]
s_waitcnt lgkmcnt(3)
buffer_load_dwordx4 a[0:3], v1, s[32:35], s46 offen offset:0 sc1
v_mfma_f32_16x16x32_bf16 v[176:179], v[156:159], a[40:43], v[176:179]
s_add_u32 m0, s76, 73728
ds_read_b128 v[152:155], v6 offset:0
s_add_u32 s67, s75, 0
v_mfma_f32_16x16x32_bf16 v[180:183], v[156:159], a[44:47], v[180:183]
s_waitcnt lgkmcnt(3)
v_mfma_f32_16x16x32_bf16 v[184:187], v[160:163], a[40:43], v[184:187]
ds_read_b128 v[156:159], v6 offset:1024
v_mfma_f32_16x16x32_bf16 v[188:191], v[160:163], a[44:47], v[188:191]
s_waitcnt lgkmcnt(3)
buffer_load_dwordx4 a[4:7], v1, s[32:35], s46 offen offset:1024 sc1
v_mfma_f32_16x16x32_bf16 v[192:195], v[164:167], a[40:43], v[192:195]
s_add_u32 s46, s55, 65536
ds_read_b128 v[160:163], v6 offset:2048
v_mfma_f32_16x16x32_bf16 v[196:199], v[164:167], a[44:47], v[196:199]
s_waitcnt lgkmcnt(3)
v_mfma_f32_16x16x32_bf16 v[200:203], v[148:151], a[40:43], v[200:203]
ds_read_b128 v[164:167], v6 offset:3072
v_mfma_f32_16x16x32_bf16 v[204:207], v[148:151], a[44:47], v[204:207]
s_waitcnt lgkmcnt(3)
buffer_load_dwordx4 a[8:11], v1, s[32:35], s46 offen offset:0 sc1
v_mfma_f32_16x16x32_bf16 v[116:119], v[152:155], a[48:51], v[116:119]
ds_read_b128 v[148:151], v6 offset:4096
v_mfma_f32_16x16x32_bf16 v[120:123], v[152:155], a[52:55], v[120:123]
s_waitcnt lgkmcnt(3)
v_mfma_f32_16x16x32_bf16 v[124:127], v[156:159], a[48:51], v[124:127]
ds_read_b128 v[152:155], v6 offset:5120
v_mfma_f32_16x16x32_bf16 v[128:131], v[156:159], a[52:55], v[128:131]
s_waitcnt lgkmcnt(3)
buffer_load_dwordx4 a[12:15], v1, s[32:35], s46 offen offset:1024 sc1
v_mfma_f32_16x16x32_bf16 v[132:135], v[160:163], a[48:51], v[132:135]
s_add_u32 s46, s59, 65536
ds_read_b128 v[156:159], v6 offset:6144
v_mfma_f32_16x16x32_bf16 v[136:139], v[160:163], a[52:55], v[136:139]
s_waitcnt lgkmcnt(3)
v_mfma_f32_16x16x32_bf16 v[140:143], v[164:167], a[48:51], v[140:143]
ds_read_b128 v[160:163], v6 offset:7168
v_mfma_f32_16x16x32_bf16 v[144:147], v[164:167], a[52:55], v[144:147]
s_waitcnt lgkmcnt(3)
buffer_load_dwordx4 v1, s[32:35], s67 offen offset:0 sc1 lds
v_mfma_f32_16x16x32_bf16 v[168:171], v[148:151], a[48:51], v[168:171]
s_add_u32 s68, s75, 4096
ds_read_b128 v[164:167], v6 offset:8192
v_mfma_f32_16x16x32_bf16 v[172:175], v[148:151], a[52:55], v[172:175]
s_waitcnt lgkmcnt(3)
v_mfma_f32_16x16x32_bf16 v[176:179], v[152:155], a[48:51], v[176:179]
ds_read_b128 v[148:151], v6 offset:9216
v_mfma_f32_16x16x32_bf16 v[180:183], v[152:155], a[52:55], v[180:183]
s_waitcnt lgkmcnt(3)
buffer_load_dwordx4 v1, s[32:35], s67 offen offset:1024 sc1 lds
v_mfma_f32_16x16x32_bf16 v[184:187], v[156:159], a[48:51], v[184:187]
s_waitcnt vmcnt(14)
ds_read_b128 v[152:155], v6 offset:10240
v_cmp_ge_u32 s[86:87], v12, 3
v_mfma_f32_16x16x32_bf16 v[188:191], v[156:159], a[52:55], v[188:191]
s_waitcnt lgkmcnt(3)
v_mfma_f32_16x16x32_bf16 v[192:195], v[160:163], a[48:51], v[192:195]
s_cmp_eq_u64 s[86:87], -1
s_cbranch_scc0 L_slow7
L_back7:
v_mfma_f32_16x16x32_bf16 v[196:199], v[160:163], a[52:55], v[196:199]
s_waitcnt lgkmcnt(2)
ds_read_b128 v[156:159], v6 offset:11264
v_mfma_f32_16x16x32_bf16 v[200:203], v[164:167], a[48:51], v[200:203]
ds_read_b128 v[160:163], v6 offset:12288
v_mfma_f32_16x16x32_bf16 v[204:207], v[164:167], a[52:55], v[204:207]
s_waitcnt lgkmcnt(3)
buffer_load_dwordx4 v1, s[32:35], s67 offen offset:2048 sc1 lds
v_mfma_f32_16x16x32_bf16 v[116:119], v[148:151], a[56:59], v[116:119]
ds_read_b128 v[164:167], v6 offset:13312
v_mfma_f32_16x16x32_bf16 v[120:123], v[148:151], a[60:63], v[120:123]
s_waitcnt lgkmcnt(3)
v_mfma_f32_16x16x32_bf16 v[124:127], v[152:155], a[56:59], v[124:127]
ds_read_b128 v[148:151], v6 offset:14336
v_mfma_f32_16x16x32_bf16 v[128:131], v[152:155], a[60:63], v[128:131]
s_waitcnt lgkmcnt(3)
buffer_load_dwordx4 a[16:19], v1, s[32:35], s46 offen offset:0 sc1
v_mfma_f32_16x16x32_bf16 v[132:135], v[156:159], a[56:59], v[132:135]
ds_read_b128 v[152:155], v6 offset:15360
v_mfma_f32_16x16x32_bf16 v[136:139], v[156:159], a[60:63], v[136:139]
s_waitcnt lgkmcnt(3)
v_mfma_f32_16x16x32_bf16 v[140:143], v[160:163], a[56:59], v[140:143]
ds_read_b128 v[156:159], v6 offset:16384
v_mfma_f32_16x16x32_bf16 v[144:147], v[160:163], a[60:63], v[144:147]
s_waitcnt lgkmcnt(3)
buffer_load_dwordx4 a[20:23], v1, s[32:35], s46 offen offset:1024 sc1
v_mfma_f32_16x16x32_bf16 v[168:171], v[164:167], a[56:59], v[168:171]
s_add_u32 s46, s3, 65536
ds_read_b128 v[160:163], v6 offset:17408
v_lshlrev_b32 v3, 7, v0
v_mfma_f32_16x16x32_bf16 v[172:175], v[164:167], a[60:63], v[172:175]
s_waitcnt lgkmcnt(3)
v_min_u32 v3, 5120, v3
s_mul_i32 s51, s1, 5184
v_mfma_f32_16x16x32_bf16 v[176:179], v[148:151], a[56:59], v[176:179]
s_mul_i32 s48, s64, 165888
ds_read_b128 v[164:167], v6 offset:18432
v_mfma_f32_16x16x32_bf16 v[180:183], v[148:151], a[60:63], v[180:183]
s_waitcnt lgkmcnt(3)
buffer_load_dwordx4 v1, s[32:35], s67 offen offset:3072 sc1 lds
v_mfma_f32_16x16x32_bf16 v[184:187], v[152:155], a[56:59], v[184:187]
s_add_u32 s51, s51, s48
ds_read_b128 v[148:151], v6 offset:19456
s_lshl_b32 s48, s61, 2
v_mfma_f32_16x16x32_bf16 v[188:191], v[152:155], a[60:63], v[188:191]
s_waitcnt lgkmcnt(3)
v_mfma_f32_16x16x32_bf16 v[192:195], v[156:159], a[56:59], v[192:195]
s_add_u32 s48, s48, s63
ds_read_b128 v[152:155], v6 offset:20480
s_mul_i32 s48, s48, 36864
v_mfma_f32_16x16x32_bf16 v[196:199], v[156:159], a[60:63], v[196:199]
s_waitcnt lgkmcnt(3)
buffer_load_dwordx4 a[24:27], v1, s[32:35], s46 offen offset:0 sc1
v_mfma_f32_16x16x32_bf16 v[200:203], v[160:163], a[56:59], v[200:203]
s_add_u32 s48, s48, s49
ds_read_b128 v[156:159], v6 offset:21504
s_sub_u32 s49, s45, s48
v_add_u32 v222, s49, v220
v_add_u32 v222, 147456, v222
v_mfma_f32_16x16x32_bf16 v[204:207], v[160:163], a[60:63], v[204:207]
s_waitcnt lgkmcnt(3)
buffer_load_dwordx4 a[28:31], v1, s[32:35], s46 offen offset:1024 sc1
v_mfma_f32_16x16x32_bf16 v[116:119], v[164:167], a[64:67], v[116:119]
s_add_u32 m0, s72, 147456
ds_read_b128 v[160:163], v6 offset:22528
s_add_u32 s67, s75, 8192
v_mfma_f32_16x16x32_bf16 v[120:123], v[164:167], a[68:71], v[120:123]
s_waitcnt lgkmcnt(3)
buffer_load_dwordx4 v208, s[4:7], s48 offen lds
v_mfma_f32_16x16x32_bf16 v[124:127], v[148:151], a[64:67], v[124:127]
s_add_u32 m0, s72, 151552
ds_read_b128 v[164:167], v6 offset:23552
v_mfma_f32_16x16x32_bf16 v[128:131], v[148:151], a[68:71], v[128:131]
s_waitcnt lgkmcnt(3)
v_mfma_f32_16x16x32_bf16 v[132:135], v[152:155], a[64:67], v[132:135]
s_add_u32 s51, s51, 41943040
ds_read_b128 v[148:151], v6 offset:24576
v_mfma_f32_16x16x32_bf16 v[136:139], v[152:155], a[68:71], v[136:139]
s_waitcnt lgkmcnt(3)
buffer_load_dwordx4 v209, s[4:7], s48 offen lds
s_add_u32 m0, s76, 77824
v_mfma_f32_16x16x32_bf16 v[140:143], v[156:159], a[64:67], v[140:143]
buffer_load_dwordx4 v1, s[32:35], s68 offen offset:0 sc1 lds
v_mfma_f32_16x16x32_bf16 v[144:147], v[156:159], a[68:71], v[144:147]
s_waitcnt lgkmcnt(2)
buffer_load_dwordx4 v1, s[32:35], s68 offen offset:1024 sc1 lds
v_mfma_f32_16x16x32_bf16 v[168:171], v[160:163], a[64:67], v[168:171]
buffer_load_dwordx4 v1, s[32:35], s68 offen offset:2048 sc1 lds
v_mfma_f32_16x16x32_bf16 v[172:175], v[160:163], a[68:71], v[172:175]
s_waitcnt lgkmcnt(1)
buffer_load_dwordx4 v1, s[32:35], s68 offen offset:3072 sc1 lds
s_add_u32 m0, s76, 81920
v_mfma_f32_16x16x32_bf16 v[176:179], v[164:167], a[64:67], v[176:179]
buffer_load_dwordx4 v1, s[32:35], s67 offen offset:0 sc1 lds
v_mfma_f32_16x16x32_bf16 v[180:183], v[164:167], a[68:71], v[180:183]
s_waitcnt lgkmcnt(0)
ds_read_b128 v[152:155], v6 offset:25600
ds_read_b128 v[156:159], v6 offset:26624
v_mfma_f32_16x16x32_bf16 v[184:187], v[148:151], a[64:67], v[184:187]
s_add_u32 m0, s72, 155648
ds_read_b128 v[160:163], v6 offset:27648
ds_read_b128 v[164:167], v6 offset:28672
v_mfma_f32_16x16x32_bf16 v[188:191], v[148:151], a[68:71], v[188:191]
s_waitcnt lgkmcnt(3)
buffer_load_dwordx4 v210, s[4:7], s48 offen lds
v_mfma_f32_16x16x32_bf16 v[192:195], v[152:155], a[64:67], v[192:195]
ds_read_b128 v[148:151], v6 offset:29696
v_mfma_f32_16x16x32_bf16 v[196:199], v[152:155], a[68:71], v[196:199]
s_waitcnt lgkmcnt(3)
buffer_load_dword v15, v3, s[32:35], s51 offen sc1
v_mfma_f32_16x16x32_bf16 v[200:203], v[156:159], a[64:67], v[200:203]
ds_read_b128 v[152:155], v6 offset:30720
v_mfma_f32_16x16x32_bf16 v[204:207], v[156:159], a[68:71], v[204:207]
s_waitcnt lgkmcnt(3)
v_mfma_f32_16x16x32_bf16 v[116:119], v[160:163], a[72:75], v[116:119]
ds_read_b128 v[156:159], v6 offset:31744
v_mfma_f32_16x16x32_bf16 v[120:123], v[160:163], a[76:79], v[120:123]
s_waitcnt lgkmcnt(3)
v_mfma_f32_16x16x32_bf16 v[124:127], v[164:167], a[72:75], v[124:127]
ds_read_b128 v[160:163], v6 offset:32768
v_mfma_f32_16x16x32_bf16 v[128:131], v[164:167], a[76:79], v[128:131]
s_waitcnt lgkmcnt(3)
v_mfma_f32_16x16x32_bf16 v[132:135], v[148:151], a[72:75], v[132:135]
ds_read_b128 v[164:167], v6 offset:33792
v_mfma_f32_16x16x32_bf16 v[136:139], v[148:151], a[76:79], v[136:139]
s_waitcnt lgkmcnt(3)
v_mfma_f32_16x16x32_bf16 v[140:143], v[152:155], a[72:75], v[140:143]
ds_read_b128 v[148:151], v6 offset:34816
v_mfma_f32_16x16x32_bf16 v[144:147], v[152:155], a[76:79], v[144:147]
s_waitcnt lgkmcnt(3)
v_mfma_f32_16x16x32_bf16 v[168:171], v[156:159], a[72:75], v[168:171]
s_barrier
ds_read_b128 v[152:155], v6 offset:35840
v_mfma_f32_16x16x32_bf16 v[172:175], v[156:159], a[76:79], v[172:175]
s_waitcnt lgkmcnt(3)
v_mfma_f32_16x16x32_bf16 v[176:179], v[160:163], a[72:75], v[176:179]
s_add_u32 m0, s76, 110592
ds_read_b128 v[156:159], v7 offset:0
v_mfma_f32_16x16x32_bf16 v[180:183], v[160:163], a[76:79], v[180:183]
s_waitcnt lgkmcnt(3)
v_mfma_f32_16x16x32_bf16 v[184:187], v[164:167], a[72:75], v[184:187]
s_add_u32 s68, s97, 0
ds_read_b128 v[160:163], v7 offset:9216
v_mfma_f32_16x16x32_bf16 v[188:191], v[164:167], a[76:79], v[188:191]
s_waitcnt lgkmcnt(3)
buffer_load_dwordx4 v1, s[32:35], s68 offen offset:0 sc1 lds
v_mfma_f32_16x16x32_bf16 v[192:195], v[148:151], a[72:75], v[192:195]
s_add_u32 s67, s97, 4096
ds_read_b128 v[164:167], v7 offset:18432
v_mfma_f32_16x16x32_bf16 v[196:199], v[148:151], a[76:79], v[196:199]
s_waitcnt vmcnt(3) lgkmcnt(3)
v_mfma_f32_16x16x32_bf16 v[200:203], v[152:155], a[72:75], v[200:203]
s_barrier
ds_read_b128 v[148:151], v7 offset:27648
v_mfma_f32_16x16x32_bf16 v[204:207], v[152:155], a[76:79], v[204:207]
s_waitcnt lgkmcnt(3)
buffer_load_dwordx4 v1, s[32:35], s68 offen offset:1024 sc1 lds
v_mfma_f32_16x16x32_bf16 v[116:119], v[156:159], a[80:83], v[116:119]
ds_read_b128 v[152:155], v8 offset:0
v_mfma_f32_16x16x32_bf16 v[120:123], v[156:159], a[84:87], v[120:123]
s_waitcnt lgkmcnt(3)
v_mfma_f32_16x16x32_bf16 v[116:119], v[160:163], a[88:91], v[116:119]
ds_read_b128 v[156:159], v8 offset:9216
v_mfma_f32_16x16x32_bf16 v[120:123], v[160:163], a[92:95], v[120:123]
s_waitcnt lgkmcnt(3)
buffer_load_dwordx4 v1, s[32:35], s68 offen offset:2048 sc1 lds
v_mfma_f32_16x16x32_bf16 v[116:119], v[164:167], a[96:99], v[116:119]
s_add_u32 s50, s98, 0
ds_read_b128 v[160:163], v8 offset:18432
v_mfma_f32_16x16x32_bf16 v[120:123], v[164:167], a[100:103], v[120:123]
s_waitcnt lgkmcnt(3)
v_mfma_f32_16x16x32_bf16 v[116:119], v[148:151], a[104:107], v[116:119]
ds_read_b128 v[164:167], v8 offset:27648
v_mfma_f32_16x16x32_bf16 v[120:123], v[148:151], a[108:111], v[120:123]
s_waitcnt lgkmcnt(3)
buffer_load_dwordx4 a[112:115], v1, s[32:35], s50 offen offset:0 sc1
v_mfma_f32_16x16x32_bf16 v[116:119], v[152:155], a[0:3], v[116:119]
ds_read_b128 v[148:151], v7 offset:1024
v_mfma_f32_16x16x32_bf16 v[120:123], v[152:155], a[4:7], v[120:123]
s_waitcnt lgkmcnt(3)
v_mfma_f32_16x16x32_bf16 v[116:119], v[156:159], a[8:11], v[116:119]
ds_read_b128 v[152:155], v7 offset:10240
v_mfma_f32_16x16x32_bf16 v[120:123], v[156:159], a[12:15], v[120:123]
s_waitcnt lgkmcnt(3)
buffer_load_dwordx4 v1, s[32:35], s68 offen offset:3072 sc1 lds
v_mfma_f32_16x16x32_bf16 v[116:119], v[160:163], a[16:19], v[116:119]
s_add_u32 m0, s76, 114688
ds_read_b128 v[156:159], v7 offset:19456
v_mfma_f32_16x16x32_bf16 v[120:123], v[160:163], a[20:23], v[120:123]
s_waitcnt lgkmcnt(3)
v_mfma_f32_16x16x32_bf16 v[116:119], v[164:167], a[24:27], v[116:119]
s_add_u32 s68, s97, 8192
ds_read_b128 v[160:163], v7 offset:28672
v_mfma_f32_16x16x32_bf16 v[120:123], v[164:167], a[28:31], v[120:123]
s_waitcnt lgkmcnt(3)
buffer_load_dwordx4 a[116:119], v1, s[32:35], s50 offen offset:1024 sc1
v_mfma_f32_16x16x32_bf16 v[124:127], v[148:151], a[80:83], v[124:127]
ds_read_b128 v[164:167], v8 offset:1024
v_mfma_f32_16x16x32_bf16 v[128:131], v[148:151], a[84:87], v[128:131]
s_waitcnt lgkmcnt(3)
v_cvt_pk_bf16_f32 v116, v116, v117
v_cvt_pk_bf16_f32 v117, v118, v119
v_mfma_f32_16x16x32_bf16 v[124:127], v[152:155], a[88:91], v[124:127]
ds_read_b128 v[148:151], v8 offset:10240
v_cvt_pk_bf16_f32 v118, v120, v121
v_mfma_f32_16x16x32_bf16 v[128:131], v[152:155], a[92:95], v[128:131]
s_waitcnt lgkmcnt(3)
v_cvt_pk_bf16_f32 v119, v122, v123
v_mfma_f32_16x16x32_bf16 v[124:127], v[156:159], a[96:99], v[124:127]
ds_read_b128 v[152:155], v8 offset:19456
v_mfma_f32_16x16x32_bf16 v[128:131], v[156:159], a[100:103], v[128:131]
s_waitcnt lgkmcnt(3)
buffer_store_dwordx4 v[116:119], v1, s[32:35], s101 offen offset:0 sc1
v_mfma_f32_16x16x32_bf16 v[124:127], v[160:163], a[104:107], v[124:127]
ds_read_b128 v[156:159], v8 offset:28672
v_mfma_f32_16x16x32_bf16 v[128:131], v[160:163], a[108:111], v[128:131]
s_waitcnt lgkmcnt(3)
ds_write_b128 v16, v[116:119] offset:0
v_mfma_f32_16x16x32_bf16 v[124:127], v[164:167], a[0:3], v[124:127]
ds_read_b128 v[160:163], v7 offset:2048
v_mfma_f32_16x16x32_bf16 v[128:131], v[164:167], a[4:7], v[128:131]
s_waitcnt lgkmcnt(4)
v_mfma_f32_16x16x32_bf16 v[124:127], v[148:151], a[8:11], v[124:127]
ds_read_b128 v[164:167], v7 offset:11264
v_mfma_f32_16x16x32_bf16 v[128:131], v[148:151], a[12:15], v[128:131]
s_waitcnt lgkmcnt(4)
buffer_load_dwordx4 a[120:123], v11, s[32:35], s50 offen offset:2048 sc1
v_mfma_f32_16x16x32_bf16 v[124:127], v[152:155], a[16:19], v[124:127]
s_add_u32 s50, s98, 9216
ds_read_b128 v[148:151], v7 offset:20480
v_mfma_f32_16x16x32_bf16 v[128:131], v[152:155], a[20:23], v[128:131]
s_waitcnt lgkmcnt(4)
buffer_load_dwordx4 v1, s[32:35], s67 offen offset:0 sc1 lds
v_mfma_f32_16x16x32_bf16 v[124:127], v[156:159], a[24:27], v[124:127]
ds_read_b128 v[152:155], v7 offset:29696
v_mfma_f32_16x16x32_bf16 v[128:131], v[156:159], a[28:31], v[128:131]
s_waitcnt lgkmcnt(3)
v_mfma_f32_16x16x32_bf16 v[132:135], v[160:163], a[80:83], v[132:135]
ds_read_b128 v[156:159], v8 offset:2048
v_mfma_f32_16x16x32_bf16 v[136:139], v[160:163], a[84:87], v[136:139]
s_waitcnt lgkmcnt(3)
buffer_load_dwordx4 a[124:127], v1, s[32:35], s50 offen offset:0 sc1
v_mfma_f32_16x16x32_bf16 v[132:135], v[164:167], a[88:91], v[132:135]
ds_read_b128 v[160:163], v8 offset:11264
v_cvt_pk_bf16_f32 v124, v124, v125
v_mfma_f32_16x16x32_bf16 v[136:139], v[164:167], a[92:95], v[136:139]
s_waitcnt lgkmcnt(3)
v_cvt_pk_bf16_f32 v125, v126, v127
v_cvt_pk_bf16_f32 v126, v128, v129
v_mfma_f32_16x16x32_bf16 v[132:135], v[148:151], a[96:99], v[132:135]
ds_read_b128 v[164:167], v8 offset:20480
v_cvt_pk_bf16_f32 v127, v130, v131
v_mfma_f32_16x16x32_bf16 v[136:139], v[148:151], a[100:103], v[136:139]
s_waitcnt lgkmcnt(3)
buffer_store_dwordx4 v[124:127], v1, s[32:35], s101 offen offset:1024 sc1
v_mfma_f32_16x16x32_bf16 v[132:135], v[152:155], a[104:107], v[132:135]
ds_read_b128 v[148:151], v8 offset:29696
v_mfma_f32_16x16x32_bf16 v[136:139], v[152:155], a[108:111], v[136:139]
s_waitcnt lgkmcnt(3)
ds_write_b128 v16, v[124:127] offset:1024
v_mfma_f32_16x16x32_bf16 v[132:135], v[156:159], a[0:3], v[132:135]
ds_read_b128 v[152:155], v7 offset:3072
v_mfma_f32_16x16x32_bf16 v[136:139], v[156:159], a[4:7], v[136:139]
s_waitcnt lgkmcnt(4)
v_mfma_f32_16x16x32_bf16 v[132:135], v[160:163], a[8:11], v[132:135]
ds_read_b128 v[156:159], v7 offset:12288
v_mfma_f32_16x16x32_bf16 v[136:139], v[160:163], a[12:15], v[136:139]
s_waitcnt lgkmcnt(4)
buffer_load_dwordx4 v1, s[32:35], s67 offen offset:1024 sc1 lds
v_mfma_f32_16x16x32_bf16 v[132:135], v[164:167], a[16:19], v[132:135]
ds_read_b128 v[160:163], v7 offset:21504
v_mfma_f32_16x16x32_bf16 v[136:139], v[164:167], a[20:23], v[136:139]
s_waitcnt lgkmcnt(4)
v_mfma_f32_16x16x32_bf16 v[132:135], v[148:151], a[24:27], v[132:135]
ds_read_b128 v[164:167], v7 offset:30720
v_mfma_f32_16x16x32_bf16 v[136:139], v[148:151], a[28:31], v[136:139]
s_waitcnt lgkmcnt(3)
buffer_load_dwordx4 a[128:131], v1, s[32:35], s50 offen offset:1024 sc1
v_mfma_f32_16x16x32_bf16 v[140:143], v[152:155], a[80:83], v[140:143]
ds_read_b128 v[148:151], v8 offset:3072
v_mfma_f32_16x16x32_bf16 v[144:147], v[152:155], a[84:87], v[144:147]
s_waitcnt lgkmcnt(3)
v_cvt_pk_bf16_f32 v132, v132, v133
v_cvt_pk_bf16_f32 v133, v134, v135
v_mfma_f32_16x16x32_bf16 v[140:143], v[156:159], a[88:91], v[140:143]
ds_read_b128 v[152:155], v8 offset:12288
v_cvt_pk_bf16_f32 v134, v136, v137
v_mfma_f32_16x16x32_bf16 v[144:147], v[156:159], a[92:95], v[144:147]
s_waitcnt lgkmcnt(3)
v_cvt_pk_bf16_f32 v135, v138, v139
v_mfma_f32_16x16x32_bf16 v[140:143], v[160:163], a[96:99], v[140:143]
ds_read_b128 v[156:159], v8 offset:21504
v_mfma_f32_16x16x32_bf16 v[144:147], v[160:163], a[100:103], v[144:147]
s_waitcnt lgkmcnt(3)
buffer_store_dwordx4 v[132:135], v1, s[32:35], s101 offen offset:2048 sc1
v_mfma_f32_16x16x32_bf16 v[140:143], v[164:167], a[104:107], v[140:143]
ds_read_b128 v[160:163], v8 offset:30720
v_mfma_f32_16x16x32_bf16 v[144:147], v[164:167], a[108:111], v[144:147]
s_waitcnt lgkmcnt(3)
ds_write_b128 v16, v[132:135] offset:2048
v_mfma_f32_16x16x32_bf16 v[140:143], v[148:151], a[0:3], v[140:143]
ds_read_b128 v[164:167], v7 offset:4096
v_mfma_f32_16x16x32_bf16 v[144:147], v[148:151], a[4:7], v[144:147]
s_waitcnt lgkmcnt(4)
v_mfma_f32_16x16x32_bf16 v[140:143], v[152:155], a[8:11], v[140:143]
ds_read_b128 v[148:151], v7 offset:13312
v_mfma_f32_16x16x32_bf16 v[144:147], v[152:155], a[12:15], v[144:147]
s_waitcnt lgkmcnt(4)
buffer_load_dwordx4 v1, s[32:35], s67 offen offset:2048 sc1 lds
v_mfma_f32_16x16x32_bf16 v[140:143], v[156:159], a[16:19], v[140:143]
ds_read_b128 v[152:155], v7 offset:22528
v_mfma_f32_16x16x32_bf16 v[144:147], v[156:159], a[20:23], v[144:147]
s_waitcnt lgkmcnt(4)
v_mfma_f32_16x16x32_bf16 v[140:143], v[160:163], a[24:27], v[140:143]
ds_read_b128 v[156:159], v7 offset:31744
v_mfma_f32_16x16x32_bf16 v[144:147], v[160:163], a[28:31], v[144:147]
s_waitcnt lgkmcnt(3)
buffer_load_dwordx4 a[132:135], v11, s[32:35], s50 offen offset:2048 sc1
v_mfma_f32_16x16x32_bf16 v[168:171], v[164:167], a[80:83], v[168:171]
s_add_u32 s50, s98, 18432
ds_read_b128 v[160:163], v8 offset:4096
v_mfma_f32_16x16x32_bf16 v[172:175], v[164:167], a[84:87], v[172:175]
s_waitcnt lgkmcnt(3)
v_cvt_pk_bf16_f32 v140, v140, v141
v_cvt_pk_bf16_f32 v141, v142, v143
v_mfma_f32_16x16x32_bf16 v[168:171], v[148:151], a[88:91], v[168:171]
ds_read_b128 v[164:167], v8 offset:13312
v_cvt_pk_bf16_f32 v142, v144, v145
v_mfma_f32_16x16x32_bf16 v[172:175], v[148:151], a[92:95], v[172:175]
s_waitcnt lgkmcnt(3)
v_cvt_pk_bf16_f32 v143, v146, v147
v_mfma_f32_16x16x32_bf16 v[168:171], v[152:155], a[96:99], v[168:171]
ds_read_b128 v[148:151], v8 offset:22528
v_mfma_f32_16x16x32_bf16 v[172:175], v[152:155], a[100:103], v[172:175]
s_waitcnt lgkmcnt(3)
buffer_store_dwordx4 v[140:143], v1, s[32:35], s101 offen offset:3072 sc1
v_mfma_f32_16x16x32_bf16 v[168:171], v[156:159], a[104:107], v[168:171]
ds_read_b128 v[152:155], v8 offset:31744
v_mfma_f32_16x16x32_bf16 v[172:175], v[156:159], a[108:111], v[172:175]
s_waitcnt lgkmcnt(3)
ds_write_b128 v16, v[140:143] offset:3072
v_mfma_f32_16x16x32_bf16 v[168:171], v[160:163], a[0:3], v[168:171]
s_add_u32 s101, s43, 4096
ds_read_b128 v[156:159], v7 offset:5120
v_mfma_f32_16x16x32_bf16 v[172:175], v[160:163], a[4:7], v[172:175]
s_waitcnt lgkmcnt(4)
v_mfma_f32_16x16x32_bf16 v[168:171], v[164:167], a[8:11], v[168:171]
ds_read_b128 v[160:163], v7 offset:14336
v_mfma_f32_16x16x32_bf16 v[172:175], v[164:167], a[12:15], v[172:175]
s_waitcnt lgkmcnt(4)
buffer_load_dwordx4 a[136:139], v1, s[32:35], s50 offen offset:0 sc1
v_mfma_f32_16x16x32_bf16 v[168:171], v[148:151], a[16:19], v[168:171]
ds_read_b128 v[164:167], v7 offset:23552
v_mfma_f32_16x16x32_bf16 v[172:175], v[148:151], a[20:23], v[172:175]
s_waitcnt lgkmcnt(4)
v_mfma_f32_16x16x32_bf16 v[168:171], v[152:155], a[24:27], v[168:171]
s_add_u32 s48, s63, 1
ds_read_b128 v[148:151], v7 offset:32768
v_mfma_f32_16x16x32_bf16 v[172:175], v[152:155], a[28:31], v[172:175]
s_waitcnt lgkmcnt(3)
buffer_load_dwordx4 v1, s[32:35], s67 offen offset:3072 sc1 lds
v_mfma_f32_16x16x32_bf16 v[176:179], v[156:159], a[80:83], v[176:179]
s_add_u32 m0, s76, 118784
ds_read_b128 v[152:155], v8 offset:5120
v_cvt_pk_bf16_f32 v168, v168, v169
v_mfma_f32_16x16x32_bf16 v[180:183], v[156:159], a[84:87], v[180:183]
s_waitcnt lgkmcnt(3)
v_cvt_pk_bf16_f32 v169, v170, v171
v_cvt_pk_bf16_f32 v170, v172, v173
v_mfma_f32_16x16x32_bf16 v[176:179], v[160:163], a[88:91], v[176:179]
s_and_b32 s48, s48, 3
ds_read_b128 v[156:159], v8 offset:14336
v_cvt_pk_bf16_f32 v171, v174, v175
v_mfma_f32_16x16x32_bf16 v[180:183], v[160:163], a[92:95], v[180:183]
s_waitcnt lgkmcnt(3)
buffer_store_dwordx4 v[168:171], v1, s[32:35], s101 offen offset:0 sc1
v_mfma_f32_16x16x32_bf16 v[176:179], v[164:167], a[96:99], v[176:179]
s_mul_i32 s48, s48, 9216
ds_read_b128 v[160:163], v8 offset:23552
v_mfma_f32_16x16x32_bf16 v[180:183], v[164:167], a[100:103], v[180:183]
s_waitcnt lgkmcnt(3)
ds_write_b128 v16, v[168:171] offset:4096
v_mfma_f32_16x16x32_bf16 v[176:179], v[148:151], a[104:107], v[176:179]
s_add_u32 s48, s48, s44
ds_read_b128 v[164:167], v8 offset:32768
v_mfma_f32_16x16x32_bf16 v[180:183], v[148:151], a[108:111], v[180:183]
s_waitcnt lgkmcnt(4)
v_mfma_f32_16x16x32_bf16 v[176:179], v[152:155], a[0:3], v[176:179]
s_add_u32 s49, s63, 2
ds_read_b128 v[148:151], v7 offset:6144
v_mfma_f32_16x16x32_bf16 v[180:183], v[152:155], a[4:7], v[180:183]
s_waitcnt lgkmcnt(4)
buffer_load_dwordx4 a[140:143], v1, s[32:35], s50 offen offset:1024 sc1
v_mfma_f32_16x16x32_bf16 v[176:179], v[156:159], a[8:11], v[176:179]
s_and_b32 s49, s49, 3
ds_read_b128 v[152:155], v7 offset:15360
v_mfma_f32_16x16x32_bf16 v[180:183], v[156:159], a[12:15], v[180:183]
s_waitcnt lgkmcnt(4)
v_mfma_f32_16x16x32_bf16 v[176:179], v[160:163], a[16:19], v[176:179]
s_mul_i32 s49, s49, 9216
ds_read_b128 v[156:159], v7 offset:24576
v_mfma_f32_16x16x32_bf16 v[180:183], v[160:163], a[20:23], v[180:183]
s_waitcnt lgkmcnt(3)
buffer_load_dwordx4 v1, s[32:35], s68 offen offset:0 sc1 lds
v_mfma_f32_16x16x32_bf16 v[176:179], v[164:167], a[24:27], v[176:179]
s_add_u32 s49, s49, s44
ds_read_b128 v[160:163], v7 offset:33792
v_mfma_f32_16x16x32_bf16 v[180:183], v[164:167], a[28:31], v[180:183]
s_waitcnt lgkmcnt(3)
v_mfma_f32_16x16x32_bf16 v[184:187], v[148:151], a[80:83], v[184:187]
s_add_u32 s51, s63, 3
ds_read_b128 v[164:167], v8 offset:6144
v_mfma_f32_16x16x32_bf16 v[188:191], v[148:151], a[84:87], v[188:191]
s_waitcnt lgkmcnt(3)
v_cvt_pk_bf16_f32 v176, v176, v177
v_cvt_pk_bf16_f32 v177, v178, v179
v_mfma_f32_16x16x32_bf16 v[184:187], v[152:155], a[88:91], v[184:187]
s_and_b32 s51, s51, 3
ds_read_b128 v[148:151], v8 offset:15360
v_cvt_pk_bf16_f32 v178, v180, v181
v_mfma_f32_16x16x32_bf16 v[188:191], v[152:155], a[92:95], v[188:191]
s_waitcnt lgkmcnt(3)
v_cvt_pk_bf16_f32 v179, v182, v183
v_mfma_f32_16x16x32_bf16 v[184:187], v[156:159], a[96:99], v[184:187]
s_mul_i32 s51, s51, 9216
ds_read_b128 v[152:155], v8 offset:24576
v_mfma_f32_16x16x32_bf16 v[188:191], v[156:159], a[100:103], v[188:191]
s_waitcnt lgkmcnt(3)
buffer_store_dwordx4 v[176:179], v1, s[32:35], s101 offen offset:1024 sc1
v_mfma_f32_16x16x32_bf16 v[184:187], v[160:163], a[104:107], v[184:187]
s_add_u32 s51, s51, s44
ds_read_b128 v[156:159], v8 offset:33792
v_mfma_f32_16x16x32_bf16 v[188:191], v[160:163], a[108:111], v[188:191]
s_waitcnt lgkmcnt(3)
ds_write_b128 v16, v[176:179] offset:5120
v_mfma_f32_16x16x32_bf16 v[184:187], v[164:167], a[0:3], v[184:187]
s_mul_i32 s46, s64, 165888
ds_read_b128 v[160:163], v7 offset:7168
v_mfma_f32_16x16x32_bf16 v[188:191], v[164:167], a[4:7], v[188:191]
s_waitcnt lgkmcnt(4)
buffer_load_dwordx4 a[144:147], v11, s[32:35], s50 offen offset:2048 sc1
v_mfma_f32_16x16x32_bf16 v[184:187], v[148:151], a[8:11], v[184:187]
s_add_u32 s50, s98, 27648
ds_read_b128 v[164:167], v7 offset:16384
v_mfma_f32_16x16x32_bf16 v[188:191], v[148:151], a[12:15], v[188:191]
s_waitcnt lgkmcnt(4)
buffer_load_dwordx4 a[148:151], v1, s[32:35], s50 offen offset:0 sc1
v_mfma_f32_16x16x32_bf16 v[184:187], v[152:155], a[16:19], v[184:187]
s_sub_u32 s46, s98, s46
ds_read_b128 v[148:151], v7 offset:25600
v_mfma_f32_16x16x32_bf16 v[188:191], v[152:155], a[20:23], v[188:191]
s_waitcnt lgkmcnt(4)
buffer_load_dwordx4 a[152:155], v1, s[32:35], s50 offen offset:1024 sc1
v_mfma_f32_16x16x32_bf16 v[184:187], v[156:159], a[24:27], v[184:187]
s_sub_u32 s46, s46, 41943040
ds_read_b128 v[152:155], v7 offset:34816
v_mfma_f32_16x16x32_bf16 v[188:191], v[156:159], a[28:31], v[188:191]
s_waitcnt lgkmcnt(3)
buffer_load_dwordx4 a[156:159], v11, s[32:35], s50 offen offset:2048 sc1
v_mfma_f32_16x16x32_bf16 v[192:195], v[160:163], a[80:83], v[192:195]
s_add_u32 s50, s98, 36864
ds_read_b128 v[156:159], v8 offset:7168
v_cvt_pk_bf16_f32 v184, v184, v185
v_mfma_f32_16x16x32_bf16 v[196:199], v[160:163], a[84:87], v[196:199]
s_waitcnt lgkmcnt(3)
v_cvt_pk_bf16_f32 v185, v186, v187
v_cvt_pk_bf16_f32 v186, v188, v189
v_mfma_f32_16x16x32_bf16 v[192:195], v[164:167], a[88:91], v[192:195]
s_mul_i32 s47, s63, 9216
ds_read_b128 v[160:163], v8 offset:16384
v_cvt_pk_bf16_f32 v187, v190, v191
v_mfma_f32_16x16x32_bf16 v[196:199], v[164:167], a[92:95], v[196:199]
s_waitcnt lgkmcnt(3)
buffer_store_dwordx4 v[184:187], v1, s[32:35], s101 offen offset:2048 sc1
v_mfma_f32_16x16x32_bf16 v[192:195], v[148:151], a[96:99], v[192:195]
s_add_u32 s46, s46, s47
ds_read_b128 v[164:167], v8 offset:25600
v_add_u32 v17, s46, v1
v_mfma_f32_16x16x32_bf16 v[196:199], v[148:151], a[100:103], v[196:199]
s_waitcnt lgkmcnt(3)
ds_write_b128 v16, v[184:187] offset:6144
v_mfma_f32_16x16x32_bf16 v[192:195], v[152:155], a[104:107], v[192:195]
ds_read_b128 v[148:151], v8 offset:34816
v_mfma_f32_16x16x32_bf16 v[196:199], v[152:155], a[108:111], v[196:199]
s_waitcnt lgkmcnt(4)
buffer_load_dwordx4 a[160:163], v1, s[32:35], s50 offen offset:0 sc1
v_mfma_f32_16x16x32_bf16 v[192:195], v[156:159], a[0:3], v[192:195]
ds_read_b128 v[152:155], v7 offset:8192
v_mfma_f32_16x16x32_bf16 v[196:199], v[156:159], a[4:7], v[196:199]
s_waitcnt lgkmcnt(4)
buffer_load_dwordx4 a[164:167], v1, s[32:35], s50 offen offset:1024 sc1
v_mfma_f32_16x16x32_bf16 v[192:195], v[160:163], a[8:11], v[192:195]
ds_read_b128 v[156:159], v7 offset:17408
v_mfma_f32_16x16x32_bf16 v[196:199], v[160:163], a[12:15], v[196:199]
s_waitcnt lgkmcnt(4)
buffer_load_dwordx4 a[168:171], v11, s[32:35], s50 offen offset:2048 sc1
v_mfma_f32_16x16x32_bf16 v[192:195], v[164:167], a[16:19], v[192:195]
s_add_u32 s50, s98, 46080
ds_read_b128 v[160:163], v7 offset:26624
v_mfma_f32_16x16x32_bf16 v[196:199], v[164:167], a[20:23], v[196:199]
s_waitcnt lgkmcnt(3)
buffer_load_dwordx4 a[172:175], v1, s[32:35], s50 offen offset:0 sc1
v_mfma_f32_16x16x32_bf16 v[192:195], v[148:151], a[24:27], v[192:195]
ds_read_b128 v[164:167], v7 offset:35840
v_mfma_f32_16x16x32_bf16 v[196:199], v[148:151], a[28:31], v[196:199]
s_waitcnt lgkmcnt(3)
v_mfma_f32_16x16x32_bf16 v[200:203], v[152:155], a[80:83], v[200:203]
ds_read_b128 v[148:151], v8 offset:8192
v_mfma_f32_16x16x32_bf16 v[204:207], v[152:155], a[84:87], v[204:207]
s_waitcnt lgkmcnt(3)
buffer_load_dwordx4 a[176:179], v1, s[32:35], s50 offen offset:1024 sc1
v_mfma_f32_16x16x32_bf16 v[200:203], v[156:159], a[88:91], v[200:203]
ds_read_b128 v[152:155], v8 offset:17408
v_cvt_pk_bf16_f32 v192, v192, v193
v_mfma_f32_16x16x32_bf16 v[204:207], v[156:159], a[92:95], v[204:207]
s_waitcnt lgkmcnt(3)
v_cvt_pk_bf16_f32 v193, v194, v195
v_cvt_pk_bf16_f32 v194, v196, v197
v_mfma_f32_16x16x32_bf16 v[200:203], v[160:163], a[96:99], v[200:203]
ds_read_b128 v[156:159], v8 offset:26624
v_cvt_pk_bf16_f32 v195, v198, v199
v_mfma_f32_16x16x32_bf16 v[204:207], v[160:163], a[100:103], v[204:207]
s_waitcnt lgkmcnt(3)
buffer_store_dwordx4 v[192:195], v1, s[32:35], s101 offen offset:3072 sc1
v_mfma_f32_16x16x32_bf16 v[200:203], v[164:167], a[104:107], v[200:203]
ds_read_b128 v[160:163], v8 offset:35840
v_mfma_f32_16x16x32_bf16 v[204:207], v[164:167], a[108:111], v[204:207]
s_waitcnt lgkmcnt(3)
ds_write_b128 v16, v[192:195] offset:7168
v_mfma_f32_16x16x32_bf16 v[200:203], v[148:151], a[0:3], v[200:203]
s_add_u32 s101, s43, 8192
v_mfma_f32_16x16x32_bf16 v[204:207], v[148:151], a[4:7], v[204:207]
s_waitcnt lgkmcnt(3)
buffer_load_dwordx4 a[180:183], v11, s[32:35], s50 offen offset:2048 sc1
v_mfma_f32_16x16x32_bf16 v[200:203], v[152:155], a[8:11], v[200:203]
s_add_u32 s50, s98, 55296
buffer_load_dwordx4 a[184:187], v1, s[32:35], s50 offen offset:0 sc1
v_mfma_f32_16x16x32_bf16 v[204:207], v[152:155], a[12:15], v[204:207]
s_waitcnt vmcnt(14) lgkmcnt(2)
v_mfma_f32_16x16x32_bf16 v[200:203], v[156:159], a[16:19], v[200:203]
s_barrier
buffer_load_dwordx4 a[188:191], v1, s[32:35], s50 offen offset:1024 sc1
v_mfma_f32_16x16x32_bf16 v[204:207], v[156:159], a[20:23], v[204:207]
s_waitcnt lgkmcnt(1)
v_mfma_f32_16x16x32_bf16 v[200:203], v[160:163], a[24:27], v[200:203]
ds_read_b128 v[84:87], v9 offset:0
ds_read_b128 v[88:91], v9 offset:1024
v_mfma_f32_16x16x32_bf16 v[204:207], v[160:163], a[28:31], v[204:207]
buffer_load_dwordx4 a[192:195], v11, s[32:35], s50 offen offset:2048 sc1
s_add_u32 s50, s98, 64512
buffer_load_dwordx4 a[196:199], v1, s[32:35], s50 offen offset:0 sc1
s_waitcnt lgkmcnt(0)
buffer_load_dwordx4 a[200:203], v1, s[32:35], s50 offen offset:1024 sc1
v_cvt_pk_bf16_f32 v200, v200, v201
v_cvt_pk_bf16_f32 v201, v202, v203
ds_read_b128 v[92:95], v9 offset:2048
v_swap_b32 v86, v88
ds_read_b128 v[96:99], v9 offset:3072
v_swap_b32 v87, v89
v_cvt_pk_bf16_f32 v202, v204, v205
v_cvt_pk_bf16_f32 v203, v206, v207
buffer_store_dwordx4 v[200:203], v1, s[32:35], s101 offen offset:0 sc1
v_mfma_f32_16x16x32_bf16 v[52:55], a[112:115], v[84:87], 0
ds_write_b128 v16, v[200:203] offset:8192
v_mfma_f32_16x16x32_bf16 v[56:59], a[112:115], v[88:91], 0
v_mfma_f32_16x16x32_bf16 v[60:63], a[116:119], v[84:87], 0
v_mfma_f32_16x16x32_bf16 v[64:67], a[116:119], v[88:91], 0
s_waitcnt lgkmcnt(1)
buffer_load_dwordx4 a[204:207], v11, s[32:35], s50 offen offset:2048 sc1
v_mfma_f32_16x16x32_bf16 v[68:71], a[120:123], v[84:87], 0
s_add_u32 s50, s98, 73728
ds_read_b128 v[100:103], v9 offset:4096
v_swap_b32 v94, v96
v_mfma_f32_16x16x32_bf16 v[72:75], a[120:123], v[88:91], 0
ds_read_b128 v[104:107], v9 offset:5120
v_swap_b32 v95, v97
s_waitcnt lgkmcnt(2)
buffer_load_dwordx4 a[208:211], v1, s[32:35], s50 offen offset:0 sc1
s_barrier
ds_read_b128 v[232:235], v17 offset:0
ds_read_b128 v[236:239], v17 offset:1024
v_mfma_f32_16x16x32_bf16 v[52:55], a[124:127], v[92:95], v[52:55]
ds_read_b128 v[240:243], v17 offset:2048
v_mov_b32 v168, 0
v_mfma_f32_16x16x32_bf16 v[56:59], a[124:127], v[96:99], v[56:59]
buffer_load_dwordx4 a[212:215], v1, s[32:35], s50 offen offset:1024 sc1
v_mfma_f32_16x16x32_bf16 v[60:63], a[128:131], v[92:95], v[60:63]
v_mov_b32 v169, 0
v_mov_b32 v170, 0
v_mfma_f32_16x16x32_bf16 v[64:67], a[128:131], v[96:99], v[64:67]
s_waitcnt lgkmcnt(3)
v_swap_b32 v102, v104
v_swap_b32 v103, v105
v_mfma_f32_16x16x32_bf16 v[68:71], a[132:135], v[92:95], v[68:71]
buffer_load_dwordx4 a[216:219], v11, s[32:35], s50 offen offset:2048 sc1
v_mfma_f32_16x16x32_bf16 v[72:75], a[132:135], v[96:99], v[72:75]
s_add_u32 s50, s98, 82944
ds_read_b128 v[84:87], v9 offset:6144
ds_read_b128 v[88:91], v9 offset:7168
buffer_load_dwordx4 a[220:223], v1, s[32:35], s50 offen offset:0 sc1
ds_read_b64 v[208:209], v222 offset:0
v_mov_b32 v171, 0
v_mfma_f32_16x16x32_bf16 v[52:55], a[136:139], v[100:103], v[52:55]
ds_read_b64 v[210:211], v222 offset:4608
v_mov_b32 v172, 0
v_mfma_f32_16x16x32_bf16 v[56:59], a[136:139], v[104:107], v[56:59]
buffer_load_dwordx4 a[224:227], v1, s[32:35], s50 offen offset:1024 sc1
v_mfma_f32_16x16x32_bf16 v[60:63], a[140:143], v[100:103], v[60:63]
ds_read_b64 v[212:213], v222 offset:32
v_mov_b32 v173, 0
v_mfma_f32_16x16x32_bf16 v[64:67], a[140:143], v[104:107], v[64:67]
s_waitcnt vmcnt(23) lgkmcnt(3)
ds_read_b64 v[214:215], v222 offset:4640
v_swap_b32 v86, v88
v_mfma_f32_16x16x32_bf16 v[68:71], a[144:147], v[100:103], v[68:71]
ds_read_b128 v[92:95], v9 offset:8192
v_swap_b32 v87, v89
v_mfma_f32_16x16x32_bf16 v[72:75], a[144:147], v[104:107], v[72:75]
buffer_load_dwordx4 a[228:231], v11, s[32:35], s50 offen offset:2048 sc1
s_add_u32 s50, s98, 92160
ds_read_b128 v[96:99], v9 offset:9216
v_mov_b32 v174, 0
s_waitcnt vmcnt(23)
buffer_load_dwordx4 a[232:235], v1, s[32:35], s50 offen offset:0 sc1
v_mfma_f32_16x16x32_bf16 v[52:55], a[148:151], v[84:87], v[52:55]
s_waitcnt lgkmcnt(5)
ds_read_b64 v[216:217], v222 offset:64
v_mov_b32 v175, 0
v_mfma_f32_16x16x32_bf16 v[56:59], a[148:151], v[88:91], v[56:59]
s_waitcnt vmcnt(23)
ds_read_b64 v[218:219], v222 offset:4672
v_mov_b32 v176, 0
v_mfma_f32_16x16x32_bf16 v[60:63], a[152:155], v[84:87], v[60:63]
buffer_load_dwordx4 a[236:239], v1, s[32:35], s50 offen offset:1024 sc1
v_mfma_f32_16x16x32_bf16 v[64:67], a[152:155], v[88:91], v[64:67]
s_waitcnt vmcnt(23)
v_mov_b32 v177, 0
v_mov_b32 v178, 0
v_mfma_f32_16x16x32_bf16 v[68:71], a[156:159], v[84:87], v[68:71]
s_waitcnt lgkmcnt(2)
ds_read_b128 v[100:103], v9 offset:10240
v_swap_b32 v94, v96
v_mfma_f32_16x16x32_bf16 v[72:75], a[156:159], v[88:91], v[72:75]
ds_read_b128 v[104:107], v9 offset:11264
v_swap_b32 v95, v97
buffer_load_dwordx4 a[240:243], v11, s[32:35], s50 offen offset:2048 sc1
v_mov_b32 v179, 0
s_waitcnt vmcnt(22)
v_mov_b32 v180, 0
s_add_u32 s50, s98, 101376
v_mfma_f32_16x16x32_bf16 v[52:55], a[160:163], v[92:95], v[52:55]
s_waitcnt vmcnt(10)
buffer_store_dword v18, v13, s[32:35], s77 offen sc1
v_mov_b32 v181, 0
v_mfma_f32_16x16x32_bf16 v[56:59], a[160:163], v[96:99], v[56:59]
v_mov_b32 v182, 0
v_lshlrev_b32 v124, 16, v208
v_mfma_f32_16x16x32_bf16 v[60:63], a[164:167], v[92:95], v[60:63]
v_mov_b32 v183, 0
v_and_b32 v125, s93, v208
v_mfma_f32_16x16x32_bf16 v[64:67], a[164:167], v[96:99], v[64:67]
s_waitcnt lgkmcnt(0)
buffer_load_dwordx4 a[244:247], v1, s[32:35], s50 offen offset:0 sc1
v_mov_b32 v184, 0
v_mfma_f32_16x16x32_bf16 v[68:71], a[168:171], v[92:95], v[68:71]
ds_read_b128 v[84:87], v9 offset:12288
v_swap_b32 v102, v104
v_mov_b32 v185, 0
v_mfma_f32_16x16x32_bf16 v[72:75], a[168:171], v[96:99], v[72:75]
ds_read_b128 v[88:91], v9 offset:13312
v_swap_b32 v103, v105
v_lshlrev_b32 v126, 16, v209
v_mov_b32 v186, 0
buffer_load_dwordx4 a[248:251], v1, s[32:35], s50 offen offset:1024 sc1
v_mov_b32 v187, 0
v_and_b32 v127, s93, v209
v_mov_b32 v188, 0
v_mfma_f32_16x16x32_bf16 v[52:55], a[172:175], v[100:103], v[52:55]
buffer_load_dwordx4 a[252:255], v11, s[32:35], s50 offen offset:2048 sc1
v_lshlrev_b32 v128, 16, v210
v_mov_b32 v189, 0
v_mfma_f32_16x16x32_bf16 v[56:59], a[172:175], v[104:107], v[56:59]
s_add_u32 s50, s98, 110592
buffer_load_dwordx4 a[0:3], v1, s[32:35], s50 offen offset:0 sc1
v_mov_b32 v190, 0
v_mfma_f32_16x16x32_bf16 v[60:63], a[176:179], v[100:103], v[60:63]
v_and_b32 v129, s93, v210
v_mov_b32 v191, 0
v_mfma_f32_16x16x32_bf16 v[64:67], a[176:179], v[104:107], v[64:67]
s_waitcnt lgkmcnt(0)
buffer_load_dwordx4 a[4:7], v1, s[32:35], s50 offen offset:1024 sc1
v_mfma_f32_16x16x32_bf16 v[68:71], a[180:183], v[100:103], v[68:71]
ds_read_b128 v[92:95], v9 offset:14336
v_swap_b32 v86, v88
v_lshlrev_b32 v130, 16, v211
v_mfma_f32_16x16x32_bf16 v[72:75], a[180:183], v[104:107], v[72:75]
ds_read_b128 v[96:99], v9 offset:15360
v_swap_b32 v87, v89
v_and_b32 v131, s93, v211
buffer_load_dwordx4 a[8:11], v11, s[32:35], s50 offen offset:2048 sc1
s_add_u32 s50, s98, 119808
buffer_load_dwordx4 a[12:15], v1, s[32:35], s50 offen offset:0 sc1
v_lshlrev_b32 v132, 16, v212
v_mfma_f32_16x16x32_bf16 v[52:55], a[184:187], v[84:87], v[52:55]
v_and_b32 v133, s93, v212
v_lshlrev_b32 v134, 16, v213
v_mfma_f32_16x16x32_bf16 v[56:59], a[184:187], v[88:91], v[56:59]
buffer_load_dwordx4 a[16:19], v1, s[32:35], s50 offen offset:1024 sc1
v_mfma_f32_16x16x32_bf16 v[60:63], a[188:191], v[84:87], v[60:63]
v_and_b32 v135, s93, v213
v_lshlrev_b32 v136, 16, v214
v_mfma_f32_16x16x32_bf16 v[64:67], a[188:191], v[88:91], v[64:67]
s_waitcnt lgkmcnt(0)
v_and_b32 v137, s93, v214
v_swap_b32 v94, v96
v_mfma_f32_16x16x32_bf16 v[68:71], a[192:195], v[84:87], v[68:71]
ds_read_b128 v[100:103], v9 offset:16384
v_swap_b32 v95, v97
v_mfma_f32_16x16x32_bf16 v[72:75], a[192:195], v[88:91], v[72:75]
buffer_load_dwordx4 a[20:23], v11, s[32:35], s50 offen offset:2048 sc1
s_add_u32 s50, s98, 129024
ds_read_b128 v[104:107], v9 offset:17408
v_lshlrev_b32 v138, 16, v215
buffer_load_dword v12, v4, s[32:35], s58 offen sc1
v_mfma_f32_16x16x32_bf16 v[52:55], a[196:199], v[92:95], v[52:55]
v_and_b32 v139, s93, v215
v_lshlrev_b32 v140, 16, v216
v_mfma_f32_16x16x32_bf16 v[56:59], a[196:199], v[96:99], v[56:59]
buffer_load_dwordx4 a[24:27], v1, s[32:35], s50 offen offset:0 sc1
v_mfma_f32_16x16x32_bf16 v[60:63], a[200:203], v[92:95], v[60:63]
v_and_b32 v141, s93, v216
v_lshlrev_b32 v142, 16, v217
v_mfma_f32_16x16x32_bf16 v[64:67], a[200:203], v[96:99], v[64:67]
s_waitcnt vmcnt(21)
v_and_b32 v143, s93, v217
v_lshlrev_b32 v144, 16, v218
v_mfma_f32_16x16x32_bf16 v[68:71], a[204:207], v[92:95], v[68:71]
s_waitcnt lgkmcnt(0)
ds_read_b128 v[84:87], v9 offset:18432
v_swap_b32 v102, v104
v_mfma_f32_16x16x32_bf16 v[72:75], a[204:207], v[96:99], v[72:75]
ds_read_b128 v[88:91], v9 offset:19456
v_swap_b32 v103, v105
buffer_load_dwordx4 a[28:31], v1, s[32:35], s50 offen offset:1024 sc1
s_waitcnt vmcnt(21)
v_and_b32 v145, s93, v218
v_lshlrev_b32 v146, 16, v219
v_mfma_f32_16x16x32_bf16 v[52:55], a[208:211], v[100:103], v[52:55]
v_and_b32 v147, s93, v219
v_mfma_f32_16x16x32_bf16 v[56:59], a[208:211], v[104:107], v[56:59]
s_waitcnt vmcnt(20)
buffer_load_dwordx4 a[32:35], v11, s[32:35], s50 offen offset:2048 sc1
v_mfma_f32_16x16x32_bf16 v[60:63], a[212:215], v[100:103], v[60:63]
s_add_u32 s50, s98, 138240
v_mfma_f32_16x16x32_bf16 v[64:67], a[212:215], v[104:107], v[64:67]
s_waitcnt vmcnt(20) lgkmcnt(0)
buffer_load_dwordx4 a[36:39], v1, s[32:35], s50 offen offset:0 sc1
v_mfma_f32_16x16x32_bf16 v[68:71], a[216:219], v[100:103], v[68:71]
ds_read_b128 v[92:95], v9 offset:20480
v_swap_b32 v86, v88
v_mfma_f32_16x16x32_bf16 v[72:75], a[216:219], v[104:107], v[72:75]
ds_read_b128 v[96:99], v9 offset:21504
v_swap_b32 v87, v89
buffer_load_dwordx4 a[40:43], v1, s[32:35], s50 offen offset:1024 sc1
s_waitcnt vmcnt(21)
v_mfma_f32_16x16x32_bf16 v[52:55], a[220:223], v[84:87], v[52:55]
v_mfma_f32_16x16x32_bf16 v[56:59], a[220:223], v[88:91], v[56:59]
s_waitcnt vmcnt(20)
buffer_load_dwordx4 a[44:47], v11, s[32:35], s50 offen offset:2048 sc1
v_mfma_f32_16x16x32_bf16 v[60:63], a[224:227], v[84:87], v[60:63]
s_add_u32 s50, s98, 147456
v_mfma_f32_16x16x32_bf16 v[64:67], a[224:227], v[88:91], v[64:67]
s_waitcnt vmcnt(20) lgkmcnt(0)
buffer_load_dwordx4 a[48:51], v1, s[32:35], s50 offen offset:0 sc1
v_mfma_f32_16x16x32_bf16 v[68:71], a[228:231], v[84:87], v[68:71]
ds_read_b128 v[100:103], v9 offset:22528
v_swap_b32 v94, v96
v_mfma_f32_16x16x32_bf16 v[72:75], a[228:231], v[88:91], v[72:75]
ds_read_b128 v[104:107], v9 offset:23552
v_swap_b32 v95, v97
buffer_load_dwordx4 a[52:55], v1, s[32:35], s50 offen offset:1024 sc1
s_waitcnt vmcnt(21)
v_mfma_f32_16x16x32_bf16 v[52:55], a[232:235], v[92:95], v[52:55]
v_mfma_f32_16x16x32_bf16 v[56:59], a[232:235], v[96:99], v[56:59]
s_waitcnt vmcnt(20)
buffer_load_dwordx4 a[56:59], v11, s[32:35], s50 offen offset:2048 sc1
v_mfma_f32_16x16x32_bf16 v[60:63], a[236:239], v[92:95], v[60:63]
s_add_u32 s50, s98, 156672
v_mfma_f32_16x16x32_bf16 v[64:67], a[236:239], v[96:99], v[64:67]
s_waitcnt vmcnt(20) lgkmcnt(0)
buffer_load_dwordx4 a[60:63], v1, s[32:35], s50 offen offset:0 sc1
v_mfma_f32_16x16x32_bf16 v[68:71], a[240:243], v[92:95], v[68:71]
ds_read_b128 v[84:87], v9 offset:24576
v_swap_b32 v102, v104
v_mfma_f32_16x16x32_bf16 v[72:75], a[240:243], v[96:99], v[72:75]
ds_read_b128 v[88:91], v9 offset:25600
v_swap_b32 v103, v105
buffer_load_dwordx4 a[64:67], v1, s[32:35], s50 offen offset:1024 sc1
s_waitcnt vmcnt(20)
v_mfma_f32_16x16x32_bf16 v[52:55], a[244:247], v[100:103], v[52:55]
v_mfma_f32_16x16x32_bf16 v[56:59], a[244:247], v[104:107], v[56:59]
s_waitcnt vmcnt(19)
buffer_load_dwordx4 a[68:71], v11, s[32:35], s50 offen offset:2048 sc1
v_mfma_f32_16x16x32_bf16 v[60:63], a[248:251], v[100:103], v[60:63]
v_mfma_f32_16x16x32_bf16 v[64:67], a[248:251], v[104:107], v[64:67]
s_waitcnt vmcnt(12)
v_cmp_ge_u32 s[88:89], v12, 6
v_mfma_f32_16x16x32_bf16 v[68:71], a[252:255], v[100:103], v[68:71]
s_waitcnt lgkmcnt(0)
ds_read_b128 v[92:95], v9 offset:26624
v_swap_b32 v86, v88
s_cmp_eq_u64 s[88:89], -1
s_cbranch_scc0 L_early
buffer_load_dwordx4 v[244:247], v1, s[32:35], s48 offen offset:0 sc1
buffer_load_dwordx4 v[20:23], v1, s[32:35], s49 offen offset:0 sc1
buffer_load_dwordx4 v[32:35], v1, s[32:35], s51 offen offset:0 sc1
buffer_load_dwordx4 v[248:251], v1, s[32:35], s48 offen offset:1024 sc1
buffer_load_dwordx4 v[24:27], v1, s[32:35], s49 offen offset:1024 sc1
buffer_load_dwordx4 v[36:39], v1, s[32:35], s51 offen offset:1024 sc1
buffer_load_dwordx4 v[252:255], v11, s[32:35], s48 offen offset:2048 sc1
buffer_load_dwordx4 v[28:31], v11, s[32:35], s49 offen offset:2048 sc1
buffer_load_dwordx4 v[40:43], v11, s[32:35], s51 offen offset:2048 sc1
L_early:
v_mfma_f32_16x16x32_bf16 v[72:75], a[252:255], v[104:107], v[72:75]
ds_read_b128 v[96:99], v9 offset:27648
v_swap_b32 v87, v89
s_nop 1
v_mfma_f32_16x16x32_bf16 v[52:55], a[0:3], v[84:87], v[52:55]
v_mfma_f32_16x16x32_bf16 v[56:59], a[0:3], v[88:91], v[56:59]
v_mfma_f32_16x16x32_bf16 v[60:63], a[4:7], v[84:87], v[60:63]
v_mfma_f32_16x16x32_bf16 v[64:67], a[4:7], v[88:91], v[64:67]
s_waitcnt lgkmcnt(0)
v_swap_b32 v94, v96
v_swap_b32 v95, v97
v_mfma_f32_16x16x32_bf16 v[68:71], a[8:11], v[84:87], v[68:71]
ds_read_b128 v[100:103], v9 offset:28672
ds_read_b128 v[104:107], v9 offset:29696
v_mfma_f32_16x16x32_bf16 v[72:75], a[8:11], v[88:91], v[72:75]
v_mfma_f32_16x16x32_bf16 v[52:55], a[12:15], v[92:95], v[52:55]
v_mfma_f32_16x16x32_bf16 v[56:59], a[12:15], v[96:99], v[56:59]
v_mfma_f32_16x16x32_bf16 v[60:63], a[16:19], v[92:95], v[60:63]
s_waitcnt lgkmcnt(0)
v_swap_b32 v102, v104
v_swap_b32 v103, v105
v_mfma_f32_16x16x32_bf16 v[64:67], a[16:19], v[96:99], v[64:67]
v_mfma_f32_16x16x32_bf16 v[68:71], a[20:23], v[92:95], v[68:71]
ds_read_b128 v[84:87], v9 offset:30720
ds_read_b128 v[88:91], v9 offset:31744
v_mfma_f32_16x16x32_bf16 v[72:75], a[20:23], v[96:99], v[72:75]
s_waitcnt vmcnt(11)
v_mfma_f32_16x16x32_bf16 v[52:55], a[24:27], v[100:103], v[52:55]
v_mfma_f32_16x16x32_bf16 v[56:59], a[24:27], v[104:107], v[56:59]
s_waitcnt vmcnt(10)
v_mfma_f32_16x16x32_bf16 v[60:63], a[28:31], v[100:103], v[60:63]
s_waitcnt lgkmcnt(0)
v_swap_b32 v86, v88
v_swap_b32 v87, v89
v_mfma_f32_16x16x32_bf16 v[64:67], a[28:31], v[104:107], v[64:67]
s_waitcnt vmcnt(9)
v_mfma_f32_16x16x32_bf16 v[68:71], a[32:35], v[100:103], v[68:71]
ds_read_b128 v[92:95], v9 offset:32768
ds_read_b128 v[96:99], v9 offset:33792
v_mfma_f32_16x16x32_bf16 v[72:75], a[32:35], v[104:107], v[72:75]
s_waitcnt vmcnt(8)
v_mfma_f32_16x16x32_bf16 v[52:55], a[36:39], v[84:87], v[52:55]
v_mfma_f32_16x16x32_bf16 v[56:59], a[36:39], v[88:91], v[56:59]
s_waitcnt vmcnt(7)
v_mfma_f32_16x16x32_bf16 v[60:63], a[40:43], v[84:87], v[60:63]
s_waitcnt lgkmcnt(1)
v_swap_b32 v93, v94
v_mfma_f32_16x16x32_bf16 v[64:67], a[40:43], v[88:91], v[64:67]
s_waitcnt vmcnt(6) lgkmcnt(0)
v_swap_b32 v97, v98
v_swap_b32 v94, v96
v_mfma_f32_16x16x32_bf16 v[68:71], a[44:47], v[84:87], v[68:71]
ds_read_b128 v[100:103], v9 offset:34816
v_swap_b32 v95, v97
v_mfma_f32_16x16x32_bf16 v[72:75], a[44:47], v[88:91], v[72:75]
ds_read_b128 v[104:107], v9 offset:35840
s_waitcnt vmcnt(5)
v_mfma_f32_16x16x32_bf16 v[52:55], a[48:51], v[92:95], v[52:55]
v_mfma_f32_16x16x32_bf16 v[56:59], a[48:51], v[96:99], v[56:59]
s_waitcnt vmcnt(4)
v_mfma_f32_16x16x32_bf16 v[60:63], a[52:55], v[92:95], v[60:63]
s_waitcnt lgkmcnt(1)
v_swap_b32 v101, v102
v_mfma_f32_16x16x32_bf16 v[64:67], a[52:55], v[96:99], v[64:67]
s_waitcnt vmcnt(3) lgkmcnt(0)
v_swap_b32 v105, v106
v_swap_b32 v102, v104
v_mfma_f32_16x16x32_bf16 v[68:71], a[56:59], v[92:95], v[68:71]
v_swap_b32 v103, v105
v_mfma_f32_16x16x32_bf16 v[72:75], a[56:59], v[96:99], v[72:75]
s_waitcnt vmcnt(2)
v_mfma_f32_16x16x32_bf16 v[52:55], a[60:63], v[100:103], v[52:55]
v_mfma_f32_16x16x32_bf16 v[56:59], a[60:63], v[104:107], v[56:59]
s_waitcnt vmcnt(1)
v_mfma_f32_16x16x32_bf16 v[60:63], a[64:67], v[100:103], v[60:63]
v_mfma_f32_16x16x32_bf16 v[64:67], a[64:67], v[104:107], v[64:67]
s_waitcnt vmcnt(0)
v_mfma_f32_16x16x32_bf16 v[68:71], a[68:71], v[100:103], v[68:71]
v_mfma_f32_16x16x32_bf16 v[72:75], a[68:71], v[104:107], v[72:75]
s_cmp_eq_u64 s[88:89], -1
s_cbranch_scc1 L_have
s_mov_b32 s100, 0
L_wait6:

buffer_load_dword v12, v4, s[32:35], s58 offen sc1
s_waitcnt vmcnt(0)
v_cmp_ge_u32 s[86:87], v12, 6
s_add_u32 s100, s100, 1
s_cmp_ge_u32 s100, 262144
s_cbranch_scc1 L_got6
s_cmp_eq_u64 s[86:87], -1
s_cbranch_scc0 L_wait6
L_got6:
buffer_load_dwordx4 v[244:247], v1, s[32:35], s48 offen offset:0 sc1
buffer_load_dwordx4 v[20:23], v1, s[32:35], s49 offen offset:0 sc1
buffer_load_dwordx4 v[32:35], v1, s[32:35], s51 offen offset:0 sc1
buffer_load_dwordx4 v[248:251], v1, s[32:35], s48 offen offset:1024 sc1
buffer_load_dwordx4 v[24:27], v1, s[32:35], s49 offen offset:1024 sc1
buffer_load_dwordx4 v[36:39], v1, s[32:35], s51 offen offset:1024 sc1
buffer_load_dwordx4 v[252:255], v11, s[32:35], s48 offen offset:2048 sc1
buffer_load_dwordx4 v[28:31], v11, s[32:35], s49 offen offset:2048 sc1
buffer_load_dwordx4 v[40:43], v11, s[32:35], s51 offen offset:2048 sc1
L_have:
s_mov_b32 s95, 0x00003f80
s_mov_b32 s96, 0x3f800000
v_dot2c_f32_bf16 v168, s95, v232
v_dot2c_f32_bf16 v169, s96, v232
v_dot2c_f32_bf16 v170, s95, v233
v_dot2c_f32_bf16 v171, s96, v233
v_dot2c_f32_bf16 v172, s95, v234
v_dot2c_f32_bf16 v173, s96, v234
v_dot2c_f32_bf16 v174, s95, v235
v_dot2c_f32_bf16 v175, s96, v235
s_waitcnt vmcnt(8)
v_dot2c_f32_bf16 v168, s95, v244
v_dot2c_f32_bf16 v169, s96, v244
v_dot2c_f32_bf16 v170, s95, v245
v_dot2c_f32_bf16 v171, s96, v245
v_dot2c_f32_bf16 v172, s95, v246
v_dot2c_f32_bf16 v173, s96, v246
v_dot2c_f32_bf16 v174, s95, v247
v_dot2c_f32_bf16 v175, s96, v247
s_waitcnt vmcnt(7)
v_dot2c_f32_bf16 v168, s95, v20
v_dot2c_f32_bf16 v169, s96, v20
v_dot2c_f32_bf16 v170, s95, v21
v_dot2c_f32_bf16 v171, s96, v21
v_dot2c_f32_bf16 v172, s95, v22
v_dot2c_f32_bf16 v173, s96, v22
v_dot2c_f32_bf16 v174, s95, v23
v_dot2c_f32_bf16 v175, s96, v23
s_waitcnt vmcnt(6)
v_dot2c_f32_bf16 v168, s95, v32
v_dot2c_f32_bf16 v169, s96, v32
v_dot2c_f32_bf16 v170, s95, v33
v_dot2c_f32_bf16 v171, s96, v33
v_dot2c_f32_bf16 v172, s95, v34
v_dot2c_f32_bf16 v173, s96, v34
v_dot2c_f32_bf16 v174, s95, v35
v_dot2c_f32_bf16 v175, s96, v35
v_mul_f32 v116, s90, v168
v_mul_f32 v117, s90, v169
v_mul_f32 v118, s90, v170
v_mul_f32 v119, s90, v171
v_mul_f32 v120, s90, v172
v_mul_f32 v121, s90, v173
v_mul_f32 v122, s90, v174
v_mul_f32 v123, s90, v175
v_exp_f32 v116, v116
v_exp_f32 v117, v117
v_exp_f32 v118, v118
v_exp_f32 v119, v119
v_exp_f32 v120, v120
v_exp_f32 v121, v121
v_exp_f32 v122, v122
v_exp_f32 v123, v123
v_mul_f32 v168, v168, v52
v_add_f32 v116, 1.0, v116
v_mul_f32 v169, v169, v53
v_add_f32 v117, 1.0, v117
v_mul_f32 v170, v170, v54
v_add_f32 v118, 1.0, v118
v_mul_f32 v171, v171, v55
v_add_f32 v119, 1.0, v119
v_mul_f32 v172, v172, v56
v_add_f32 v120, 1.0, v120
v_mul_f32 v173, v173, v57
v_add_f32 v121, 1.0, v121
v_mul_f32 v174, v174, v58
v_add_f32 v122, 1.0, v122
v_mul_f32 v175, v175, v59
v_add_f32 v123, 1.0, v123
v_rcp_f32 v116, v116
v_rcp_f32 v117, v117
v_rcp_f32 v118, v118
v_rcp_f32 v119, v119
v_rcp_f32 v120, v120
v_rcp_f32 v121, v121
v_rcp_f32 v122, v122
v_rcp_f32 v123, v123
v_fma_f32 v168, v168, v116, v124
v_fma_f32 v169, v169, v117, v125
v_fma_f32 v170, v170, v118, v126
v_fma_f32 v171, v171, v119, v127
v_fma_f32 v172, v172, v120, v128
v_fma_f32 v173, v173, v121, v129
v_fma_f32 v174, v174, v122, v130
v_fma_f32 v175, v175, v123, v131
v_cvt_pk_bf16_f32 v168, v168, v169
v_cvt_pk_bf16_f32 v169, v170, v171
buffer_store_dwordx2 v[168:169], v2, s[24:27], s45 offen offset:0
v_cvt_pk_bf16_f32 v172, v172, v173
v_cvt_pk_bf16_f32 v173, v174, v175
buffer_store_dwordx2 v[172:173], v5, s[24:27], s45 offen offset:0
v_dot2c_f32_bf16 v176, s95, v236
v_dot2c_f32_bf16 v177, s96, v236
v_dot2c_f32_bf16 v178, s95, v237
v_dot2c_f32_bf16 v179, s96, v237
v_dot2c_f32_bf16 v180, s95, v238
v_dot2c_f32_bf16 v181, s96, v238
v_dot2c_f32_bf16 v182, s95, v239
v_dot2c_f32_bf16 v183, s96, v239
s_waitcnt vmcnt(7)
v_dot2c_f32_bf16 v176, s95, v248
v_dot2c_f32_bf16 v177, s96, v248
v_dot2c_f32_bf16 v178, s95, v249
v_dot2c_f32_bf16 v179, s96, v249
v_dot2c_f32_bf16 v180, s95, v250
v_dot2c_f32_bf16 v181, s96, v250
v_dot2c_f32_bf16 v182, s95, v251
v_dot2c_f32_bf16 v183, s96, v251
s_waitcnt vmcnt(6)
v_dot2c_f32_bf16 v176, s95, v24
v_dot2c_f32_bf16 v177, s96, v24
v_dot2c_f32_bf16 v178, s95, v25
v_dot2c_f32_bf16 v179, s96, v25
v_dot2c_f32_bf16 v180, s95, v26
v_dot2c_f32_bf16 v181, s96, v26
v_dot2c_f32_bf16 v182, s95, v27
v_dot2c_f32_bf16 v183, s96, v27
s_waitcnt vmcnt(5)
v_dot2c_f32_bf16 v176, s95, v36
v_dot2c_f32_bf16 v177, s96, v36
v_dot2c_f32_bf16 v178, s95, v37
v_dot2c_f32_bf16 v179, s96, v37
v_dot2c_f32_bf16 v180, s95, v38
v_dot2c_f32_bf16 v181, s96, v38
v_dot2c_f32_bf16 v182, s95, v39
v_dot2c_f32_bf16 v183, s96, v39
v_mul_f32 v116, s90, v176
v_mul_f32 v117, s90, v177
v_mul_f32 v118, s90, v178
v_mul_f32 v119, s90, v179
v_mul_f32 v120, s90, v180
v_mul_f32 v121, s90, v181
v_mul_f32 v122, s90, v182
v_mul_f32 v123, s90, v183
v_exp_f32 v116, v116
v_exp_f32 v117, v117
v_exp_f32 v118, v118
v_exp_f32 v119, v119
v_exp_f32 v120, v120
v_exp_f32 v121, v121
v_exp_f32 v122, v122
v_exp_f32 v123, v123
v_mul_f32 v176, v176, v60
v_add_f32 v116, 1.0, v116
v_mul_f32 v177, v177, v61
v_add_f32 v117, 1.0, v117
v_mul_f32 v178, v178, v62
v_add_f32 v118, 1.0, v118
v_mul_f32 v179, v179, v63
v_add_f32 v119, 1.0, v119
v_mul_f32 v180, v180, v64
v_add_f32 v120, 1.0, v120
v_mul_f32 v181, v181, v65
v_add_f32 v121, 1.0, v121
v_mul_f32 v182, v182, v66
v_add_f32 v122, 1.0, v122
v_mul_f32 v183, v183, v67
v_add_f32 v123, 1.0, v123
v_rcp_f32 v116, v116
v_rcp_f32 v117, v117
v_rcp_f32 v118, v118
v_rcp_f32 v119, v119
v_rcp_f32 v120, v120
v_rcp_f32 v121, v121
v_rcp_f32 v122, v122
v_rcp_f32 v123, v123
v_fma_f32 v176, v176, v116, v132
v_fma_f32 v177, v177, v117, v133
v_fma_f32 v178, v178, v118, v134
v_fma_f32 v179, v179, v119, v135
v_fma_f32 v180, v180, v120, v136
v_fma_f32 v181, v181, v121, v137
v_fma_f32 v182, v182, v122, v138
v_fma_f32 v183, v183, v123, v139
v_cvt_pk_bf16_f32 v176, v176, v177
v_cvt_pk_bf16_f32 v177, v178, v179
buffer_store_dwordx2 v[176:177], v2, s[24:27], s45 offen offset:32
v_cvt_pk_bf16_f32 v180, v180, v181
v_cvt_pk_bf16_f32 v181, v182, v183
buffer_store_dwordx2 v[180:181], v5, s[24:27], s45 offen offset:32
v_dot2c_f32_bf16 v184, s95, v240
v_dot2c_f32_bf16 v185, s96, v240
v_dot2c_f32_bf16 v186, s95, v241
v_dot2c_f32_bf16 v187, s96, v241
v_dot2c_f32_bf16 v188, s95, v242
v_dot2c_f32_bf16 v189, s96, v242
v_dot2c_f32_bf16 v190, s95, v243
v_dot2c_f32_bf16 v191, s96, v243
s_waitcnt vmcnt(6)
v_dot2c_f32_bf16 v184, s95, v252
v_dot2c_f32_bf16 v185, s96, v252
v_dot2c_f32_bf16 v186, s95, v253
v_dot2c_f32_bf16 v187, s96, v253
v_dot2c_f32_bf16 v188, s95, v254
v_dot2c_f32_bf16 v189, s96, v254
v_dot2c_f32_bf16 v190, s95, v255
v_dot2c_f32_bf16 v191, s96, v255
s_waitcnt vmcnt(5)
v_dot2c_f32_bf16 v184, s95, v28
v_dot2c_f32_bf16 v185, s96, v28
v_dot2c_f32_bf16 v186, s95, v29
v_dot2c_f32_bf16 v187, s96, v29
v_dot2c_f32_bf16 v188, s95, v30
v_dot2c_f32_bf16 v189, s96, v30
v_dot2c_f32_bf16 v190, s95, v31
v_dot2c_f32_bf16 v191, s96, v31
s_waitcnt vmcnt(4)
v_dot2c_f32_bf16 v184, s95, v40
v_dot2c_f32_bf16 v185, s96, v40
v_dot2c_f32_bf16 v186, s95, v41
v_dot2c_f32_bf16 v187, s96, v41
v_dot2c_f32_bf16 v188, s95, v42
v_dot2c_f32_bf16 v189, s96, v42
v_dot2c_f32_bf16 v190, s95, v43
v_dot2c_f32_bf16 v191, s96, v43
v_mul_f32 v116, s90, v184
v_mul_f32 v117, s90, v185
v_mul_f32 v118, s90, v186
v_mul_f32 v119, s90, v187
v_mul_f32 v120, s90, v188
v_mul_f32 v121, s90, v189
v_mul_f32 v122, s90, v190
v_mul_f32 v123, s90, v191
v_exp_f32 v116, v116
v_exp_f32 v117, v117
v_exp_f32 v118, v118
v_exp_f32 v119, v119
v_exp_f32 v120, v120
v_exp_f32 v121, v121
v_exp_f32 v122, v122
v_exp_f32 v123, v123
v_mul_f32 v184, v184, v68
v_add_f32 v116, 1.0, v116
v_mul_f32 v185, v185, v69
v_add_f32 v117, 1.0, v117
v_mul_f32 v186, v186, v70
v_add_f32 v118, 1.0, v118
v_mul_f32 v187, v187, v71
v_add_f32 v119, 1.0, v119
v_mul_f32 v188, v188, v72
v_add_f32 v120, 1.0, v120
v_mul_f32 v189, v189, v73
v_add_f32 v121, 1.0, v121
v_mul_f32 v190, v190, v74
v_add_f32 v122, 1.0, v122
v_mul_f32 v191, v191, v75
v_add_f32 v123, 1.0, v123
v_rcp_f32 v116, v116
v_rcp_f32 v117, v117
v_rcp_f32 v118, v118
v_rcp_f32 v119, v119
v_rcp_f32 v120, v120
v_rcp_f32 v121, v121
v_rcp_f32 v122, v122
v_rcp_f32 v123, v123
v_fma_f32 v184, v184, v116, v140
v_fma_f32 v185, v185, v117, v141
v_fma_f32 v186, v186, v118, v142
v_fma_f32 v187, v187, v119, v143
v_fma_f32 v188, v188, v120, v144
v_fma_f32 v189, v189, v121, v145
v_fma_f32 v190, v190, v122, v146
v_fma_f32 v191, v191, v123, v147
v_cvt_pk_bf16_f32 v184, v184, v185
v_cvt_pk_bf16_f32 v185, v186, v187
buffer_store_dwordx2 v[184:185], v76, s[24:27], s45 offen offset:64
v_cvt_pk_bf16_f32 v188, v188, v189
v_cvt_pk_bf16_f32 v189, v190, v191
buffer_store_dwordx2 v[188:189], v77, s[24:27], s45 offen offset:64
L_end:
s_endpgm
L_slow0:
s_mov_b32 s100, 0
L_spin0:
s_sleep 1
buffer_load_dword v12, v14, s[28:31], s51 offen sc1
s_waitcnt vmcnt(0)
v_cmp_ge_u32 s[86:87], v12, 16
s_nop 3
s_add_u32 s100, s100, 1

s_cmp_eq_u64 s[86:87], -1
s_cbranch_scc1 L_back0
s_cmp_lt_u32 s100, 262144
s_cbranch_scc1 L_spin0
s_branch L_back0
L_slow1:
s_mov_b32 s100, 0
L_spin1:
s_sleep 1
buffer_load_dword v12, v14, s[28:31], 0 offen sc1
s_waitcnt vmcnt(0)
v_cmp_ge_u32 s[86:87], v12, 16
s_nop 3
s_add_u32 s100, s100, 1

s_cmp_eq_u64 s[86:87], -1
s_cbranch_scc1 L_back1
s_cmp_lt_u32 s100, 262144
s_cbranch_scc1 L_spin1
s_branch L_back1
L_slow2:
s_mov_b32 s100, 0
L_spin2:
s_sleep 1
buffer_load_dword v12, v14, s[32:35], s57 offen sc1
s_waitcnt vmcnt(0)
v_cmp_ge_u32 s[86:87], v12, 1
s_nop 3
s_add_u32 s100, s100, 1

s_cmp_eq_u64 s[86:87], -1
s_cbranch_scc1 L_back2
s_cmp_lt_u32 s100, 262144
s_cbranch_scc1 L_spin2
s_branch L_back2
L_slow3:
s_mov_b32 s100, 0
L_spin3:
s_sleep 1
buffer_load_dword v12, v3, s[32:35], s74 offen sc1
s_waitcnt vmcnt(0)
v_cmp_ge_u32 s[86:87], v12, 2
s_nop 3
s_add_u32 s100, s100, 1

s_cmp_eq_u64 s[86:87], -1
s_cbranch_scc1 L_back3
s_cmp_lt_u32 s100, 262144
s_cbranch_scc1 L_spin3
s_branch L_back3
L_slow4:
s_mov_b32 s100, 0
L_spin4:
s_sleep 1
buffer_load_dword v12, v3, s[32:35], s74 offen sc1
s_waitcnt vmcnt(0)
v_cmp_ge_u32 s[86:87], v12, 3
s_nop 3
s_add_u32 s100, s100, 1

s_cmp_eq_u64 s[86:87], -1
s_cbranch_scc1 L_back4
s_cmp_lt_u32 s100, 262144
s_cbranch_scc1 L_spin4
s_branch L_back4
L_slow5:
s_mov_b32 s100, 0
L_spin5:
s_sleep 1
buffer_load_dword v12, v3, s[32:35], s74 offen sc1
s_waitcnt vmcnt(0)
v_cmp_ge_u32 s[86:87], v12, 4
s_nop 3
s_add_u32 s100, s100, 1

s_cmp_eq_u64 s[86:87], -1
s_cbranch_scc1 L_back5
s_cmp_lt_u32 s100, 262144
s_cbranch_scc1 L_spin5
s_branch L_back5
L_slow6:
s_mov_b32 s100, 0
L_spin6:
s_sleep 1
buffer_load_dword v12, v3, s[32:35], s74 offen sc1
s_waitcnt vmcnt(0)
v_cmp_ge_u32 s[86:87], v12, 5
s_nop 3
s_add_u32 s100, s100, 1

s_cmp_eq_u64 s[86:87], -1
s_cbranch_scc1 L_back6
s_cmp_lt_u32 s100, 262144
s_cbranch_scc1 L_spin6
s_branch L_back6
L_slow7:
s_mov_b32 s100, 0
L_spin7:
s_sleep 1
buffer_load_dword v12, v14, s[32:35], s56 offen sc1
s_waitcnt vmcnt(0)
v_cmp_ge_u32 s[86:87], v12, 3
s_nop 3
s_add_u32 s100, s100, 1

s_cmp_eq_u64 s[86:87], -1
s_cbranch_scc1 L_back7
s_cmp_lt_u32 s100, 262144
s_cbranch_scc1 L_spin7
s_branch L_back7
L_code_end:
.section .rodata,"a"
.p2align 6
.amdhsa_kernel recurrent_scan__linear_attn_block__glu_gated_glu__prompt_kernel
  .amdhsa_next_free_vgpr 512
  .amdhsa_next_free_sgpr 102
  .amdhsa_accum_offset 256
  .amdhsa_group_segment_fixed_size 0
  .amdhsa_kernarg_size 80
  .amdhsa_user_sgpr_count 2
  .amdhsa_user_sgpr_kernarg_segment_ptr 1
  .amdhsa_system_sgpr_workgroup_id_x 1
.end_amdhsa_kernel
```
